```python
import torch

def _softmax(x, axis=-1):
    return torch.softmax(x, dim=axis)

def _gelu(x):
    return torch.nn.functional.gelu(x, approximate='tanh')

def _silu(x):
    return torch.nn.functional.silu(x)

def _sigmoid(x):
    return torch.sigmoid(x)

def _layernorm(x, axis=-1, eps=1e-05):
    m = x.mean(dim=axis, keepdim=True)
    v = x.var(dim=axis, keepdim=True, unbiased=False)
    return (x - m) / torch.sqrt(v + eps)

def _scatter_add(tgt, idx, src, axis=0):
    return tgt.clone().index_add_(axis, idx, src)

def _segment_sum(src, seg, n):
    out = torch.zeros((n,) + src.shape[1:], dtype=src.dtype)
    return out.index_add_(0, seg, src)

def _pad(x, pw):
    flat = tuple((v for pair in reversed(pw) for v in pair))
    return torch.nn.functional.pad(x, flat)
kernel_name = 'standalone__conformer_family_e_branchformer__speech'

def setup_inputs():

    _w = lambda a: (lambda t: t.to(torch.bfloat16) if t.is_floating_point() else t)(torch.as_tensor(a))
    B, T, D, K = (2, 1000, 512, 31)
    return {'x': _w((lambda *s: torch.randn(*s, dtype=torch.bfloat16) * 0.05)(B, T, D)), 'w_qkv': _w((lambda *s: torch.randn(*s, dtype=torch.bfloat16) * 0.05)(D, 3 * D)), 'w_att_out': _w((lambda *s: torch.randn(*s, dtype=torch.bfloat16) * 0.05)(D, D)), 'w_mlp_in': _w((lambda *s: torch.randn(*s, dtype=torch.bfloat16) * 0.05)(D, 2 * D)), 'dw_csgu': _w((lambda *s: torch.randn(*s, dtype=torch.bfloat16) * 0.05)(K, D)), 'w_mlp_out': _w((lambda *s: torch.randn(*s, dtype=torch.bfloat16) * 0.05)(D, D)), 'dw_merge': _w((lambda *s: torch.randn(*s, dtype=torch.bfloat16) * 0.05)(K, 2 * D)), 'w_merge': _w((lambda *s: torch.randn(*s, dtype=torch.bfloat16) * 0.05)(2 * D, D))}

def reference(x, w_qkv, w_att_out, w_mlp_in, dw_csgu, w_mlp_out, dw_merge, w_merge):
    B, T, D = x.shape
    K = dw_csgu.shape[0]
    pad = K // 2
    xa = _layernorm(x, axis=-1)
    qkv = torch.einsum('btd,de->bte', xa, w_qkv)
    q, k, v = (qkv[..., :D].clone(), qkv[..., D:2 * D].clone(), qkv[..., 2 * D:].clone())
    scores = torch.einsum('btd,bsd->bts', q, k) * D ** (-0.5)
    p = _softmax(scores, axis=-1)
    attn = torch.einsum('bts,bsd->btd', p, v)
    glob = torch.einsum('btd,de->bte', attn, w_att_out)
    xc = _layernorm(x, axis=-1)
    h = _gelu(torch.einsum('btd,de->bte', xc, w_mlp_in))
    u, g = (h[..., :D].clone(), h[..., D:].clone())
    g = _layernorm(g, axis=-1)
    gp = _pad(g, ((0, 0), (pad, pad), (0, 0)))
    gc = torch.zeros_like(g)
    for i in range(K):
        gc = gc + gp[:, i:i + T, :] * dw_csgu[i][None, None, :]
    loc = torch.einsum('btd,de->bte', u * gc, w_mlp_out)
    m = torch.concatenate([glob, loc], axis=-1)
    mp = _pad(m, ((0, 0), (pad, pad), (0, 0)))
    mc = torch.zeros_like(m)
    for i in range(K):
        mc = mc + mp[:, i:i + T, :] * dw_merge[i][None, None, :]
    m = m + mc
    return x + torch.einsum('btc,cd->btd', m, w_merge)
```

```asm
; @launch grid=(256,1,1) block=(512,1,1) lds=163840
.amdgcn_target "amdgcn-amd-amdhsa--gfx950"
.text
.globl standalone__conformer_family_e_branchformer__speech_kernel
.p2align 8
.type standalone__conformer_family_e_branchformer__speech_kernel,@function
standalone__conformer_family_e_branchformer__speech_kernel:
  s_cmp_ge_u32 s2, 256
  s_cbranch_scc1 P4_END_EXIT
  s_load_dwordx2 s[96:97], s[0:1], 80
  s_cmp_ge_u32 s2, 256
  s_cbranch_scc1 P1_END
  s_load_dwordx2 s[4:5], s[0:1], 0
  s_load_dwordx2 s[6:7], s[0:1], 8
  s_load_dwordx2 s[32:33], s[0:1], 24
  s_load_dwordx2 s[34:35], s[0:1], 80
  v_lshrrev_b32 v1, 6, v0
  v_and_b32 v2, 63, v0
  v_readfirstlane_b32 s36, v1
  s_and_b32 s42, s2, 7
  s_lshr_b32 s43, s2, 3
  s_lshr_b32 s37, s42, 1
  s_lshl_b32 s37, s37, 2
  s_and_b32 s44, s43, 3
  s_add_u32 s37, s37, s44
  s_and_b32 s38, s42, 1
  s_lshl_b32 s38, s38, 3
  s_lshr_b32 s39, s43, 2
  s_add_u32 s38, s38, s39
  s_lshr_b32 s39, s37, 1
  s_mov_b32 s58, s36
  s_cmp_ge_u32 s36, 4
  s_cbranch_scc1 P1_LOADER
  v_and_b32 v10, 31, v2
  v_lshrrev_b32 v11, 5, v2
  v_lshrrev_b32 v12, 1, v10
  v_and_b32 v12, 7, v12
  v_lshlrev_b32 v13, 7, v10
  s_lshl_b32 s42, s36, 12
  v_add_u32 v13, s42, v13
  v_add_u32 v13, 2048, v13
  v_add_u32 v14, 0, v11
  v_xor_b32 v14, v14, v12
  v_lshl_add_u32 v3, v14, 4, v13
  v_add_u32 v14, 2, v11
  v_xor_b32 v14, v14, v12
  v_lshl_add_u32 v4, v14, 4, v13
  v_add_u32 v14, 4, v11
  v_xor_b32 v14, v14, v12
  v_lshl_add_u32 v5, v14, 4, v13
  v_add_u32 v14, 6, v11
  v_xor_b32 v14, v14, v12
  v_lshl_add_u32 v6, v14, 4, v13
  s_lshl_b32 s42, s37, 7
  s_lshl_b32 s43, s38, 3
  s_add_u32 s42, s42, s43
  s_lshl_b32 s43, s36, 1
  s_add_u32 s46, s42, s43
  s_lshl_b32 s43, s46, 10
  v_lshlrev_b32 v10, 4, v2
  s_lshl_b32 s45, s37, 4
  s_add_u32 s45, s45, s38
  s_waitcnt lgkmcnt(0)
  s_mov_b32 s16, s4
  s_mov_b32 s17, s5
  s_mov_b32 s18, 2048000
  s_mov_b32 s19, 0x20000
  buffer_load_dwordx4 v[160:163], v10, s[16:19], s43 offen
  s_add_u32 s43, s43, 1024
  buffer_load_dwordx4 v[164:167], v10, s[16:19], s43 offen
  s_add_u32 s8, s34, 11010048
  s_addc_u32 s9, s35, 0
  s_mov_b32 s10, 16384
  s_mov_b32 s11, 0x20000
  s_add_u32 s12, s34, 11141120
  s_addc_u32 s13, s35, 0
  s_mov_b32 s14, 163840
  s_mov_b32 s15, 0x20000
  s_add_u32 s92, s96, 31457280
  s_addc_u32 s93, s97, 0
  s_mov_b32 s94, 163840
  s_mov_b32 s95, 0x20000
  s_add_u32 s96, s96, 31588352
  s_addc_u32 s97, s97, 0
  s_load_dword s3, s[96:97], 0
  s_mov_b32 s20, s34
  s_mov_b32 s21, s35
  s_mov_b32 s22, 6144000
  s_mov_b32 s23, 0x20000
  s_add_u32 s24, s34, 6291456
  s_addc_u32 s25, s35, 0
  s_mov_b32 s26, 4194304
  s_mov_b32 s27, 0x20000
  s_add_u32 s28, s34, 10485760
  s_addc_u32 s29, s35, 0
  s_mov_b32 s30, 131072
  s_mov_b32 s31, 0x20000
  v_lshrrev_b32 v10, 5, v2
  v_lshlrev_b32 v10, 3, v10
  v_bfe_u32 v11, v2, 2, 2
  v_add_u32 v10, v10, v11
  v_bfe_u32 v12, v2, 4, 1
  v_lshlrev_b32 v12, 5, v12
  v_and_b32 v13, 3, v2
  v_lshl_add_u32 v12, v13, 3, v12
  v_mul_u32_u24 v7, 192, v10
  v_add_u32 v7, v7, v12
  v_add_u32 v7, 2048, v7
  v_lshrrev_b32 v10, 5, v2
  v_lshlrev_b32 v10, 3, v10
  v_bfe_u32 v11, v2, 2, 2
  v_add_u32 v10, v10, v11
  v_bfe_u32 v12, v2, 4, 1
  v_lshlrev_b32 v12, 5, v12
  v_and_b32 v13, 3, v2
  v_lshl_add_u32 v12, v13, 3, v12
  v_lshlrev_b32 v13, 7, v10
  v_add_u32 v13, v13, v12
  v_add_u32 v13, 2048, v13
  v_bfe_u32 v14, v2, 3, 1
  v_lshlrev_b32 v14, 6, v14
  v_add_u32 v8, v13, v14
  v_xor_b32 v14, 64, v14
  v_add_u32 v9, v13, v14
  s_mov_b32 s53, 0
  s_mov_b32 s56, 4294856704
  s_mov_b32 s57, 36864
  v_mov_b32 v68, 0
  v_mov_b32 v69, 0
  v_mov_b32 v70, 0
  v_mov_b32 v71, 0
  v_mov_b32 v72, 0
  v_mov_b32 v73, 0
  v_mov_b32 v74, 0
  v_mov_b32 v75, 0
  v_mov_b32 v76, 0
  v_mov_b32 v77, 0
  v_mov_b32 v78, 0
  v_mov_b32 v79, 0
  v_mov_b32 v80, 0
  v_mov_b32 v81, 0
  v_mov_b32 v82, 0
  v_mov_b32 v83, 0
  v_mov_b32 v84, 0
  v_mov_b32 v85, 0
  v_mov_b32 v86, 0
  v_mov_b32 v87, 0
  v_mov_b32 v88, 0
  v_mov_b32 v89, 0
  v_mov_b32 v90, 0
  v_mov_b32 v91, 0
  v_mov_b32 v92, 0
  v_mov_b32 v93, 0
  v_mov_b32 v94, 0
  v_mov_b32 v95, 0
  v_mov_b32 v96, 0
  v_mov_b32 v97, 0
  v_mov_b32 v98, 0
  v_mov_b32 v99, 0
  v_mov_b32 v100, 0
  v_mov_b32 v101, 0
  v_mov_b32 v102, 0
  v_mov_b32 v103, 0
  v_mov_b32 v104, 0
  v_mov_b32 v105, 0
  v_mov_b32 v106, 0
  v_mov_b32 v107, 0
  v_mov_b32 v108, 0
  v_mov_b32 v109, 0
  v_mov_b32 v110, 0
  v_mov_b32 v111, 0
  v_mov_b32 v112, 0
  v_mov_b32 v113, 0
  v_mov_b32 v114, 0
  v_mov_b32 v115, 0
  v_mov_b32 v116, 0
  v_mov_b32 v117, 0
  v_mov_b32 v118, 0
  v_mov_b32 v119, 0
  v_mov_b32 v120, 0
  v_mov_b32 v121, 0
  v_mov_b32 v122, 0
  v_mov_b32 v123, 0
  v_mov_b32 v124, 0
  v_mov_b32 v125, 0
  v_mov_b32 v126, 0
  v_mov_b32 v127, 0
  v_mov_b32 v128, 0
  v_mov_b32 v129, 0
  v_mov_b32 v130, 0
  v_mov_b32 v131, 0
  v_mov_b32 v132, 0
  v_mov_b32 v133, 0
  v_mov_b32 v134, 0
  v_mov_b32 v135, 0
  v_mov_b32 v136, 0
  v_mov_b32 v137, 0
  v_mov_b32 v138, 0
  v_mov_b32 v139, 0
  v_mov_b32 v140, 0
  v_mov_b32 v141, 0
  v_mov_b32 v142, 0
  v_mov_b32 v143, 0
  v_mov_b32 v144, 0
  v_mov_b32 v145, 0
  v_mov_b32 v146, 0
  v_mov_b32 v147, 0
  v_mov_b32 v148, 0
  v_mov_b32 v149, 0
  v_mov_b32 v150, 0
  v_mov_b32 v151, 0
  v_mov_b32 v152, 0
  v_mov_b32 v153, 0
  v_mov_b32 v154, 0
  v_mov_b32 v155, 0
  v_mov_b32 v156, 0x3f803f80
  v_mov_b32 v157, 0x3f803f80
  s_mov_b32 s51, 0x3f803f80
  v_mov_b32 v168, 0
  v_mov_b32 v169, 0
  v_mov_b32 v170, 0
  v_mov_b32 v171, 0
  s_waitcnt vmcnt(0)
  v_dot2_f32_bf16 v168, v160, s51, v168
  v_dot2_f32_bf16 v169, v160, v160, v169
  v_dot2_f32_bf16 v170, v164, s51, v170
  v_dot2_f32_bf16 v171, v164, v164, v171
  v_dot2_f32_bf16 v168, v161, s51, v168
  v_dot2_f32_bf16 v169, v161, v161, v169
  v_dot2_f32_bf16 v170, v165, s51, v170
  v_dot2_f32_bf16 v171, v165, v165, v171
  v_dot2_f32_bf16 v168, v162, s51, v168
  v_dot2_f32_bf16 v169, v162, v162, v169
  v_dot2_f32_bf16 v170, v166, s51, v170
  v_dot2_f32_bf16 v171, v166, v166, v171
  v_dot2_f32_bf16 v168, v163, s51, v168
  v_dot2_f32_bf16 v169, v163, v163, v169
  v_dot2_f32_bf16 v170, v167, s51, v170
  v_dot2_f32_bf16 v171, v167, v167, v171
  s_nop 2
  v_permlane32_swap_b32 v168, v169
  v_permlane32_swap_b32 v170, v171
  v_add_f32 v168, v168, v169
  v_add_f32 v170, v170, v171
  s_nop 1
  v_permlane16_swap_b32 v168, v170
  v_add_f32 v168, v168, v170
  s_nop 1
  v_add_f32_dpp v168, v168, v168 row_ror:8 row_mask:0xf bank_mask:0xf
  s_nop 1
  v_add_f32_dpp v168, v168, v168 row_ror:4 row_mask:0xf bank_mask:0xf
  s_nop 1
  v_add_f32_dpp v168, v168, v168 row_ror:2 row_mask:0xf bank_mask:0xf
  s_nop 1
  v_add_f32_dpp v168, v168, v168 row_ror:1 row_mask:0xf bank_mask:0xf
  v_mov_b32 v169, v168
  s_nop 1
  v_permlane32_swap_b32 v168, v169
  v_mul_f32 v168, 0x3b000000, v168
  v_mul_f32 v169, 0x3b000000, v169
  v_fma_f32 v169, -v168, v168, v169
  v_max_f32 v169, 0, v169
  v_add_f32 v169, 0x3727c5ac, v169
  v_rsq_f32 v170, v169
  v_mul_f32 v171, -1.0, v168
  v_bfe_u32 v172, v2, 4, 1
  v_mul_f32 v171, v171, v170
  v_add_u32 v172, s46, v172
  v_lshlrev_b32 v172, 3, v172
  v_and_b32 v173, 0x2f, v2
  v_cmp_eq_u32 vcc, 0, v173
  s_nop 0
  s_and_saveexec_b64 s[54:55], vcc
  buffer_store_dwordx2 v[170:171], v172, s[8:11], 0 offen sc1
  s_mov_b64 exec, s[54:55]
  s_waitcnt lgkmcnt(0)
  s_barrier
  ds_read_b128 v[20:23], v3
  ds_read_b64_tr_b16 v[28:29], v7 offset:16384
  ds_read_b64_tr_b16 v[30:31], v7 offset:17152
  ds_read_b64_tr_b16 v[32:33], v7 offset:16448
  ds_read_b64_tr_b16 v[34:35], v7 offset:17216
  ds_read_b64_tr_b16 v[36:37], v7 offset:16512
  ds_read_b64_tr_b16 v[38:39], v7 offset:17280
  ds_read_b64_tr_b16 v[40:41], v8 offset:28672
  ds_read_b64_tr_b16 v[42:43], v8 offset:29184
  ds_read_b64_tr_b16 v[44:45], v9 offset:28672
  ds_read_b64_tr_b16 v[46:47], v9 offset:29184
  s_waitcnt lgkmcnt(8)
  v_mfma_f32_32x32x16_bf16 v[68:83], v[28:31], v[20:23], v[68:83]
  ds_read_b128 v[24:27], v4
  ds_read_b64_tr_b16 v[48:49], v7 offset:19456
  ds_read_b64_tr_b16 v[50:51], v7 offset:20224
  ds_read_b64_tr_b16 v[52:53], v7 offset:19520
  s_waitcnt lgkmcnt(10)
  v_mfma_f32_32x32x16_bf16 v[84:99], v[32:35], v[20:23], v[84:99]
  ds_read_b64_tr_b16 v[54:55], v7 offset:20288
  ds_read_b64_tr_b16 v[56:57], v7 offset:19584
  ds_read_b64_tr_b16 v[58:59], v7 offset:20352
  ds_read_b64_tr_b16 v[60:61], v8 offset:30720
  s_waitcnt lgkmcnt(12)
  v_mfma_f32_32x32x16_bf16 v[100:115], v[36:39], v[20:23], v[100:115]
  ds_read_b64_tr_b16 v[62:63], v8 offset:31232
  ds_read_b64_tr_b16 v[64:65], v9 offset:30720
  ds_read_b64_tr_b16 v[66:67], v9 offset:31232
  s_waitcnt lgkmcnt(13)
  v_mfma_f32_32x32x16_bf16 v[116:131], v[20:23], v[40:43], v[116:131]
  s_waitcnt lgkmcnt(11)
  v_mfma_f32_32x32x16_bf16 v[132:147], v[20:23], v[44:47], v[132:147]
  s_and_b32 s42, s37, 1
  s_cmp_lg_u32 s42, 0
  s_cbranch_scc1 p1_slab_1
  s_cmp_lg_u32 s36, 0
  s_cbranch_scc1 p1_slabw_2
  v_mfma_f32_4x4x4_16b_bf16 v[148:151], v[156:157], v[28:29], v[148:151]
  v_mfma_f32_4x4x4_16b_bf16 v[152:155], v[156:157], v[44:45], v[152:155]
  s_nop 0
  v_mfma_f32_4x4x4_16b_bf16 v[148:151], v[156:157], v[30:31], v[148:151]
  v_mfma_f32_4x4x4_16b_bf16 v[152:155], v[156:157], v[46:47], v[152:155]
p1_slabw_2:
  s_cmp_lg_u32 s36, 1
  s_cbranch_scc1 p1_slabw_3
  v_mfma_f32_4x4x4_16b_bf16 v[148:151], v[156:157], v[32:33], v[148:151]
  s_nop 1
  v_mfma_f32_4x4x4_16b_bf16 v[148:151], v[156:157], v[34:35], v[148:151]
p1_slabw_3:
  s_cmp_lg_u32 s36, 2
  s_cbranch_scc1 p1_slabw_4
  v_mfma_f32_4x4x4_16b_bf16 v[148:151], v[156:157], v[36:37], v[148:151]
  s_nop 1
  v_mfma_f32_4x4x4_16b_bf16 v[148:151], v[156:157], v[38:39], v[148:151]
p1_slabw_4:
  s_cmp_lg_u32 s36, 3
  s_cbranch_scc1 p1_slabw_5
  v_mfma_f32_4x4x4_16b_bf16 v[148:151], v[156:157], v[40:41], v[148:151]
  s_nop 1
  v_mfma_f32_4x4x4_16b_bf16 v[148:151], v[156:157], v[42:43], v[148:151]
p1_slabw_5:
p1_slab_1:
  s_waitcnt lgkmcnt(8)
  v_mfma_f32_32x32x16_bf16 v[68:83], v[48:51], v[24:27], v[68:83]
  ds_read_b128 v[20:23], v5
  ds_read_b64_tr_b16 v[28:29], v7 offset:22528
  ds_read_b64_tr_b16 v[30:31], v7 offset:23296
  ds_read_b64_tr_b16 v[32:33], v7 offset:22592
  s_waitcnt lgkmcnt(10)
  v_mfma_f32_32x32x16_bf16 v[84:99], v[52:55], v[24:27], v[84:99]
  ds_read_b64_tr_b16 v[34:35], v7 offset:23360
  ds_read_b64_tr_b16 v[36:37], v7 offset:22656
  ds_read_b64_tr_b16 v[38:39], v7 offset:23424
  ds_read_b64_tr_b16 v[40:41], v8 offset:32768
  s_waitcnt lgkmcnt(12)
  v_mfma_f32_32x32x16_bf16 v[100:115], v[56:59], v[24:27], v[100:115]
  ds_read_b64_tr_b16 v[42:43], v8 offset:33280
  ds_read_b64_tr_b16 v[44:45], v9 offset:32768
  ds_read_b64_tr_b16 v[46:47], v9 offset:33280
  s_waitcnt lgkmcnt(13)
  v_mfma_f32_32x32x16_bf16 v[116:131], v[24:27], v[60:63], v[116:131]
  s_waitcnt lgkmcnt(11)
  v_mfma_f32_32x32x16_bf16 v[132:147], v[24:27], v[64:67], v[132:147]
  s_and_b32 s42, s37, 1
  s_cmp_lg_u32 s42, 0
  s_cbranch_scc1 p1_slab_6
  s_cmp_lg_u32 s36, 0
  s_cbranch_scc1 p1_slabw_7
  v_mfma_f32_4x4x4_16b_bf16 v[148:151], v[156:157], v[48:49], v[148:151]
  v_mfma_f32_4x4x4_16b_bf16 v[152:155], v[156:157], v[64:65], v[152:155]
  s_nop 0
  v_mfma_f32_4x4x4_16b_bf16 v[148:151], v[156:157], v[50:51], v[148:151]
  v_mfma_f32_4x4x4_16b_bf16 v[152:155], v[156:157], v[66:67], v[152:155]
p1_slabw_7:
  s_cmp_lg_u32 s36, 1
  s_cbranch_scc1 p1_slabw_8
  v_mfma_f32_4x4x4_16b_bf16 v[148:151], v[156:157], v[52:53], v[148:151]
  s_nop 1
  v_mfma_f32_4x4x4_16b_bf16 v[148:151], v[156:157], v[54:55], v[148:151]
p1_slabw_8:
  s_cmp_lg_u32 s36, 2
  s_cbranch_scc1 p1_slabw_9
  v_mfma_f32_4x4x4_16b_bf16 v[148:151], v[156:157], v[56:57], v[148:151]
  s_nop 1
  v_mfma_f32_4x4x4_16b_bf16 v[148:151], v[156:157], v[58:59], v[148:151]
p1_slabw_9:
  s_cmp_lg_u32 s36, 3
  s_cbranch_scc1 p1_slabw_10
  v_mfma_f32_4x4x4_16b_bf16 v[148:151], v[156:157], v[60:61], v[148:151]
  s_nop 1
  v_mfma_f32_4x4x4_16b_bf16 v[148:151], v[156:157], v[62:63], v[148:151]
p1_slabw_10:
p1_slab_6:
  s_waitcnt lgkmcnt(8)
  v_mfma_f32_32x32x16_bf16 v[68:83], v[28:31], v[20:23], v[68:83]
  ds_read_b128 v[24:27], v6
  ds_read_b64_tr_b16 v[48:49], v7 offset:25600
  ds_read_b64_tr_b16 v[50:51], v7 offset:26368
  ds_read_b64_tr_b16 v[52:53], v7 offset:25664
  s_waitcnt lgkmcnt(10)
  v_mfma_f32_32x32x16_bf16 v[84:99], v[32:35], v[20:23], v[84:99]
  ds_read_b64_tr_b16 v[54:55], v7 offset:26432
  ds_read_b64_tr_b16 v[56:57], v7 offset:25728
  ds_read_b64_tr_b16 v[58:59], v7 offset:26496
  ds_read_b64_tr_b16 v[60:61], v8 offset:34816
  s_waitcnt lgkmcnt(12)
  v_mfma_f32_32x32x16_bf16 v[100:115], v[36:39], v[20:23], v[100:115]
  ds_read_b64_tr_b16 v[62:63], v8 offset:35328
  ds_read_b64_tr_b16 v[64:65], v9 offset:34816
  ds_read_b64_tr_b16 v[66:67], v9 offset:35328
  s_waitcnt lgkmcnt(13)
  v_mfma_f32_32x32x16_bf16 v[116:131], v[20:23], v[40:43], v[116:131]
  s_waitcnt lgkmcnt(11)
  v_mfma_f32_32x32x16_bf16 v[132:147], v[20:23], v[44:47], v[132:147]
  s_and_b32 s42, s37, 1
  s_cmp_lg_u32 s42, 1
  s_cbranch_scc1 p1_slab_11
  s_cmp_lg_u32 s36, 0
  s_cbranch_scc1 p1_slabw_12
  v_mfma_f32_4x4x4_16b_bf16 v[148:151], v[156:157], v[28:29], v[148:151]
  v_mfma_f32_4x4x4_16b_bf16 v[152:155], v[156:157], v[44:45], v[152:155]
  s_nop 0
  v_mfma_f32_4x4x4_16b_bf16 v[148:151], v[156:157], v[30:31], v[148:151]
  v_mfma_f32_4x4x4_16b_bf16 v[152:155], v[156:157], v[46:47], v[152:155]
p1_slabw_12:
  s_cmp_lg_u32 s36, 1
  s_cbranch_scc1 p1_slabw_13
  v_mfma_f32_4x4x4_16b_bf16 v[148:151], v[156:157], v[32:33], v[148:151]
  s_nop 1
  v_mfma_f32_4x4x4_16b_bf16 v[148:151], v[156:157], v[34:35], v[148:151]
p1_slabw_13:
  s_cmp_lg_u32 s36, 2
  s_cbranch_scc1 p1_slabw_14
  v_mfma_f32_4x4x4_16b_bf16 v[148:151], v[156:157], v[36:37], v[148:151]
  s_nop 1
  v_mfma_f32_4x4x4_16b_bf16 v[148:151], v[156:157], v[38:39], v[148:151]
p1_slabw_14:
  s_cmp_lg_u32 s36, 3
  s_cbranch_scc1 p1_slabw_15
  v_mfma_f32_4x4x4_16b_bf16 v[148:151], v[156:157], v[40:41], v[148:151]
  s_nop 1
  v_mfma_f32_4x4x4_16b_bf16 v[148:151], v[156:157], v[42:43], v[148:151]
p1_slabw_15:
p1_slab_11:
  s_barrier
  s_add_u32 s53, s53, 36864
  s_cmp_eq_u32 s53, 147456
  s_cselect_b32 s52, s56, s57
  s_cselect_b32 s53, 0, s53
  v_add_u32 v3, s52, v3
  v_add_u32 v4, s52, v4
  v_add_u32 v5, s52, v5
  v_add_u32 v6, s52, v6
  v_add_u32 v7, s52, v7
  v_add_u32 v8, s52, v8
  v_add_u32 v9, s52, v9
  s_waitcnt lgkmcnt(8)
  v_mfma_f32_32x32x16_bf16 v[68:83], v[48:51], v[24:27], v[68:83]
  ds_read_b128 v[20:23], v3
  ds_read_b64_tr_b16 v[28:29], v7 offset:16384
  ds_read_b64_tr_b16 v[30:31], v7 offset:17152
  ds_read_b64_tr_b16 v[32:33], v7 offset:16448
  s_waitcnt lgkmcnt(10)
  v_mfma_f32_32x32x16_bf16 v[84:99], v[52:55], v[24:27], v[84:99]
  ds_read_b64_tr_b16 v[34:35], v7 offset:17216
  ds_read_b64_tr_b16 v[36:37], v7 offset:16512
  ds_read_b64_tr_b16 v[38:39], v7 offset:17280
  ds_read_b64_tr_b16 v[40:41], v8 offset:28672
  s_waitcnt lgkmcnt(12)
  v_mfma_f32_32x32x16_bf16 v[100:115], v[56:59], v[24:27], v[100:115]
  ds_read_b64_tr_b16 v[42:43], v8 offset:29184
  ds_read_b64_tr_b16 v[44:45], v9 offset:28672
  ds_read_b64_tr_b16 v[46:47], v9 offset:29184
  s_waitcnt lgkmcnt(13)
  v_mfma_f32_32x32x16_bf16 v[116:131], v[24:27], v[60:63], v[116:131]
  s_waitcnt lgkmcnt(11)
  v_mfma_f32_32x32x16_bf16 v[132:147], v[24:27], v[64:67], v[132:147]
  s_and_b32 s42, s37, 1
  s_cmp_lg_u32 s42, 1
  s_cbranch_scc1 p1_slab_16
  s_cmp_lg_u32 s36, 0
  s_cbranch_scc1 p1_slabw_17
  v_mfma_f32_4x4x4_16b_bf16 v[148:151], v[156:157], v[48:49], v[148:151]
  v_mfma_f32_4x4x4_16b_bf16 v[152:155], v[156:157], v[64:65], v[152:155]
  s_nop 0
  v_mfma_f32_4x4x4_16b_bf16 v[148:151], v[156:157], v[50:51], v[148:151]
  v_mfma_f32_4x4x4_16b_bf16 v[152:155], v[156:157], v[66:67], v[152:155]
p1_slabw_17:
  s_cmp_lg_u32 s36, 1
  s_cbranch_scc1 p1_slabw_18
  v_mfma_f32_4x4x4_16b_bf16 v[148:151], v[156:157], v[52:53], v[148:151]
  s_nop 1
  v_mfma_f32_4x4x4_16b_bf16 v[148:151], v[156:157], v[54:55], v[148:151]
p1_slabw_18:
  s_cmp_lg_u32 s36, 2
  s_cbranch_scc1 p1_slabw_19
  v_mfma_f32_4x4x4_16b_bf16 v[148:151], v[156:157], v[56:57], v[148:151]
  s_nop 1
  v_mfma_f32_4x4x4_16b_bf16 v[148:151], v[156:157], v[58:59], v[148:151]
p1_slabw_19:
  s_cmp_lg_u32 s36, 3
  s_cbranch_scc1 p1_slabw_20
  v_mfma_f32_4x4x4_16b_bf16 v[148:151], v[156:157], v[60:61], v[148:151]
  s_nop 1
  v_mfma_f32_4x4x4_16b_bf16 v[148:151], v[156:157], v[62:63], v[148:151]
p1_slabw_20:
p1_slab_16:
  s_nop 4
  v_mov_b32 v149, v148
  v_mov_b32 v153, v152
  s_nop 1
  v_permlane32_swap_b32 v148, v149
  v_permlane32_swap_b32 v152, v153
  v_add_f32 v148, v148, v149
  v_add_f32 v152, v152, v153
  v_and_b32 v10, 31, v2
  s_lshl_b32 s42, s36, 5
  v_add_u32 v10, s42, v10
  v_lshlrev_b32 v10, 2, v10
  s_lshl_b32 s42, s38, 4
  s_add_u32 s42, s42, s37
  s_mul_i32 s42, s42, 640
  s_mov_b32 exec_hi, 0
  buffer_store_dword v148, v10, s[12:15], s42 offen sc1
  s_cmp_lg_u32 s36, 0
  s_cbranch_scc1 P1_pub4
  buffer_store_dword v152, v10, s[12:15], s42 offen offset:512 sc1
P1_pub4:
  s_mov_b32 exec_hi, -1
  s_waitcnt lgkmcnt(8)
  v_mfma_f32_32x32x16_bf16 v[68:83], v[28:31], v[20:23], v[68:83]
  ds_read_b128 v[24:27], v4
  ds_read_b64_tr_b16 v[48:49], v7 offset:19456
  ds_read_b64_tr_b16 v[50:51], v7 offset:20224
  ds_read_b64_tr_b16 v[52:53], v7 offset:19520
  s_waitcnt lgkmcnt(10)
  v_mfma_f32_32x32x16_bf16 v[84:99], v[32:35], v[20:23], v[84:99]
  ds_read_b64_tr_b16 v[54:55], v7 offset:20288
  ds_read_b64_tr_b16 v[56:57], v7 offset:19584
  ds_read_b64_tr_b16 v[58:59], v7 offset:20352
  ds_read_b64_tr_b16 v[60:61], v8 offset:30720
  s_waitcnt lgkmcnt(12)
  v_mfma_f32_32x32x16_bf16 v[100:115], v[36:39], v[20:23], v[100:115]
  ds_read_b64_tr_b16 v[62:63], v8 offset:31232
  ds_read_b64_tr_b16 v[64:65], v9 offset:30720
  ds_read_b64_tr_b16 v[66:67], v9 offset:31232
  s_waitcnt lgkmcnt(13)
  v_mfma_f32_32x32x16_bf16 v[116:131], v[20:23], v[40:43], v[116:131]
  s_waitcnt lgkmcnt(11)
  v_mfma_f32_32x32x16_bf16 v[132:147], v[20:23], v[44:47], v[132:147]
  s_waitcnt lgkmcnt(8)
  v_mfma_f32_32x32x16_bf16 v[68:83], v[48:51], v[24:27], v[68:83]
  ds_read_b128 v[20:23], v5
  ds_read_b64_tr_b16 v[28:29], v7 offset:22528
  ds_read_b64_tr_b16 v[30:31], v7 offset:23296
  ds_read_b64_tr_b16 v[32:33], v7 offset:22592
  s_waitcnt lgkmcnt(10)
  v_mfma_f32_32x32x16_bf16 v[84:99], v[52:55], v[24:27], v[84:99]
  ds_read_b64_tr_b16 v[34:35], v7 offset:23360
  ds_read_b64_tr_b16 v[36:37], v7 offset:22656
  ds_read_b64_tr_b16 v[38:39], v7 offset:23424
  ds_read_b64_tr_b16 v[40:41], v8 offset:32768
  s_waitcnt lgkmcnt(12)
  v_mfma_f32_32x32x16_bf16 v[100:115], v[56:59], v[24:27], v[100:115]
  ds_read_b64_tr_b16 v[42:43], v8 offset:33280
  ds_read_b64_tr_b16 v[44:45], v9 offset:32768
  ds_read_b64_tr_b16 v[46:47], v9 offset:33280
  s_waitcnt lgkmcnt(13)
  v_mfma_f32_32x32x16_bf16 v[116:131], v[24:27], v[60:63], v[116:131]
  s_waitcnt lgkmcnt(11)
  v_mfma_f32_32x32x16_bf16 v[132:147], v[24:27], v[64:67], v[132:147]
  s_waitcnt lgkmcnt(8)
  v_mfma_f32_32x32x16_bf16 v[68:83], v[28:31], v[20:23], v[68:83]
  ds_read_b128 v[24:27], v6
  ds_read_b64_tr_b16 v[48:49], v7 offset:25600
  ds_read_b64_tr_b16 v[50:51], v7 offset:26368
  ds_read_b64_tr_b16 v[52:53], v7 offset:25664
  s_waitcnt lgkmcnt(10)
  v_mfma_f32_32x32x16_bf16 v[84:99], v[32:35], v[20:23], v[84:99]
  ds_read_b64_tr_b16 v[54:55], v7 offset:26432
  ds_read_b64_tr_b16 v[56:57], v7 offset:25728
  ds_read_b64_tr_b16 v[58:59], v7 offset:26496
  ds_read_b64_tr_b16 v[60:61], v8 offset:34816
  s_waitcnt lgkmcnt(12)
  v_mfma_f32_32x32x16_bf16 v[100:115], v[36:39], v[20:23], v[100:115]
  ds_read_b64_tr_b16 v[62:63], v8 offset:35328
  ds_read_b64_tr_b16 v[64:65], v9 offset:34816
  ds_read_b64_tr_b16 v[66:67], v9 offset:35328
  s_waitcnt lgkmcnt(13)
  v_mfma_f32_32x32x16_bf16 v[116:131], v[20:23], v[40:43], v[116:131]
  s_waitcnt lgkmcnt(11)
  v_mfma_f32_32x32x16_bf16 v[132:147], v[20:23], v[44:47], v[132:147]
  s_barrier
  s_add_u32 s53, s53, 36864
  s_cmp_eq_u32 s53, 147456
  s_cselect_b32 s52, s56, s57
  s_cselect_b32 s53, 0, s53
  v_add_u32 v3, s52, v3
  v_add_u32 v4, s52, v4
  v_add_u32 v5, s52, v5
  v_add_u32 v6, s52, v6
  v_add_u32 v7, s52, v7
  v_add_u32 v8, s52, v8
  v_add_u32 v9, s52, v9
  s_waitcnt lgkmcnt(8)
  v_mfma_f32_32x32x16_bf16 v[68:83], v[48:51], v[24:27], v[68:83]
  ds_read_b128 v[20:23], v3
  ds_read_b64_tr_b16 v[28:29], v7 offset:16384
  ds_read_b64_tr_b16 v[30:31], v7 offset:17152
  ds_read_b64_tr_b16 v[32:33], v7 offset:16448
  s_waitcnt lgkmcnt(10)
  v_mfma_f32_32x32x16_bf16 v[84:99], v[52:55], v[24:27], v[84:99]
  ds_read_b64_tr_b16 v[34:35], v7 offset:17216
  ds_read_b64_tr_b16 v[36:37], v7 offset:16512
  ds_read_b64_tr_b16 v[38:39], v7 offset:17280
  ds_read_b64_tr_b16 v[40:41], v8 offset:28672
  s_waitcnt lgkmcnt(12)
  v_mfma_f32_32x32x16_bf16 v[100:115], v[56:59], v[24:27], v[100:115]
  ds_read_b64_tr_b16 v[42:43], v8 offset:29184
  ds_read_b64_tr_b16 v[44:45], v9 offset:28672
  ds_read_b64_tr_b16 v[46:47], v9 offset:29184
  s_waitcnt lgkmcnt(13)
  v_mfma_f32_32x32x16_bf16 v[116:131], v[24:27], v[60:63], v[116:131]
  s_waitcnt lgkmcnt(11)
  v_mfma_f32_32x32x16_bf16 v[132:147], v[24:27], v[64:67], v[132:147]
  s_waitcnt vmcnt(0)
  s_waitcnt lgkmcnt(8)
  v_mfma_f32_32x32x16_bf16 v[68:83], v[28:31], v[20:23], v[68:83]
  ds_read_b128 v[24:27], v4
  ds_read_b64_tr_b16 v[48:49], v7 offset:19456
  ds_read_b64_tr_b16 v[50:51], v7 offset:20224
  ds_read_b64_tr_b16 v[52:53], v7 offset:19520
  s_waitcnt lgkmcnt(10)
  v_mfma_f32_32x32x16_bf16 v[84:99], v[32:35], v[20:23], v[84:99]
  ds_read_b64_tr_b16 v[54:55], v7 offset:20288
  ds_read_b64_tr_b16 v[56:57], v7 offset:19584
  ds_read_b64_tr_b16 v[58:59], v7 offset:20352
  ds_read_b64_tr_b16 v[60:61], v8 offset:30720
  s_waitcnt lgkmcnt(12)
  v_mfma_f32_32x32x16_bf16 v[100:115], v[36:39], v[20:23], v[100:115]
  ds_read_b64_tr_b16 v[62:63], v8 offset:31232
  ds_read_b64_tr_b16 v[64:65], v9 offset:30720
  ds_read_b64_tr_b16 v[66:67], v9 offset:31232
  s_waitcnt lgkmcnt(13)
  v_mfma_f32_32x32x16_bf16 v[116:131], v[20:23], v[40:43], v[116:131]
  s_waitcnt lgkmcnt(11)
  v_mfma_f32_32x32x16_bf16 v[132:147], v[20:23], v[44:47], v[132:147]
  s_waitcnt lgkmcnt(8)
  v_mfma_f32_32x32x16_bf16 v[68:83], v[48:51], v[24:27], v[68:83]
  ds_read_b128 v[20:23], v5
  ds_read_b64_tr_b16 v[28:29], v7 offset:22528
  ds_read_b64_tr_b16 v[30:31], v7 offset:23296
  ds_read_b64_tr_b16 v[32:33], v7 offset:22592
  s_waitcnt lgkmcnt(10)
  v_mfma_f32_32x32x16_bf16 v[84:99], v[52:55], v[24:27], v[84:99]
  ds_read_b64_tr_b16 v[34:35], v7 offset:23360
  ds_read_b64_tr_b16 v[36:37], v7 offset:22656
  ds_read_b64_tr_b16 v[38:39], v7 offset:23424
  ds_read_b64_tr_b16 v[40:41], v8 offset:32768
  s_waitcnt lgkmcnt(12)
  v_mfma_f32_32x32x16_bf16 v[100:115], v[56:59], v[24:27], v[100:115]
  ds_read_b64_tr_b16 v[42:43], v8 offset:33280
  ds_read_b64_tr_b16 v[44:45], v9 offset:32768
  ds_read_b64_tr_b16 v[46:47], v9 offset:33280
  s_waitcnt lgkmcnt(13)
  v_mfma_f32_32x32x16_bf16 v[116:131], v[24:27], v[60:63], v[116:131]
  s_waitcnt lgkmcnt(11)
  v_mfma_f32_32x32x16_bf16 v[132:147], v[24:27], v[64:67], v[132:147]
  s_waitcnt lgkmcnt(8)
  v_mfma_f32_32x32x16_bf16 v[68:83], v[28:31], v[20:23], v[68:83]
  ds_read_b128 v[24:27], v6
  ds_read_b64_tr_b16 v[48:49], v7 offset:25600
  ds_read_b64_tr_b16 v[50:51], v7 offset:26368
  ds_read_b64_tr_b16 v[52:53], v7 offset:25664
  s_waitcnt lgkmcnt(10)
  v_mfma_f32_32x32x16_bf16 v[84:99], v[32:35], v[20:23], v[84:99]
  ds_read_b64_tr_b16 v[54:55], v7 offset:26432
  ds_read_b64_tr_b16 v[56:57], v7 offset:25728
  ds_read_b64_tr_b16 v[58:59], v7 offset:26496
  ds_read_b64_tr_b16 v[60:61], v8 offset:34816
  s_waitcnt lgkmcnt(12)
  v_mfma_f32_32x32x16_bf16 v[100:115], v[36:39], v[20:23], v[100:115]
  ds_read_b64_tr_b16 v[62:63], v8 offset:35328
  ds_read_b64_tr_b16 v[64:65], v9 offset:34816
  ds_read_b64_tr_b16 v[66:67], v9 offset:35328
  s_waitcnt lgkmcnt(13)
  v_mfma_f32_32x32x16_bf16 v[116:131], v[20:23], v[40:43], v[116:131]
  s_waitcnt lgkmcnt(11)
  v_mfma_f32_32x32x16_bf16 v[132:147], v[20:23], v[44:47], v[132:147]
  s_barrier
  s_add_u32 s53, s53, 36864
  s_cmp_eq_u32 s53, 147456
  s_cselect_b32 s52, s56, s57
  s_cselect_b32 s53, 0, s53
  v_add_u32 v3, s52, v3
  v_add_u32 v4, s52, v4
  v_add_u32 v5, s52, v5
  v_add_u32 v6, s52, v6
  v_add_u32 v7, s52, v7
  v_add_u32 v8, s52, v8
  v_add_u32 v9, s52, v9
  s_waitcnt lgkmcnt(8)
  v_mfma_f32_32x32x16_bf16 v[68:83], v[48:51], v[24:27], v[68:83]
  ds_read_b128 v[20:23], v3
  ds_read_b64_tr_b16 v[28:29], v7 offset:16384
  ds_read_b64_tr_b16 v[30:31], v7 offset:17152
  ds_read_b64_tr_b16 v[32:33], v7 offset:16448
  s_waitcnt lgkmcnt(10)
  v_mfma_f32_32x32x16_bf16 v[84:99], v[52:55], v[24:27], v[84:99]
  ds_read_b64_tr_b16 v[34:35], v7 offset:17216
  ds_read_b64_tr_b16 v[36:37], v7 offset:16512
  ds_read_b64_tr_b16 v[38:39], v7 offset:17280
  ds_read_b64_tr_b16 v[40:41], v8 offset:28672
  s_waitcnt lgkmcnt(12)
  v_mfma_f32_32x32x16_bf16 v[100:115], v[56:59], v[24:27], v[100:115]
  ds_read_b64_tr_b16 v[42:43], v8 offset:29184
  ds_read_b64_tr_b16 v[44:45], v9 offset:28672
  ds_read_b64_tr_b16 v[46:47], v9 offset:29184
  s_waitcnt lgkmcnt(13)
  v_mfma_f32_32x32x16_bf16 v[116:131], v[24:27], v[60:63], v[116:131]
  s_waitcnt lgkmcnt(11)
  v_mfma_f32_32x32x16_bf16 v[132:147], v[24:27], v[64:67], v[132:147]
  s_cmp_lg_u32 s36, 0
  s_cbranch_scc1 P1_noflag
  s_lshl_b32 s42, s45, 2
  s_add_u32 s42, s42, 98304
  s_waitcnt lgkmcnt(0)
  s_add_u32 s43, s3, 1
  v_mov_b32 v168, s43
  v_mov_b32 v169, 0
  s_mov_b64 exec, 1
  buffer_store_dword v168, v169, s[92:95], s42 offen sc1
  s_mov_b64 exec, -1
P1_noflag:
  s_waitcnt lgkmcnt(8)
  v_mfma_f32_32x32x16_bf16 v[68:83], v[28:31], v[20:23], v[68:83]
  ds_read_b128 v[24:27], v4
  ds_read_b64_tr_b16 v[48:49], v7 offset:19456
  ds_read_b64_tr_b16 v[50:51], v7 offset:20224
  ds_read_b64_tr_b16 v[52:53], v7 offset:19520
  s_waitcnt lgkmcnt(10)
  v_mfma_f32_32x32x16_bf16 v[84:99], v[32:35], v[20:23], v[84:99]
  ds_read_b64_tr_b16 v[54:55], v7 offset:20288
  ds_read_b64_tr_b16 v[56:57], v7 offset:19584
  ds_read_b64_tr_b16 v[58:59], v7 offset:20352
  ds_read_b64_tr_b16 v[60:61], v8 offset:30720
  s_waitcnt lgkmcnt(12)
  v_mfma_f32_32x32x16_bf16 v[100:115], v[36:39], v[20:23], v[100:115]
  ds_read_b64_tr_b16 v[62:63], v8 offset:31232
  ds_read_b64_tr_b16 v[64:65], v9 offset:30720
  ds_read_b64_tr_b16 v[66:67], v9 offset:31232
  s_waitcnt lgkmcnt(13)
  v_mfma_f32_32x32x16_bf16 v[116:131], v[20:23], v[40:43], v[116:131]
  s_waitcnt lgkmcnt(11)
  v_mfma_f32_32x32x16_bf16 v[132:147], v[20:23], v[44:47], v[132:147]
  s_waitcnt lgkmcnt(8)
  v_mfma_f32_32x32x16_bf16 v[68:83], v[48:51], v[24:27], v[68:83]
  ds_read_b128 v[20:23], v5
  ds_read_b64_tr_b16 v[28:29], v7 offset:22528
  ds_read_b64_tr_b16 v[30:31], v7 offset:23296
  ds_read_b64_tr_b16 v[32:33], v7 offset:22592
  s_waitcnt lgkmcnt(10)
  v_mfma_f32_32x32x16_bf16 v[84:99], v[52:55], v[24:27], v[84:99]
  ds_read_b64_tr_b16 v[34:35], v7 offset:23360
  ds_read_b64_tr_b16 v[36:37], v7 offset:22656
  ds_read_b64_tr_b16 v[38:39], v7 offset:23424
  ds_read_b64_tr_b16 v[40:41], v8 offset:32768
  s_waitcnt lgkmcnt(12)
  v_mfma_f32_32x32x16_bf16 v[100:115], v[56:59], v[24:27], v[100:115]
  ds_read_b64_tr_b16 v[42:43], v8 offset:33280
  ds_read_b64_tr_b16 v[44:45], v9 offset:32768
  ds_read_b64_tr_b16 v[46:47], v9 offset:33280
  s_waitcnt lgkmcnt(13)
  v_mfma_f32_32x32x16_bf16 v[116:131], v[24:27], v[60:63], v[116:131]
  s_waitcnt lgkmcnt(11)
  v_mfma_f32_32x32x16_bf16 v[132:147], v[24:27], v[64:67], v[132:147]
  s_waitcnt lgkmcnt(8)
  v_mfma_f32_32x32x16_bf16 v[68:83], v[28:31], v[20:23], v[68:83]
  ds_read_b128 v[24:27], v6
  ds_read_b64_tr_b16 v[48:49], v7 offset:25600
  ds_read_b64_tr_b16 v[50:51], v7 offset:26368
  ds_read_b64_tr_b16 v[52:53], v7 offset:25664
  s_waitcnt lgkmcnt(10)
  v_mfma_f32_32x32x16_bf16 v[84:99], v[32:35], v[20:23], v[84:99]
  ds_read_b64_tr_b16 v[54:55], v7 offset:26432
  ds_read_b64_tr_b16 v[56:57], v7 offset:25728
  ds_read_b64_tr_b16 v[58:59], v7 offset:26496
  ds_read_b64_tr_b16 v[60:61], v8 offset:34816
  s_waitcnt lgkmcnt(12)
  v_mfma_f32_32x32x16_bf16 v[100:115], v[36:39], v[20:23], v[100:115]
  ds_read_b64_tr_b16 v[62:63], v8 offset:35328
  ds_read_b64_tr_b16 v[64:65], v9 offset:34816
  ds_read_b64_tr_b16 v[66:67], v9 offset:35328
  s_waitcnt lgkmcnt(13)
  v_mfma_f32_32x32x16_bf16 v[116:131], v[20:23], v[40:43], v[116:131]
  s_waitcnt lgkmcnt(11)
  v_mfma_f32_32x32x16_bf16 v[132:147], v[20:23], v[44:47], v[132:147]
  s_barrier
  s_add_u32 s53, s53, 36864
  s_cmp_eq_u32 s53, 147456
  s_cselect_b32 s52, s56, s57
  s_cselect_b32 s53, 0, s53
  v_add_u32 v3, s52, v3
  v_add_u32 v4, s52, v4
  v_add_u32 v5, s52, v5
  v_add_u32 v6, s52, v6
  v_add_u32 v7, s52, v7
  v_add_u32 v8, s52, v8
  v_add_u32 v9, s52, v9
  s_waitcnt lgkmcnt(8)
  v_mfma_f32_32x32x16_bf16 v[68:83], v[48:51], v[24:27], v[68:83]
  ds_read_b128 v[20:23], v3
  ds_read_b64_tr_b16 v[28:29], v7 offset:16384
  ds_read_b64_tr_b16 v[30:31], v7 offset:17152
  ds_read_b64_tr_b16 v[32:33], v7 offset:16448
  s_waitcnt lgkmcnt(10)
  v_mfma_f32_32x32x16_bf16 v[84:99], v[52:55], v[24:27], v[84:99]
  ds_read_b64_tr_b16 v[34:35], v7 offset:17216
  ds_read_b64_tr_b16 v[36:37], v7 offset:16512
  ds_read_b64_tr_b16 v[38:39], v7 offset:17280
  ds_read_b64_tr_b16 v[40:41], v8 offset:28672
  s_waitcnt lgkmcnt(12)
  v_mfma_f32_32x32x16_bf16 v[100:115], v[56:59], v[24:27], v[100:115]
  ds_read_b64_tr_b16 v[42:43], v8 offset:29184
  ds_read_b64_tr_b16 v[44:45], v9 offset:28672
  ds_read_b64_tr_b16 v[46:47], v9 offset:29184
  s_waitcnt lgkmcnt(13)
  v_mfma_f32_32x32x16_bf16 v[116:131], v[24:27], v[60:63], v[116:131]
  s_waitcnt lgkmcnt(11)
  v_mfma_f32_32x32x16_bf16 v[132:147], v[24:27], v[64:67], v[132:147]
  s_waitcnt lgkmcnt(8)
  v_mfma_f32_32x32x16_bf16 v[68:83], v[28:31], v[20:23], v[68:83]
  ds_read_b128 v[24:27], v4
  ds_read_b64_tr_b16 v[48:49], v7 offset:19456
  ds_read_b64_tr_b16 v[50:51], v7 offset:20224
  ds_read_b64_tr_b16 v[52:53], v7 offset:19520
  s_waitcnt lgkmcnt(10)
  v_mfma_f32_32x32x16_bf16 v[84:99], v[32:35], v[20:23], v[84:99]
  ds_read_b64_tr_b16 v[54:55], v7 offset:20288
  ds_read_b64_tr_b16 v[56:57], v7 offset:19584
  ds_read_b64_tr_b16 v[58:59], v7 offset:20352
  ds_read_b64_tr_b16 v[60:61], v8 offset:30720
  s_waitcnt lgkmcnt(12)
  v_mfma_f32_32x32x16_bf16 v[100:115], v[36:39], v[20:23], v[100:115]
  ds_read_b64_tr_b16 v[62:63], v8 offset:31232
  ds_read_b64_tr_b16 v[64:65], v9 offset:30720
  ds_read_b64_tr_b16 v[66:67], v9 offset:31232
  s_waitcnt lgkmcnt(13)
  v_mfma_f32_32x32x16_bf16 v[116:131], v[20:23], v[40:43], v[116:131]
  s_waitcnt lgkmcnt(11)
  v_mfma_f32_32x32x16_bf16 v[132:147], v[20:23], v[44:47], v[132:147]
  s_waitcnt lgkmcnt(8)
  v_mfma_f32_32x32x16_bf16 v[68:83], v[48:51], v[24:27], v[68:83]
  ds_read_b128 v[20:23], v5
  ds_read_b64_tr_b16 v[28:29], v7 offset:22528
  ds_read_b64_tr_b16 v[30:31], v7 offset:23296
  ds_read_b64_tr_b16 v[32:33], v7 offset:22592
  s_waitcnt lgkmcnt(10)
  v_mfma_f32_32x32x16_bf16 v[84:99], v[52:55], v[24:27], v[84:99]
  ds_read_b64_tr_b16 v[34:35], v7 offset:23360
  ds_read_b64_tr_b16 v[36:37], v7 offset:22656
  ds_read_b64_tr_b16 v[38:39], v7 offset:23424
  ds_read_b64_tr_b16 v[40:41], v8 offset:32768
  s_waitcnt lgkmcnt(12)
  v_mfma_f32_32x32x16_bf16 v[100:115], v[56:59], v[24:27], v[100:115]
  ds_read_b64_tr_b16 v[42:43], v8 offset:33280
  ds_read_b64_tr_b16 v[44:45], v9 offset:32768
  ds_read_b64_tr_b16 v[46:47], v9 offset:33280
  s_waitcnt lgkmcnt(13)
  v_mfma_f32_32x32x16_bf16 v[116:131], v[24:27], v[60:63], v[116:131]
  s_waitcnt lgkmcnt(11)
  v_mfma_f32_32x32x16_bf16 v[132:147], v[24:27], v[64:67], v[132:147]
  s_waitcnt lgkmcnt(8)
  v_mfma_f32_32x32x16_bf16 v[68:83], v[28:31], v[20:23], v[68:83]
  ds_read_b128 v[24:27], v6
  ds_read_b64_tr_b16 v[48:49], v7 offset:25600
  ds_read_b64_tr_b16 v[50:51], v7 offset:26368
  ds_read_b64_tr_b16 v[52:53], v7 offset:25664
  s_waitcnt lgkmcnt(10)
  v_mfma_f32_32x32x16_bf16 v[84:99], v[32:35], v[20:23], v[84:99]
  ds_read_b64_tr_b16 v[54:55], v7 offset:26432
  ds_read_b64_tr_b16 v[56:57], v7 offset:25728
  ds_read_b64_tr_b16 v[58:59], v7 offset:26496
  ds_read_b64_tr_b16 v[60:61], v8 offset:34816
  s_waitcnt lgkmcnt(12)
  v_mfma_f32_32x32x16_bf16 v[100:115], v[36:39], v[20:23], v[100:115]
  ds_read_b64_tr_b16 v[62:63], v8 offset:35328
  ds_read_b64_tr_b16 v[64:65], v9 offset:34816
  ds_read_b64_tr_b16 v[66:67], v9 offset:35328
  s_waitcnt lgkmcnt(13)
  v_mfma_f32_32x32x16_bf16 v[116:131], v[20:23], v[40:43], v[116:131]
  s_waitcnt lgkmcnt(11)
  v_mfma_f32_32x32x16_bf16 v[132:147], v[20:23], v[44:47], v[132:147]
  s_barrier
  s_add_u32 s53, s53, 36864
  s_cmp_eq_u32 s53, 147456
  s_cselect_b32 s52, s56, s57
  s_cselect_b32 s53, 0, s53
  v_add_u32 v3, s52, v3
  v_add_u32 v4, s52, v4
  v_add_u32 v5, s52, v5
  v_add_u32 v6, s52, v6
  v_add_u32 v7, s52, v7
  v_add_u32 v8, s52, v8
  v_add_u32 v9, s52, v9
  s_waitcnt lgkmcnt(8)
  v_mfma_f32_32x32x16_bf16 v[68:83], v[48:51], v[24:27], v[68:83]
  ds_read_b128 v[20:23], v3
  ds_read_b64_tr_b16 v[28:29], v7 offset:16384
  ds_read_b64_tr_b16 v[30:31], v7 offset:17152
  ds_read_b64_tr_b16 v[32:33], v7 offset:16448
  s_waitcnt lgkmcnt(10)
  v_mfma_f32_32x32x16_bf16 v[84:99], v[52:55], v[24:27], v[84:99]
  ds_read_b64_tr_b16 v[34:35], v7 offset:17216
  ds_read_b64_tr_b16 v[36:37], v7 offset:16512
  ds_read_b64_tr_b16 v[38:39], v7 offset:17280
  ds_read_b64_tr_b16 v[40:41], v8 offset:28672
  s_waitcnt lgkmcnt(12)
  v_mfma_f32_32x32x16_bf16 v[100:115], v[56:59], v[24:27], v[100:115]
  ds_read_b64_tr_b16 v[42:43], v8 offset:29184
  ds_read_b64_tr_b16 v[44:45], v9 offset:28672
  ds_read_b64_tr_b16 v[46:47], v9 offset:29184
  s_waitcnt lgkmcnt(13)
  v_mfma_f32_32x32x16_bf16 v[116:131], v[24:27], v[60:63], v[116:131]
  s_waitcnt lgkmcnt(11)
  v_mfma_f32_32x32x16_bf16 v[132:147], v[24:27], v[64:67], v[132:147]
  v_and_b32 v170, 15, v2
  s_lshl_b32 s42, s37, 4
  v_add_u32 v171, s42, v170
  v_lshlrev_b32 v172, 4, v170
  v_add_u32 v172, s38, v172
  v_cmp_gt_u32 vcc, 16, v2
  s_nop 1
  v_cndmask_b32 v171, v172, v171, vcc
  v_lshlrev_b32 v171, 2, v171
  s_mov_b32 s46, 98304
  buffer_load_dword v170, v171, s[92:95], s46 offen sc1
  s_waitcnt lgkmcnt(8)
  v_mfma_f32_32x32x16_bf16 v[68:83], v[28:31], v[20:23], v[68:83]
  ds_read_b128 v[24:27], v4
  ds_read_b64_tr_b16 v[48:49], v7 offset:19456
  ds_read_b64_tr_b16 v[50:51], v7 offset:20224
  ds_read_b64_tr_b16 v[52:53], v7 offset:19520
  s_waitcnt lgkmcnt(10)
  v_mfma_f32_32x32x16_bf16 v[84:99], v[32:35], v[20:23], v[84:99]
  ds_read_b64_tr_b16 v[54:55], v7 offset:20288
  ds_read_b64_tr_b16 v[56:57], v7 offset:19584
  ds_read_b64_tr_b16 v[58:59], v7 offset:20352
  ds_read_b64_tr_b16 v[60:61], v8 offset:30720
  s_waitcnt lgkmcnt(12)
  v_mfma_f32_32x32x16_bf16 v[100:115], v[36:39], v[20:23], v[100:115]
  ds_read_b64_tr_b16 v[62:63], v8 offset:31232
  ds_read_b64_tr_b16 v[64:65], v9 offset:30720
  ds_read_b64_tr_b16 v[66:67], v9 offset:31232
  s_waitcnt lgkmcnt(13)
  v_mfma_f32_32x32x16_bf16 v[116:131], v[20:23], v[40:43], v[116:131]
  s_waitcnt lgkmcnt(11)
  v_mfma_f32_32x32x16_bf16 v[132:147], v[20:23], v[44:47], v[132:147]
  s_waitcnt lgkmcnt(8)
  v_mfma_f32_32x32x16_bf16 v[68:83], v[48:51], v[24:27], v[68:83]
  ds_read_b128 v[20:23], v5
  ds_read_b64_tr_b16 v[28:29], v7 offset:22528
  ds_read_b64_tr_b16 v[30:31], v7 offset:23296
  ds_read_b64_tr_b16 v[32:33], v7 offset:22592
  s_waitcnt lgkmcnt(10)
  v_mfma_f32_32x32x16_bf16 v[84:99], v[52:55], v[24:27], v[84:99]
  ds_read_b64_tr_b16 v[34:35], v7 offset:23360
  ds_read_b64_tr_b16 v[36:37], v7 offset:22656
  ds_read_b64_tr_b16 v[38:39], v7 offset:23424
  ds_read_b64_tr_b16 v[40:41], v8 offset:32768
  s_waitcnt lgkmcnt(12)
  v_mfma_f32_32x32x16_bf16 v[100:115], v[56:59], v[24:27], v[100:115]
  ds_read_b64_tr_b16 v[42:43], v8 offset:33280
  ds_read_b64_tr_b16 v[44:45], v9 offset:32768
  ds_read_b64_tr_b16 v[46:47], v9 offset:33280
  s_waitcnt lgkmcnt(13)
  v_mfma_f32_32x32x16_bf16 v[116:131], v[24:27], v[60:63], v[116:131]
  s_waitcnt lgkmcnt(11)
  v_mfma_f32_32x32x16_bf16 v[132:147], v[24:27], v[64:67], v[132:147]
  s_waitcnt lgkmcnt(8)
  v_mfma_f32_32x32x16_bf16 v[68:83], v[28:31], v[20:23], v[68:83]
  ds_read_b128 v[24:27], v6
  ds_read_b64_tr_b16 v[48:49], v7 offset:25600
  ds_read_b64_tr_b16 v[50:51], v7 offset:26368
  ds_read_b64_tr_b16 v[52:53], v7 offset:25664
  s_waitcnt lgkmcnt(10)
  v_mfma_f32_32x32x16_bf16 v[84:99], v[32:35], v[20:23], v[84:99]
  ds_read_b64_tr_b16 v[54:55], v7 offset:26432
  ds_read_b64_tr_b16 v[56:57], v7 offset:25728
  ds_read_b64_tr_b16 v[58:59], v7 offset:26496
  ds_read_b64_tr_b16 v[60:61], v8 offset:34816
  s_waitcnt lgkmcnt(12)
  v_mfma_f32_32x32x16_bf16 v[100:115], v[36:39], v[20:23], v[100:115]
  ds_read_b64_tr_b16 v[62:63], v8 offset:35328
  ds_read_b64_tr_b16 v[64:65], v9 offset:34816
  ds_read_b64_tr_b16 v[66:67], v9 offset:35328
  s_waitcnt lgkmcnt(13)
  v_mfma_f32_32x32x16_bf16 v[116:131], v[20:23], v[40:43], v[116:131]
  s_waitcnt lgkmcnt(11)
  v_mfma_f32_32x32x16_bf16 v[132:147], v[20:23], v[44:47], v[132:147]
  s_barrier
  s_add_u32 s53, s53, 36864
  s_cmp_eq_u32 s53, 147456
  s_cselect_b32 s52, s56, s57
  s_cselect_b32 s53, 0, s53
  v_add_u32 v3, s52, v3
  v_add_u32 v4, s52, v4
  v_add_u32 v5, s52, v5
  v_add_u32 v6, s52, v6
  v_add_u32 v7, s52, v7
  v_add_u32 v8, s52, v8
  v_add_u32 v9, s52, v9
  s_waitcnt lgkmcnt(8)
  v_mfma_f32_32x32x16_bf16 v[68:83], v[48:51], v[24:27], v[68:83]
  ds_read_b128 v[20:23], v3
  ds_read_b64_tr_b16 v[28:29], v7 offset:16384
  ds_read_b64_tr_b16 v[30:31], v7 offset:17152
  ds_read_b64_tr_b16 v[32:33], v7 offset:16448
  s_waitcnt lgkmcnt(10)
  v_mfma_f32_32x32x16_bf16 v[84:99], v[52:55], v[24:27], v[84:99]
  ds_read_b64_tr_b16 v[34:35], v7 offset:17216
  ds_read_b64_tr_b16 v[36:37], v7 offset:16512
  ds_read_b64_tr_b16 v[38:39], v7 offset:17280
  ds_read_b64_tr_b16 v[40:41], v8 offset:28672
  s_waitcnt lgkmcnt(12)
  v_mfma_f32_32x32x16_bf16 v[100:115], v[56:59], v[24:27], v[100:115]
  ds_read_b64_tr_b16 v[42:43], v8 offset:29184
  ds_read_b64_tr_b16 v[44:45], v9 offset:28672
  ds_read_b64_tr_b16 v[46:47], v9 offset:29184
  s_waitcnt lgkmcnt(13)
  v_mfma_f32_32x32x16_bf16 v[116:131], v[24:27], v[60:63], v[116:131]
  s_waitcnt lgkmcnt(11)
  v_mfma_f32_32x32x16_bf16 v[132:147], v[24:27], v[64:67], v[132:147]
  s_add_u32 s43, s3, 1
  s_mov_b32 s44, 0x200000
P1_chk:
  s_waitcnt vmcnt(0)
  v_cmp_ne_u32 vcc, s43, v170
  s_sub_u32 s44, s44, 1
  s_cmp_eq_u32 s44, 0
  s_cbranch_scc1 P1_chkd
  s_nop 1
  s_cbranch_vccz P1_chkd
  buffer_load_dword v170, v171, s[92:95], s46 offen sc1
  s_branch P1_chk
P1_chkd:
  v_and_b32 v168, 31, v2
  s_lshl_b32 s42, s36, 5
  v_add_u32 v168, s42, v168
  s_lshl_b32 s43, s37, 7
  v_add_u32 v169, s43, v168
  v_lshlrev_b32 v169, 3, v169
  buffer_load_dwordx2 v[150:151], v169, s[8:11], 0 offen sc1
  v_lshrrev_b32 v169, 5, v2
  v_mul_u32_u24 v169, 5120, v169
  v_lshl_add_u32 v169, v168, 2, v169
  s_mul_i32 s42, s38, 10240
  s_add_u32 s43, s42, 0
  buffer_load_dword v172, v169, s[12:15], s43 offen sc1
  s_add_u32 s43, s42, 640
  buffer_load_dword v173, v169, s[12:15], s43 offen sc1
  s_add_u32 s43, s42, 1280
  buffer_load_dword v174, v169, s[12:15], s43 offen sc1
  s_add_u32 s43, s42, 1920
  buffer_load_dword v175, v169, s[12:15], s43 offen sc1
  s_add_u32 s43, s42, 2560
  buffer_load_dword v176, v169, s[12:15], s43 offen sc1
  s_add_u32 s43, s42, 3200
  buffer_load_dword v177, v169, s[12:15], s43 offen sc1
  s_add_u32 s43, s42, 3840
  buffer_load_dword v178, v169, s[12:15], s43 offen sc1
  s_add_u32 s43, s42, 4480
  buffer_load_dword v179, v169, s[12:15], s43 offen sc1
  v_and_b32 v170, 31, v2
  v_lshlrev_b32 v170, 2, v170
  v_lshrrev_b32 v171, 5, v2
  v_mul_u32_u24 v171, 1280, v171
  v_add_u32 v170, v170, v171
  s_mul_i32 s43, s36, 2560
  s_add_u32 s43, s43, s42
  s_add_u32 s43, s43, 512
  buffer_load_dword v180, v170, s[12:15], s43 offen sc1
  buffer_load_dword v181, v170, s[12:15], s43 offen offset:640 sc1
  s_waitcnt lgkmcnt(8)
  v_mfma_f32_32x32x16_bf16 v[68:83], v[28:31], v[20:23], v[68:83]
  ds_read_b128 v[24:27], v4
  ds_read_b64_tr_b16 v[48:49], v7 offset:19456
  ds_read_b64_tr_b16 v[50:51], v7 offset:20224
  ds_read_b64_tr_b16 v[52:53], v7 offset:19520
  s_waitcnt lgkmcnt(10)
  v_mfma_f32_32x32x16_bf16 v[84:99], v[32:35], v[20:23], v[84:99]
  ds_read_b64_tr_b16 v[54:55], v7 offset:20288
  ds_read_b64_tr_b16 v[56:57], v7 offset:19584
  ds_read_b64_tr_b16 v[58:59], v7 offset:20352
  ds_read_b64_tr_b16 v[60:61], v8 offset:30720
  s_waitcnt lgkmcnt(12)
  v_mfma_f32_32x32x16_bf16 v[100:115], v[36:39], v[20:23], v[100:115]
  ds_read_b64_tr_b16 v[62:63], v8 offset:31232
  ds_read_b64_tr_b16 v[64:65], v9 offset:30720
  ds_read_b64_tr_b16 v[66:67], v9 offset:31232
  s_waitcnt lgkmcnt(13)
  v_mfma_f32_32x32x16_bf16 v[116:131], v[20:23], v[40:43], v[116:131]
  s_waitcnt lgkmcnt(11)
  v_mfma_f32_32x32x16_bf16 v[132:147], v[20:23], v[44:47], v[132:147]
  s_waitcnt lgkmcnt(8)
  v_mfma_f32_32x32x16_bf16 v[68:83], v[48:51], v[24:27], v[68:83]
  ds_read_b128 v[20:23], v5
  ds_read_b64_tr_b16 v[28:29], v7 offset:22528
  ds_read_b64_tr_b16 v[30:31], v7 offset:23296
  ds_read_b64_tr_b16 v[32:33], v7 offset:22592
  s_waitcnt lgkmcnt(10)
  v_mfma_f32_32x32x16_bf16 v[84:99], v[52:55], v[24:27], v[84:99]
  ds_read_b64_tr_b16 v[34:35], v7 offset:23360
  ds_read_b64_tr_b16 v[36:37], v7 offset:22656
  ds_read_b64_tr_b16 v[38:39], v7 offset:23424
  ds_read_b64_tr_b16 v[40:41], v8 offset:32768
  s_waitcnt lgkmcnt(12)
  v_mfma_f32_32x32x16_bf16 v[100:115], v[56:59], v[24:27], v[100:115]
  ds_read_b64_tr_b16 v[42:43], v8 offset:33280
  ds_read_b64_tr_b16 v[44:45], v9 offset:32768
  ds_read_b64_tr_b16 v[46:47], v9 offset:33280
  s_waitcnt lgkmcnt(13)
  v_mfma_f32_32x32x16_bf16 v[116:131], v[24:27], v[60:63], v[116:131]
  s_waitcnt lgkmcnt(11)
  v_mfma_f32_32x32x16_bf16 v[132:147], v[24:27], v[64:67], v[132:147]
  s_waitcnt lgkmcnt(8)
  v_mfma_f32_32x32x16_bf16 v[68:83], v[28:31], v[20:23], v[68:83]
  ds_read_b128 v[24:27], v6
  ds_read_b64_tr_b16 v[48:49], v7 offset:25600
  ds_read_b64_tr_b16 v[50:51], v7 offset:26368
  ds_read_b64_tr_b16 v[52:53], v7 offset:25664
  s_waitcnt lgkmcnt(10)
  v_mfma_f32_32x32x16_bf16 v[84:99], v[32:35], v[20:23], v[84:99]
  ds_read_b64_tr_b16 v[54:55], v7 offset:26432
  ds_read_b64_tr_b16 v[56:57], v7 offset:25728
  ds_read_b64_tr_b16 v[58:59], v7 offset:26496
  ds_read_b64_tr_b16 v[60:61], v8 offset:34816
  s_waitcnt lgkmcnt(12)
  v_mfma_f32_32x32x16_bf16 v[100:115], v[36:39], v[20:23], v[100:115]
  ds_read_b64_tr_b16 v[62:63], v8 offset:35328
  ds_read_b64_tr_b16 v[64:65], v9 offset:34816
  ds_read_b64_tr_b16 v[66:67], v9 offset:35328
  s_waitcnt lgkmcnt(13)
  v_mfma_f32_32x32x16_bf16 v[116:131], v[20:23], v[40:43], v[116:131]
  s_waitcnt lgkmcnt(11)
  v_mfma_f32_32x32x16_bf16 v[132:147], v[20:23], v[44:47], v[132:147]
  s_barrier
  s_add_u32 s53, s53, 36864
  s_cmp_eq_u32 s53, 147456
  s_cselect_b32 s52, s56, s57
  s_cselect_b32 s53, 0, s53
  v_add_u32 v3, s52, v3
  v_add_u32 v4, s52, v4
  v_add_u32 v5, s52, v5
  v_add_u32 v6, s52, v6
  v_add_u32 v7, s52, v7
  v_add_u32 v8, s52, v8
  v_add_u32 v9, s52, v9
  s_waitcnt lgkmcnt(8)
  v_mfma_f32_32x32x16_bf16 v[68:83], v[48:51], v[24:27], v[68:83]
  ds_read_b128 v[20:23], v3
  ds_read_b64_tr_b16 v[28:29], v7 offset:16384
  ds_read_b64_tr_b16 v[30:31], v7 offset:17152
  ds_read_b64_tr_b16 v[32:33], v7 offset:16448
  s_waitcnt lgkmcnt(10)
  v_mfma_f32_32x32x16_bf16 v[84:99], v[52:55], v[24:27], v[84:99]
  ds_read_b64_tr_b16 v[34:35], v7 offset:17216
  ds_read_b64_tr_b16 v[36:37], v7 offset:16512
  ds_read_b64_tr_b16 v[38:39], v7 offset:17280
  ds_read_b64_tr_b16 v[40:41], v8 offset:28672
  s_waitcnt lgkmcnt(12)
  v_mfma_f32_32x32x16_bf16 v[100:115], v[56:59], v[24:27], v[100:115]
  ds_read_b64_tr_b16 v[42:43], v8 offset:29184
  ds_read_b64_tr_b16 v[44:45], v9 offset:28672
  ds_read_b64_tr_b16 v[46:47], v9 offset:29184
  s_waitcnt lgkmcnt(13)
  v_mfma_f32_32x32x16_bf16 v[116:131], v[24:27], v[60:63], v[116:131]
  s_waitcnt lgkmcnt(11)
  v_mfma_f32_32x32x16_bf16 v[132:147], v[24:27], v[64:67], v[132:147]
  s_waitcnt lgkmcnt(8)
  v_mfma_f32_32x32x16_bf16 v[68:83], v[28:31], v[20:23], v[68:83]
  ds_read_b128 v[24:27], v4
  ds_read_b64_tr_b16 v[48:49], v7 offset:19456
  ds_read_b64_tr_b16 v[50:51], v7 offset:20224
  ds_read_b64_tr_b16 v[52:53], v7 offset:19520
  s_waitcnt lgkmcnt(10)
  v_mfma_f32_32x32x16_bf16 v[84:99], v[32:35], v[20:23], v[84:99]
  ds_read_b64_tr_b16 v[54:55], v7 offset:20288
  ds_read_b64_tr_b16 v[56:57], v7 offset:19584
  ds_read_b64_tr_b16 v[58:59], v7 offset:20352
  ds_read_b64_tr_b16 v[60:61], v8 offset:30720
  s_waitcnt lgkmcnt(12)
  v_mfma_f32_32x32x16_bf16 v[100:115], v[36:39], v[20:23], v[100:115]
  ds_read_b64_tr_b16 v[62:63], v8 offset:31232
  ds_read_b64_tr_b16 v[64:65], v9 offset:30720
  ds_read_b64_tr_b16 v[66:67], v9 offset:31232
  s_waitcnt lgkmcnt(13)
  v_mfma_f32_32x32x16_bf16 v[116:131], v[20:23], v[40:43], v[116:131]
  s_waitcnt lgkmcnt(11)
  v_mfma_f32_32x32x16_bf16 v[132:147], v[20:23], v[44:47], v[132:147]
  s_waitcnt lgkmcnt(8)
  v_mfma_f32_32x32x16_bf16 v[68:83], v[48:51], v[24:27], v[68:83]
  ds_read_b128 v[20:23], v5
  ds_read_b64_tr_b16 v[28:29], v7 offset:22528
  ds_read_b64_tr_b16 v[30:31], v7 offset:23296
  ds_read_b64_tr_b16 v[32:33], v7 offset:22592
  s_waitcnt lgkmcnt(10)
  v_mfma_f32_32x32x16_bf16 v[84:99], v[52:55], v[24:27], v[84:99]
  ds_read_b64_tr_b16 v[34:35], v7 offset:23360
  ds_read_b64_tr_b16 v[36:37], v7 offset:22656
  ds_read_b64_tr_b16 v[38:39], v7 offset:23424
  ds_read_b64_tr_b16 v[40:41], v8 offset:32768
  s_waitcnt lgkmcnt(12)
  v_mfma_f32_32x32x16_bf16 v[100:115], v[56:59], v[24:27], v[100:115]
  ds_read_b64_tr_b16 v[42:43], v8 offset:33280
  ds_read_b64_tr_b16 v[44:45], v9 offset:32768
  ds_read_b64_tr_b16 v[46:47], v9 offset:33280
  s_waitcnt lgkmcnt(13)
  v_mfma_f32_32x32x16_bf16 v[116:131], v[24:27], v[60:63], v[116:131]
  s_waitcnt lgkmcnt(11)
  v_mfma_f32_32x32x16_bf16 v[132:147], v[24:27], v[64:67], v[132:147]
  s_waitcnt lgkmcnt(8)
  v_mfma_f32_32x32x16_bf16 v[68:83], v[28:31], v[20:23], v[68:83]
  ds_read_b128 v[24:27], v6
  ds_read_b64_tr_b16 v[48:49], v7 offset:25600
  ds_read_b64_tr_b16 v[50:51], v7 offset:26368
  ds_read_b64_tr_b16 v[52:53], v7 offset:25664
  s_waitcnt lgkmcnt(10)
  v_mfma_f32_32x32x16_bf16 v[84:99], v[32:35], v[20:23], v[84:99]
  ds_read_b64_tr_b16 v[54:55], v7 offset:26432
  ds_read_b64_tr_b16 v[56:57], v7 offset:25728
  ds_read_b64_tr_b16 v[58:59], v7 offset:26496
  ds_read_b64_tr_b16 v[60:61], v8 offset:34816
  s_waitcnt lgkmcnt(12)
  v_mfma_f32_32x32x16_bf16 v[100:115], v[36:39], v[20:23], v[100:115]
  ds_read_b64_tr_b16 v[62:63], v8 offset:35328
  ds_read_b64_tr_b16 v[64:65], v9 offset:34816
  ds_read_b64_tr_b16 v[66:67], v9 offset:35328
  s_waitcnt lgkmcnt(13)
  v_mfma_f32_32x32x16_bf16 v[116:131], v[20:23], v[40:43], v[116:131]
  s_waitcnt lgkmcnt(11)
  v_mfma_f32_32x32x16_bf16 v[132:147], v[20:23], v[44:47], v[132:147]
  s_waitcnt lgkmcnt(8)
  v_mfma_f32_32x32x16_bf16 v[68:83], v[48:51], v[24:27], v[68:83]
  s_waitcnt lgkmcnt(6)
  v_mfma_f32_32x32x16_bf16 v[84:99], v[52:55], v[24:27], v[84:99]
  s_waitcnt lgkmcnt(4)
  v_mfma_f32_32x32x16_bf16 v[100:115], v[56:59], v[24:27], v[100:115]
  s_waitcnt lgkmcnt(2)
  v_mfma_f32_32x32x16_bf16 v[116:131], v[24:27], v[60:63], v[116:131]
  s_waitcnt lgkmcnt(0)
  v_mfma_f32_32x32x16_bf16 v[132:147], v[24:27], v[64:67], v[132:147]
  s_waitcnt vmcnt(0)
  v_add_f32 v172, v172, v173
  v_add_f32 v172, v172, v174
  v_add_f32 v172, v172, v175
  v_add_f32 v172, v172, v176
  v_add_f32 v172, v172, v177
  v_add_f32 v172, v172, v178
  v_add_f32 v172, v172, v179
  v_add_f32 v180, v180, v181
  v_mov_b32 v173, v172
  v_mov_b32 v181, v180
  s_nop 1
  v_permlane32_swap_b32 v172, v173
  v_permlane32_swap_b32 v180, v181
  v_add_f32 v172, v172, v173
  v_add_f32 v180, v180, v181
  v_lshlrev_b32 v10, 2, v168
  ds_write_b32 v10, v172 offset:1024
  ds_write_b32 v10, v180 offset:1536
  ds_write_b32 v10, v150 offset:0
  ds_write_b32 v10, v151 offset:512
  s_waitcnt lgkmcnt(0)
  s_barrier
  v_lshrrev_b32 v12, 5, v2
  v_lshlrev_b32 v12, 4, v12
  v_and_b32 v10, 31, v2
  s_lshl_b32 s42, s36, 5
  v_add_u32 v13, s42, v10
  v_mul_u32_u24 v13, 208, v13
  v_lshrrev_b32 v10, 1, v12
  v_add_u32 v13, v13, v10
  ds_read_b128 v[20:23], v12 offset:1024
  ds_read_b128 v[24:27], v12 offset:1056
  ds_read_b128 v[28:31], v12 offset:1088
  ds_read_b128 v[32:35], v12 offset:1120
  ds_read_b128 v[36:39], v12 offset:1152
  ds_read_b128 v[40:43], v12 offset:1184
  ds_read_b128 v[44:47], v12 offset:1216
  ds_read_b128 v[48:51], v12 offset:1248
  s_waitcnt lgkmcnt(4)
  v_pk_mul_f32 v[20:21], v[20:21], v[150:151] op_sel:[0,1] op_sel_hi:[1,1]
  v_pk_fma_f32 v[68:69], v[68:69], v[150:151], v[20:21] op_sel_hi:[1,0,1]
  v_pk_mul_f32 v[22:23], v[22:23], v[150:151] op_sel:[0,1] op_sel_hi:[1,1]
  v_pk_fma_f32 v[70:71], v[70:71], v[150:151], v[22:23] op_sel_hi:[1,0,1]
  v_cvt_pk_bf16_f32 v52, v68, v69
  v_cvt_pk_bf16_f32 v53, v70, v71
  ds_write_b64 v13, v[52:53] offset:2048
  v_pk_mul_f32 v[24:25], v[24:25], v[150:151] op_sel:[0,1] op_sel_hi:[1,1]
  v_pk_fma_f32 v[72:73], v[72:73], v[150:151], v[24:25] op_sel_hi:[1,0,1]
  v_pk_mul_f32 v[26:27], v[26:27], v[150:151] op_sel:[0,1] op_sel_hi:[1,1]
  v_pk_fma_f32 v[74:75], v[74:75], v[150:151], v[26:27] op_sel_hi:[1,0,1]
  v_cvt_pk_bf16_f32 v54, v72, v73
  v_cvt_pk_bf16_f32 v55, v74, v75
  ds_write_b64 v13, v[54:55] offset:2064
  v_pk_mul_f32 v[28:29], v[28:29], v[150:151] op_sel:[0,1] op_sel_hi:[1,1]
  v_pk_fma_f32 v[76:77], v[76:77], v[150:151], v[28:29] op_sel_hi:[1,0,1]
  v_pk_mul_f32 v[30:31], v[30:31], v[150:151] op_sel:[0,1] op_sel_hi:[1,1]
  v_pk_fma_f32 v[78:79], v[78:79], v[150:151], v[30:31] op_sel_hi:[1,0,1]
  v_cvt_pk_bf16_f32 v52, v76, v77
  v_cvt_pk_bf16_f32 v53, v78, v79
  ds_write_b64 v13, v[52:53] offset:2080
  v_pk_mul_f32 v[32:33], v[32:33], v[150:151] op_sel:[0,1] op_sel_hi:[1,1]
  v_pk_fma_f32 v[80:81], v[80:81], v[150:151], v[32:33] op_sel_hi:[1,0,1]
  v_pk_mul_f32 v[34:35], v[34:35], v[150:151] op_sel:[0,1] op_sel_hi:[1,1]
  v_pk_fma_f32 v[82:83], v[82:83], v[150:151], v[34:35] op_sel_hi:[1,0,1]
  v_cvt_pk_bf16_f32 v54, v80, v81
  v_cvt_pk_bf16_f32 v55, v82, v83
  ds_write_b64 v13, v[54:55] offset:2096
  ds_read_b128 v[20:23], v12 offset:1280
  ds_read_b128 v[24:27], v12 offset:1312
  ds_read_b128 v[28:31], v12 offset:1344
  ds_read_b128 v[32:35], v12 offset:1376
  s_waitcnt lgkmcnt(4)
  v_pk_mul_f32 v[36:37], v[36:37], v[150:151] op_sel:[0,1] op_sel_hi:[1,1]
  v_pk_fma_f32 v[84:85], v[84:85], v[150:151], v[36:37] op_sel_hi:[1,0,1]
  v_pk_mul_f32 v[38:39], v[38:39], v[150:151] op_sel:[0,1] op_sel_hi:[1,1]
  v_pk_fma_f32 v[86:87], v[86:87], v[150:151], v[38:39] op_sel_hi:[1,0,1]
  v_cvt_pk_bf16_f32 v52, v84, v85
  v_cvt_pk_bf16_f32 v53, v86, v87
  ds_write_b64 v13, v[52:53] offset:2112
  v_pk_mul_f32 v[40:41], v[40:41], v[150:151] op_sel:[0,1] op_sel_hi:[1,1]
  v_pk_fma_f32 v[88:89], v[88:89], v[150:151], v[40:41] op_sel_hi:[1,0,1]
  v_pk_mul_f32 v[42:43], v[42:43], v[150:151] op_sel:[0,1] op_sel_hi:[1,1]
  v_pk_fma_f32 v[90:91], v[90:91], v[150:151], v[42:43] op_sel_hi:[1,0,1]
  v_cvt_pk_bf16_f32 v54, v88, v89
  v_cvt_pk_bf16_f32 v55, v90, v91
  ds_write_b64 v13, v[54:55] offset:2128
  v_pk_mul_f32 v[44:45], v[44:45], v[150:151] op_sel:[0,1] op_sel_hi:[1,1]
  v_pk_fma_f32 v[92:93], v[92:93], v[150:151], v[44:45] op_sel_hi:[1,0,1]
  v_pk_mul_f32 v[46:47], v[46:47], v[150:151] op_sel:[0,1] op_sel_hi:[1,1]
  v_pk_fma_f32 v[94:95], v[94:95], v[150:151], v[46:47] op_sel_hi:[1,0,1]
  v_cvt_pk_bf16_f32 v52, v92, v93
  v_cvt_pk_bf16_f32 v53, v94, v95
  ds_write_b64 v13, v[52:53] offset:2144
  v_pk_mul_f32 v[48:49], v[48:49], v[150:151] op_sel:[0,1] op_sel_hi:[1,1]
  v_pk_fma_f32 v[96:97], v[96:97], v[150:151], v[48:49] op_sel_hi:[1,0,1]
  v_pk_mul_f32 v[50:51], v[50:51], v[150:151] op_sel:[0,1] op_sel_hi:[1,1]
  v_pk_fma_f32 v[98:99], v[98:99], v[150:151], v[50:51] op_sel_hi:[1,0,1]
  v_cvt_pk_bf16_f32 v54, v96, v97
  v_cvt_pk_bf16_f32 v55, v98, v99
  ds_write_b64 v13, v[54:55] offset:2160
  s_waitcnt lgkmcnt(0)
  v_pk_mul_f32 v[20:21], v[20:21], v[150:151] op_sel:[0,1] op_sel_hi:[1,1]
  v_pk_fma_f32 v[100:101], v[100:101], v[150:151], v[20:21] op_sel_hi:[1,0,1]
  v_pk_mul_f32 v[22:23], v[22:23], v[150:151] op_sel:[0,1] op_sel_hi:[1,1]
  v_pk_fma_f32 v[102:103], v[102:103], v[150:151], v[22:23] op_sel_hi:[1,0,1]
  v_cvt_pk_bf16_f32 v52, v100, v101
  v_cvt_pk_bf16_f32 v53, v102, v103
  ds_write_b64 v13, v[52:53] offset:2176
  v_pk_mul_f32 v[24:25], v[24:25], v[150:151] op_sel:[0,1] op_sel_hi:[1,1]
  v_pk_fma_f32 v[104:105], v[104:105], v[150:151], v[24:25] op_sel_hi:[1,0,1]
  v_pk_mul_f32 v[26:27], v[26:27], v[150:151] op_sel:[0,1] op_sel_hi:[1,1]
  v_pk_fma_f32 v[106:107], v[106:107], v[150:151], v[26:27] op_sel_hi:[1,0,1]
  v_cvt_pk_bf16_f32 v54, v104, v105
  v_cvt_pk_bf16_f32 v55, v106, v107
  ds_write_b64 v13, v[54:55] offset:2192
  v_pk_mul_f32 v[28:29], v[28:29], v[150:151] op_sel:[0,1] op_sel_hi:[1,1]
  v_pk_fma_f32 v[108:109], v[108:109], v[150:151], v[28:29] op_sel_hi:[1,0,1]
  v_pk_mul_f32 v[30:31], v[30:31], v[150:151] op_sel:[0,1] op_sel_hi:[1,1]
  v_pk_fma_f32 v[110:111], v[110:111], v[150:151], v[30:31] op_sel_hi:[1,0,1]
  v_cvt_pk_bf16_f32 v52, v108, v109
  v_cvt_pk_bf16_f32 v53, v110, v111
  ds_write_b64 v13, v[52:53] offset:2208
  v_pk_mul_f32 v[32:33], v[32:33], v[150:151] op_sel:[0,1] op_sel_hi:[1,1]
  v_pk_fma_f32 v[112:113], v[112:113], v[150:151], v[32:33] op_sel_hi:[1,0,1]
  v_pk_mul_f32 v[34:35], v[34:35], v[150:151] op_sel:[0,1] op_sel_hi:[1,1]
  v_pk_fma_f32 v[114:115], v[114:115], v[150:151], v[34:35] op_sel_hi:[1,0,1]
  v_cvt_pk_bf16_f32 v54, v112, v113
  v_cvt_pk_bf16_f32 v55, v114, v115
  ds_write_b64 v13, v[54:55] offset:2224
  s_lshl_b32 s42, s36, 7
  v_add_u32 v14, s42, v12
  v_and_b32 v10, 31, v2
  v_lshlrev_b32 v11, 2, v10
  s_waitcnt lgkmcnt(0)
  s_barrier
  ds_read_b32 v56, v11 offset:1408
  ds_read_b32 v57, v11 offset:1536
  ds_read_b32 v60, v11 offset:1664
  ds_read_b32 v61, v11 offset:1792
  ds_read_b32 v62, v11 offset:1920
  ds_read_b128 v[20:23], v14 offset:0
  ds_read_b128 v[36:39], v14 offset:512
  ds_read_b128 v[24:27], v14 offset:32
  ds_read_b128 v[40:43], v14 offset:544
  ds_read_b128 v[28:31], v14 offset:64
  ds_read_b128 v[44:47], v14 offset:576
  ds_read_b128 v[32:35], v14 offset:96
  ds_read_b128 v[48:51], v14 offset:608
  v_mul_u32_u24 v13, 272, v10
  s_lshl_b32 s42, s36, 6
  v_add_u32 v13, s42, v13
  v_lshrrev_b32 v11, 1, v12
  v_add_u32 v13, v13, v11
  s_waitcnt lgkmcnt(0)
  v_add_f32 v57, v57, v60
  v_add_f32 v61, v61, v62
  v_add_f32 v57, v57, v61
  v_pk_mul_f32 v[60:61], v[36:37], v[56:57] op_sel:[0,0] op_sel_hi:[1,0]
  v_pk_fma_f32 v[116:117], v[116:117], v[20:21], v[60:61]
  v_pk_mul_f32 v[62:63], v[38:39], v[56:57] op_sel:[0,0] op_sel_hi:[1,0]
  v_pk_fma_f32 v[118:119], v[118:119], v[22:23], v[62:63]
  v_cvt_pk_bf16_f32 v52, v116, v117
  v_cvt_pk_bf16_f32 v53, v118, v119
  ds_write_b64 v13, v[52:53] offset:28672
  v_pk_mul_f32 v[60:61], v[40:41], v[56:57] op_sel:[0,0] op_sel_hi:[1,0]
  v_pk_fma_f32 v[120:121], v[120:121], v[24:25], v[60:61]
  v_pk_mul_f32 v[62:63], v[42:43], v[56:57] op_sel:[0,0] op_sel_hi:[1,0]
  v_pk_fma_f32 v[122:123], v[122:123], v[26:27], v[62:63]
  v_cvt_pk_bf16_f32 v54, v120, v121
  v_cvt_pk_bf16_f32 v55, v122, v123
  ds_write_b64 v13, v[54:55] offset:28688
  v_pk_mul_f32 v[60:61], v[44:45], v[56:57] op_sel:[0,0] op_sel_hi:[1,0]
  v_pk_fma_f32 v[124:125], v[124:125], v[28:29], v[60:61]
  v_pk_mul_f32 v[62:63], v[46:47], v[56:57] op_sel:[0,0] op_sel_hi:[1,0]
  v_pk_fma_f32 v[126:127], v[126:127], v[30:31], v[62:63]
  v_cvt_pk_bf16_f32 v52, v124, v125
  v_cvt_pk_bf16_f32 v53, v126, v127
  ds_write_b64 v13, v[52:53] offset:28704
  v_pk_mul_f32 v[60:61], v[48:49], v[56:57] op_sel:[0,0] op_sel_hi:[1,0]
  v_pk_fma_f32 v[128:129], v[128:129], v[32:33], v[60:61]
  v_pk_mul_f32 v[62:63], v[50:51], v[56:57] op_sel:[0,0] op_sel_hi:[1,0]
  v_pk_fma_f32 v[130:131], v[130:131], v[34:35], v[62:63]
  v_cvt_pk_bf16_f32 v54, v128, v129
  v_cvt_pk_bf16_f32 v55, v130, v131
  ds_write_b64 v13, v[54:55] offset:28720
  v_pk_mul_f32 v[60:61], v[36:37], v[56:57] op_sel:[0,1] op_sel_hi:[1,1]
  v_pk_fma_f32 v[132:133], v[132:133], v[20:21], v[60:61]
  v_pk_mul_f32 v[62:63], v[38:39], v[56:57] op_sel:[0,1] op_sel_hi:[1,1]
  v_pk_fma_f32 v[134:135], v[134:135], v[22:23], v[62:63]
  v_cvt_pk_bf16_f32 v52, v132, v133
  v_cvt_pk_bf16_f32 v53, v134, v135
  ds_write_b64 v13, v[52:53] offset:37376
  v_pk_mul_f32 v[60:61], v[40:41], v[56:57] op_sel:[0,1] op_sel_hi:[1,1]
  v_pk_fma_f32 v[136:137], v[136:137], v[24:25], v[60:61]
  v_pk_mul_f32 v[62:63], v[42:43], v[56:57] op_sel:[0,1] op_sel_hi:[1,1]
  v_pk_fma_f32 v[138:139], v[138:139], v[26:27], v[62:63]
  v_cvt_pk_bf16_f32 v54, v136, v137
  v_cvt_pk_bf16_f32 v55, v138, v139
  ds_write_b64 v13, v[54:55] offset:37392
  v_pk_mul_f32 v[60:61], v[44:45], v[56:57] op_sel:[0,1] op_sel_hi:[1,1]
  v_pk_fma_f32 v[140:141], v[140:141], v[28:29], v[60:61]
  v_pk_mul_f32 v[62:63], v[46:47], v[56:57] op_sel:[0,1] op_sel_hi:[1,1]
  v_pk_fma_f32 v[142:143], v[142:143], v[30:31], v[62:63]
  v_cvt_pk_bf16_f32 v52, v140, v141
  v_cvt_pk_bf16_f32 v53, v142, v143
  ds_write_b64 v13, v[52:53] offset:37408
  v_pk_mul_f32 v[60:61], v[48:49], v[56:57] op_sel:[0,1] op_sel_hi:[1,1]
  v_pk_fma_f32 v[144:145], v[144:145], v[32:33], v[60:61]
  v_pk_mul_f32 v[62:63], v[50:51], v[56:57] op_sel:[0,1] op_sel_hi:[1,1]
  v_pk_fma_f32 v[146:147], v[146:147], v[34:35], v[62:63]
  v_cvt_pk_bf16_f32 v54, v144, v145
  v_cvt_pk_bf16_f32 v55, v146, v147
  ds_write_b64 v13, v[54:55] offset:37424
  s_waitcnt lgkmcnt(0)
  s_barrier
  s_branch P1_GELU
P1_LOADER:
  s_sub_u32 s36, s36, 4
  v_lshrrev_b32 v8, 3, v2
  v_lshrrev_b32 v9, 4, v2
  s_and_b32 s42, s36, 1
  s_lshl_b32 s42, s42, 2
  v_add_u32 v9, s42, v9
  v_and_b32 v10, 7, v2
  v_xor_b32 v10, v10, v9
  v_lshlrev_b32 v10, 4, v10
  v_mul_u32_u24 v8, 1024, v8
  v_add_u32 v3, v8, v10
  s_lshl_b32 s45, s37, 17
  s_lshl_b32 s42, s36, 13
  s_add_u32 s45, s45, s42
  s_lshl_b32 s48, s36, 10
  v_lshrrev_b32 v8, 3, v2
  v_bfe_u32 v9, v2, 4, 1
  v_lshlrev_b32 v9, 2, v9
  v_and_b32 v10, 7, v2
  v_xor_b32 v10, v10, v9
  v_lshlrev_b32 v10, 4, v10
  v_mul_u32_u24 v8, 2048, v8
  v_add_u32 v7, v8, v10
  v_add_u32 v8, 0, v2
  v_mul_u32_u24 v9, 43691, v8
  v_lshrrev_b32 v9, 19, v9
  v_mul_u32_u24 v10, 12, v9
  v_sub_u32 v10, v8, v10
  v_lshlrev_b32 v10, 4, v10
  v_mul_u32_u24 v9, 3072, v9
  v_add_u32 v4, v9, v10
  v_add_u32 v8, 64, v2
  v_mul_u32_u24 v9, 43691, v8
  v_lshrrev_b32 v9, 19, v9
  v_mul_u32_u24 v10, 12, v9
  v_sub_u32 v10, v8, v10
  v_lshlrev_b32 v10, 4, v10
  v_mul_u32_u24 v9, 3072, v9
  v_add_u32 v5, v9, v10
  v_add_u32 v8, 128, v2
  v_mul_u32_u24 v9, 43691, v8
  v_lshrrev_b32 v9, 19, v9
  v_mul_u32_u24 v10, 12, v9
  v_sub_u32 v10, v8, v10
  v_lshlrev_b32 v10, 4, v10
  v_mul_u32_u24 v9, 3072, v9
  v_add_u32 v6, v9, v10
  s_mul_i32 s46, s36, 49152
  s_mul_i32 s42, s38, 192
  s_add_u32 s46, s46, s42
  s_mul_i32 s47, s36, 32768
  s_lshl_b32 s42, s38, 7
  s_add_u32 s47, s47, s42
  s_mul_i32 s49, s36, 3072
  s_add_u32 s49, s49, 16384
  s_lshl_b32 s50, s36, 11
  s_add_u32 s50, s50, 28672
  s_waitcnt lgkmcnt(0)
  s_mov_b32 s8, s4
  s_mov_b32 s9, s5
  s_mov_b32 s10, 2048000
  s_mov_b32 s11, 0x20000
  s_mov_b32 s12, s6
  s_mov_b32 s13, s7
  s_mov_b32 s14, 1572864
  s_mov_b32 s15, 0x20000
  s_mov_b32 s16, s32
  s_mov_b32 s17, s33
  s_mov_b32 s18, 1048576
  s_mov_b32 s19, 0x20000
  s_mov_b32 s40, 2048
  s_mul_i32 s42, s39, 128
  s_add_u32 s42, s42, s45
  s_add_u32 s43, s40, s48
  s_mov_b32 m0, s43
  s_nop 0
  buffer_load_dwordx4 v3, s[8:11], s42 offen  lds
  s_add_u32 m0, s43, 4096
  s_add_u32 s44, s42, 32768
  buffer_load_dwordx4 v3, s[8:11], s44 offen  lds
  s_add_u32 m0, s43, 8192
  s_add_u32 s44, s42, 65536
  buffer_load_dwordx4 v3, s[8:11], s44 offen  lds
  s_add_u32 m0, s43, 12288
  s_add_u32 s44, s42, 98304
  buffer_load_dwordx4 v3, s[8:11], s44 offen  lds
  s_mul_i32 s42, s39, 196608
  s_add_u32 s42, s42, s46
  s_add_u32 s43, s40, s49
  s_mov_b32 m0, s43
  s_nop 0
  buffer_load_dwordx4 v4, s[12:15], s42 offen  lds
  s_add_u32 m0, s43, 1024
  s_nop 0
  buffer_load_dwordx4 v5, s[12:15], s42 offen  lds
  s_add_u32 m0, s43, 2048
  s_nop 0
  buffer_load_dwordx4 v6, s[12:15], s42 offen  lds
  s_mul_i32 s42, s39, 131072
  s_add_u32 s42, s42, s47
  s_add_u32 s43, s40, s50
  s_mov_b32 m0, s43
  s_nop 0
  buffer_load_dwordx4 v7, s[16:19], s42 offen  lds
  s_add_u32 m0, s43, 1024
  s_add_u32 s44, s42, 16384
  buffer_load_dwordx4 v7, s[16:19], s44 offen  lds
  s_add_u32 s39, s39, 1
  s_and_b32 s39, s39, 7
  s_add_u32 s40, s40, 36864
  s_cmp_eq_u32 s40, 149504
  s_cselect_b32 s40, 2048, s40
  s_mul_i32 s42, s39, 128
  s_add_u32 s42, s42, s45
  s_add_u32 s43, s40, s48
  s_mov_b32 m0, s43
  s_nop 0
  buffer_load_dwordx4 v3, s[8:11], s42 offen  lds
  s_add_u32 m0, s43, 4096
  s_add_u32 s44, s42, 32768
  buffer_load_dwordx4 v3, s[8:11], s44 offen  lds
  s_add_u32 m0, s43, 8192
  s_add_u32 s44, s42, 65536
  buffer_load_dwordx4 v3, s[8:11], s44 offen  lds
  s_add_u32 m0, s43, 12288
  s_add_u32 s44, s42, 98304
  buffer_load_dwordx4 v3, s[8:11], s44 offen  lds
  s_mul_i32 s42, s39, 196608
  s_add_u32 s42, s42, s46
  s_add_u32 s43, s40, s49
  s_mov_b32 m0, s43
  s_nop 0
  buffer_load_dwordx4 v4, s[12:15], s42 offen  lds
  s_add_u32 m0, s43, 1024
  s_nop 0
  buffer_load_dwordx4 v5, s[12:15], s42 offen  lds
  s_add_u32 m0, s43, 2048
  s_nop 0
  buffer_load_dwordx4 v6, s[12:15], s42 offen  lds
  s_mul_i32 s42, s39, 131072
  s_add_u32 s42, s42, s47
  s_add_u32 s43, s40, s50
  s_mov_b32 m0, s43
  s_nop 0
  buffer_load_dwordx4 v7, s[16:19], s42 offen  lds
  s_add_u32 m0, s43, 1024
  s_add_u32 s44, s42, 16384
  buffer_load_dwordx4 v7, s[16:19], s44 offen  lds
  s_add_u32 s39, s39, 1
  s_and_b32 s39, s39, 7
  s_add_u32 s40, s40, 36864
  s_cmp_eq_u32 s40, 149504
  s_cselect_b32 s40, 2048, s40
  s_add_u32 s92, s96, 31457280
  s_addc_u32 s93, s97, 0
  s_mov_b32 s94, 163840
  s_mov_b32 s95, 0x20000
  s_add_u32 s96, s96, 31588352
  s_addc_u32 s97, s97, 0
  s_load_dword s3, s[96:97], 0
  s_mov_b32 s20, s34
  s_mov_b32 s21, s35
  s_mov_b32 s22, 6144000
  s_mov_b32 s23, 0x20000
  s_add_u32 s24, s34, 6291456
  s_addc_u32 s25, s35, 0
  s_mov_b32 s26, 4194304
  s_mov_b32 s27, 0x20000
  s_add_u32 s28, s34, 10485760
  s_addc_u32 s29, s35, 0
  s_mov_b32 s30, 131072
  s_mov_b32 s31, 0x20000
  s_waitcnt vmcnt(9)
  s_barrier
  s_mov_b32 s41, 6
p1_LD_st_21:
  s_mul_i32 s42, s39, 128
  s_add_u32 s42, s42, s45
  s_add_u32 s43, s40, s48
  s_mov_b32 m0, s43
  s_nop 0
  buffer_load_dwordx4 v3, s[8:11], s42 offen  lds
  s_add_u32 m0, s43, 4096
  s_add_u32 s44, s42, 32768
  buffer_load_dwordx4 v3, s[8:11], s44 offen  lds
  s_add_u32 m0, s43, 8192
  s_add_u32 s44, s42, 65536
  buffer_load_dwordx4 v3, s[8:11], s44 offen  lds
  s_add_u32 m0, s43, 12288
  s_add_u32 s44, s42, 98304
  buffer_load_dwordx4 v3, s[8:11], s44 offen  lds
  s_mul_i32 s42, s39, 196608
  s_add_u32 s42, s42, s46
  s_add_u32 s43, s40, s49
  s_mov_b32 m0, s43
  s_nop 0
  buffer_load_dwordx4 v4, s[12:15], s42 offen  lds
  s_add_u32 m0, s43, 1024
  s_nop 0
  buffer_load_dwordx4 v5, s[12:15], s42 offen  lds
  s_add_u32 m0, s43, 2048
  s_nop 0
  buffer_load_dwordx4 v6, s[12:15], s42 offen  lds
  s_mul_i32 s42, s39, 131072
  s_add_u32 s42, s42, s47
  s_add_u32 s43, s40, s50
  s_mov_b32 m0, s43
  s_nop 0
  buffer_load_dwordx4 v7, s[16:19], s42 offen  lds
  s_add_u32 m0, s43, 1024
  s_add_u32 s44, s42, 16384
  buffer_load_dwordx4 v7, s[16:19], s44 offen  lds
  s_add_u32 s39, s39, 1
  s_and_b32 s39, s39, 7
  s_add_u32 s40, s40, 36864
  s_cmp_eq_u32 s40, 149504
  s_cselect_b32 s40, 2048, s40
  s_waitcnt vmcnt(9)
  s_barrier
  s_sub_u32 s41, s41, 1
  s_cmp_lg_u32 s41, 0
  s_cbranch_scc1 p1_LD_st_21
  s_waitcnt vmcnt(0)
  s_barrier
  s_load_dwordx2 s[8:9], s[0:1], 16
  s_load_dwordx2 s[12:13], s[0:1], 40
  s_load_dwordx2 s[16:17], s[0:1], 56
  v_and_b32 v3, 15, v2
  s_lshl_b32 s42, s2, 4
  v_add_u32 v3, s42, v3
  v_lshlrev_b32 v3, 7, v3
  s_waitcnt lgkmcnt(0)
  s_mov_b32 s10, 524288
  s_mov_b32 s11, 0x20000
  s_mov_b32 s14, 524288
  s_mov_b32 s15, 0x20000
  s_mov_b32 s18, 1048576
  s_mov_b32 s19, 0x20000
  v_cmp_gt_u32 vcc, 16, v2
  s_nop 0
  s_and_saveexec_b64 s[54:55], vcc
  s_cmp_eq_u32 s58, 4
  s_cbranch_scc0 P1_pf9
  buffer_load_dword v127, v3, s[8:11], 0 offen
  s_branch P1_pfd
P1_pf9:
  s_cmp_eq_u32 s58, 5
  s_cbranch_scc0 P1_pf10
  buffer_load_dword v127, v3, s[12:15], 0 offen
  s_branch P1_pfd
P1_pf10:
  s_sub_u32 s43, s58, 6
  s_lshl_b32 s43, s43, 19
  buffer_load_dword v127, v3, s[16:19], s43 offen
P1_pfd:
  s_mov_b64 exec, s[54:55]
  s_barrier
  s_mul_i32 s43, s37, 393216
  s_mul_i32 s44, s38, 192
  s_add_u32 s43, s43, s44
  v_add_u32 v3, 4294967040, v0
  v_mul_u32_u24 v4, 43691, v3
  v_lshrrev_b32 v4, 19, v4
  v_mul_u32_u24 v5, 12, v4
  v_sub_u32 v5, v3, v5
  v_lshlrev_b32 v5, 4, v5
  v_mul_u32_u24 v6, 208, v4
  v_add_u32 v32, v6, v5
  v_mul_u32_u24 v4, 3072, v4
  v_add_u32 v40, v4, v5
  v_add_u32 v3, 0, v0
  v_mul_u32_u24 v4, 43691, v3
  v_lshrrev_b32 v4, 19, v4
  v_mul_u32_u24 v5, 12, v4
  v_sub_u32 v5, v3, v5
  v_lshlrev_b32 v5, 4, v5
  v_mul_u32_u24 v6, 208, v4
  v_add_u32 v33, v6, v5
  v_mul_u32_u24 v4, 3072, v4
  v_add_u32 v41, v4, v5
  v_add_u32 v3, 256, v0
  v_mul_u32_u24 v4, 43691, v3
  v_lshrrev_b32 v4, 19, v4
  v_mul_u32_u24 v5, 12, v4
  v_sub_u32 v5, v3, v5
  v_lshlrev_b32 v5, 4, v5
  v_mul_u32_u24 v6, 208, v4
  v_add_u32 v34, v6, v5
  v_mul_u32_u24 v4, 3072, v4
  v_add_u32 v42, v4, v5
  v_add_u32 v3, 512, v0
  v_mul_u32_u24 v4, 43691, v3
  v_lshrrev_b32 v4, 19, v4
  v_mul_u32_u24 v5, 12, v4
  v_sub_u32 v5, v3, v5
  v_lshlrev_b32 v5, 4, v5
  v_mul_u32_u24 v6, 208, v4
  v_add_u32 v35, v6, v5
  v_mul_u32_u24 v4, 3072, v4
  v_add_u32 v43, v4, v5
  v_add_u32 v3, 768, v0
  v_mul_u32_u24 v4, 43691, v3
  v_lshrrev_b32 v4, 19, v4
  v_mul_u32_u24 v5, 12, v4
  v_sub_u32 v5, v3, v5
  v_lshlrev_b32 v5, 4, v5
  v_mul_u32_u24 v6, 208, v4
  v_add_u32 v36, v6, v5
  v_mul_u32_u24 v4, 3072, v4
  v_add_u32 v44, v4, v5
  v_add_u32 v3, 1024, v0
  v_mul_u32_u24 v4, 43691, v3
  v_lshrrev_b32 v4, 19, v4
  v_mul_u32_u24 v5, 12, v4
  v_sub_u32 v5, v3, v5
  v_lshlrev_b32 v5, 4, v5
  v_mul_u32_u24 v6, 208, v4
  v_add_u32 v37, v6, v5
  v_mul_u32_u24 v4, 3072, v4
  v_add_u32 v45, v4, v5
  s_barrier
  ds_read_b128 v[8:11], v32 offset:2048
  ds_read_b128 v[12:15], v33 offset:2048
  ds_read_b128 v[16:19], v34 offset:2048
  ds_read_b128 v[20:23], v35 offset:2048
  ds_read_b128 v[24:27], v36 offset:2048
  ds_read_b128 v[28:31], v37 offset:2048
  s_waitcnt lgkmcnt(5)
  buffer_store_dwordx4 v[8:11], v40, s[20:23], s43 offen sc1
  s_waitcnt lgkmcnt(4)
  buffer_store_dwordx4 v[12:15], v41, s[20:23], s43 offen sc1
  s_waitcnt lgkmcnt(3)
  buffer_store_dwordx4 v[16:19], v42, s[20:23], s43 offen sc1
  s_waitcnt lgkmcnt(2)
  buffer_store_dwordx4 v[20:23], v43, s[20:23], s43 offen sc1
  s_waitcnt lgkmcnt(1)
  buffer_store_dwordx4 v[24:27], v44, s[20:23], s43 offen sc1
  s_waitcnt lgkmcnt(0)
  buffer_store_dwordx4 v[28:31], v45, s[20:23], s43 offen sc1
  s_barrier
P1_GELU:
  v_lshrrev_b32 v4, 4, v0
  v_and_b32 v5, 15, v0
  v_lshlrev_b32 v5, 4, v5
  v_mul_u32_u24 v6, 272, v4
  v_add_u32 v6, v6, v5
  ds_read_b128 v[48:51], v6 offset:28672
  ds_read_b128 v[52:55], v6 offset:37376
  v_lshl_add_u32 v7, v4, 12, v5
  s_lshl_b32 s44, s38, 18
  s_lshl_b32 s42, s37, 8
  s_add_u32 s44, s44, s42
  v_mov_b32 v88, 0xc0135761
  v_mov_b32 v89, 0xbdd2d3e8
  s_waitcnt lgkmcnt(0)
  v_lshlrev_b32 v56, 16, v48
  v_and_b32 v57, 0xffff0000, v48
  v_lshlrev_b32 v58, 16, v49
  v_and_b32 v59, 0xffff0000, v49
  v_lshlrev_b32 v60, 16, v50
  v_and_b32 v61, 0xffff0000, v50
  v_lshlrev_b32 v62, 16, v51
  v_and_b32 v63, 0xffff0000, v51
  v_lshlrev_b32 v64, 16, v52
  v_and_b32 v65, 0xffff0000, v52
  v_lshlrev_b32 v66, 16, v53
  v_and_b32 v67, 0xffff0000, v53
  v_lshlrev_b32 v68, 16, v54
  v_and_b32 v69, 0xffff0000, v54
  v_lshlrev_b32 v70, 16, v55
  v_and_b32 v71, 0xffff0000, v55
  v_mul_f32 v72, v56, v56
  v_mul_f32 v73, v57, v57
  v_mul_f32 v74, v58, v58
  v_mul_f32 v75, v59, v59
  v_mul_f32 v76, v60, v60
  v_mul_f32 v77, v61, v61
  v_mul_f32 v78, v62, v62
  v_mul_f32 v79, v63, v63
  v_mul_f32 v80, v64, v64
  v_mul_f32 v81, v65, v65
  v_mul_f32 v82, v66, v66
  v_mul_f32 v83, v67, v67
  v_mul_f32 v84, v68, v68
  v_mul_f32 v85, v69, v69
  v_mul_f32 v86, v70, v70
  v_mul_f32 v87, v71, v71
  v_fma_f32 v72, v72, v89, v88
  v_fma_f32 v73, v73, v89, v88
  v_fma_f32 v74, v74, v89, v88
  v_fma_f32 v75, v75, v89, v88
  v_fma_f32 v76, v76, v89, v88
  v_fma_f32 v77, v77, v89, v88
  v_fma_f32 v78, v78, v89, v88
  v_fma_f32 v79, v79, v89, v88
  v_fma_f32 v80, v80, v89, v88
  v_fma_f32 v81, v81, v89, v88
  v_fma_f32 v82, v82, v89, v88
  v_fma_f32 v83, v83, v89, v88
  v_fma_f32 v84, v84, v89, v88
  v_fma_f32 v85, v85, v89, v88
  v_fma_f32 v86, v86, v89, v88
  v_fma_f32 v87, v87, v89, v88
  v_mul_f32 v72, v72, v56
  v_mul_f32 v73, v73, v57
  v_mul_f32 v74, v74, v58
  v_mul_f32 v75, v75, v59
  v_mul_f32 v76, v76, v60
  v_mul_f32 v77, v77, v61
  v_mul_f32 v78, v78, v62
  v_mul_f32 v79, v79, v63
  v_mul_f32 v80, v80, v64
  v_mul_f32 v81, v81, v65
  v_mul_f32 v82, v82, v66
  v_mul_f32 v83, v83, v67
  v_mul_f32 v84, v84, v68
  v_mul_f32 v85, v85, v69
  v_mul_f32 v86, v86, v70
  v_mul_f32 v87, v87, v71
  v_exp_f32 v72, v72
  v_exp_f32 v73, v73
  v_exp_f32 v74, v74
  v_exp_f32 v75, v75
  v_exp_f32 v76, v76
  v_exp_f32 v77, v77
  v_exp_f32 v78, v78
  v_exp_f32 v79, v79
  v_exp_f32 v80, v80
  v_exp_f32 v81, v81
  v_exp_f32 v82, v82
  v_exp_f32 v83, v83
  v_exp_f32 v84, v84
  v_exp_f32 v85, v85
  v_exp_f32 v86, v86
  v_exp_f32 v87, v87
  v_add_f32 v72, 1.0, v72
  v_add_f32 v73, 1.0, v73
  v_add_f32 v74, 1.0, v74
  v_add_f32 v75, 1.0, v75
  v_add_f32 v76, 1.0, v76
  v_add_f32 v77, 1.0, v77
  v_add_f32 v78, 1.0, v78
  v_add_f32 v79, 1.0, v79
  v_add_f32 v80, 1.0, v80
  v_add_f32 v81, 1.0, v81
  v_add_f32 v82, 1.0, v82
  v_add_f32 v83, 1.0, v83
  v_add_f32 v84, 1.0, v84
  v_add_f32 v85, 1.0, v85
  v_add_f32 v86, 1.0, v86
  v_add_f32 v87, 1.0, v87
  v_rcp_f32 v72, v72
  v_rcp_f32 v73, v73
  v_rcp_f32 v74, v74
  v_rcp_f32 v75, v75
  v_rcp_f32 v76, v76
  v_rcp_f32 v77, v77
  v_rcp_f32 v78, v78
  v_rcp_f32 v79, v79
  v_rcp_f32 v80, v80
  v_rcp_f32 v81, v81
  v_rcp_f32 v82, v82
  v_rcp_f32 v83, v83
  v_rcp_f32 v84, v84
  v_rcp_f32 v85, v85
  v_rcp_f32 v86, v86
  v_rcp_f32 v87, v87
  v_mul_f32 v56, v56, v72
  v_mul_f32 v57, v57, v73
  v_mul_f32 v58, v58, v74
  v_mul_f32 v59, v59, v75
  v_mul_f32 v60, v60, v76
  v_mul_f32 v61, v61, v77
  v_mul_f32 v62, v62, v78
  v_mul_f32 v63, v63, v79
  v_mul_f32 v64, v64, v80
  v_mul_f32 v65, v65, v81
  v_mul_f32 v66, v66, v82
  v_mul_f32 v67, v67, v83
  v_mul_f32 v68, v68, v84
  v_mul_f32 v69, v69, v85
  v_mul_f32 v70, v70, v86
  v_mul_f32 v71, v71, v87
  v_cvt_pk_bf16_f32 v48, v56, v57
  v_cvt_pk_bf16_f32 v49, v58, v59
  v_cvt_pk_bf16_f32 v50, v60, v61
  v_cvt_pk_bf16_f32 v51, v62, v63
  v_cvt_pk_bf16_f32 v52, v64, v65
  v_cvt_pk_bf16_f32 v53, v66, v67
  v_cvt_pk_bf16_f32 v54, v68, v69
  v_cvt_pk_bf16_f32 v55, v70, v71
  buffer_store_dwordx4 v[48:51], v7, s[24:27], s44 offen sc1
  s_add_u32 s43, s44, 131072
  buffer_store_dwordx4 v[52:55], v7, s[24:27], s43 offen sc1
  s_cmp_lt_u32 s38, 8
  s_cbranch_scc1 P1_nostat
  v_mul_f32 v72, v56, v56
  v_fma_f32 v72, v64, v64, v72
  v_add_f32 v56, v56, v64
  v_mul_f32 v73, v57, v57
  v_fma_f32 v73, v65, v65, v73
  v_add_f32 v57, v57, v65
  v_mul_f32 v74, v58, v58
  v_fma_f32 v74, v66, v66, v74
  v_add_f32 v58, v58, v66
  v_mul_f32 v75, v59, v59
  v_fma_f32 v75, v67, v67, v75
  v_add_f32 v59, v59, v67
  v_mul_f32 v76, v60, v60
  v_fma_f32 v76, v68, v68, v76
  v_add_f32 v60, v60, v68
  v_mul_f32 v77, v61, v61
  v_fma_f32 v77, v69, v69, v77
  v_add_f32 v61, v61, v69
  v_mul_f32 v78, v62, v62
  v_fma_f32 v78, v70, v70, v78
  v_add_f32 v62, v62, v70
  v_mul_f32 v79, v63, v63
  v_fma_f32 v79, v71, v71, v79
  v_add_f32 v63, v63, v71
  v_permlane16_swap_b32 v56, v72
  v_permlane16_swap_b32 v57, v73
  v_permlane16_swap_b32 v58, v74
  v_permlane16_swap_b32 v59, v75
  v_permlane16_swap_b32 v60, v76
  v_permlane16_swap_b32 v61, v77
  v_permlane16_swap_b32 v62, v78
  v_permlane16_swap_b32 v63, v79
  v_add_f32 v56, v56, v72
  v_add_f32 v57, v57, v73
  v_add_f32 v58, v58, v74
  v_add_f32 v59, v59, v75
  v_add_f32 v60, v60, v76
  v_add_f32 v61, v61, v77
  v_add_f32 v62, v62, v78
  v_add_f32 v63, v63, v79
  v_permlane32_swap_b32 v56, v60
  v_permlane32_swap_b32 v57, v61
  v_permlane32_swap_b32 v58, v62
  v_permlane32_swap_b32 v59, v63
  v_add_f32 v56, v56, v60
  v_add_f32 v57, v57, v61
  v_add_f32 v58, v58, v62
  v_add_f32 v59, v59, v63
  v_lshlrev_b32 v4, 4, v0
  ds_write_b128 v4, v[56:59] offset:46080
  s_waitcnt lgkmcnt(0)
  s_barrier
  s_cmp_lg_u32 s58, 7
  s_cbranch_scc1 P1_nostat
  v_lshlrev_b32 v4, 4, v2
  ds_read_b128 v[8:11], v4 offset:46080
  ds_read_b128 v[12:15], v4 offset:47104
  ds_read_b128 v[16:19], v4 offset:48128
  ds_read_b128 v[20:23], v4 offset:49152
  ds_read_b128 v[24:27], v4 offset:50176
  ds_read_b128 v[28:31], v4 offset:51200
  ds_read_b128 v[32:35], v4 offset:52224
  ds_read_b128 v[36:39], v4 offset:53248
  v_and_b32 v5, 15, v2
  v_lshlrev_b32 v5, 3, v5
  v_lshrrev_b32 v6, 5, v2
  v_lshl_add_u32 v5, v6, 2, v5
  s_lshl_b32 s42, s37, 7
  v_add_u32 v5, s42, v5
  v_lshlrev_b32 v5, 2, v5
  v_bfe_u32 v6, v2, 4, 1
  v_lshl_add_u32 v5, v6, 13, v5
  s_sub_u32 s42, s38, 8
  s_lshl_b32 s42, s42, 14
  s_waitcnt lgkmcnt(0)
  v_add_f32 v8, v8, v12
  v_add_f32 v9, v9, v13
  v_add_f32 v10, v10, v14
  v_add_f32 v11, v11, v15
  v_add_f32 v8, v8, v16
  v_add_f32 v9, v9, v17
  v_add_f32 v10, v10, v18
  v_add_f32 v11, v11, v19
  v_add_f32 v8, v8, v20
  v_add_f32 v9, v9, v21
  v_add_f32 v10, v10, v22
  v_add_f32 v11, v11, v23
  v_add_f32 v8, v8, v24
  v_add_f32 v9, v9, v25
  v_add_f32 v10, v10, v26
  v_add_f32 v11, v11, v27
  v_add_f32 v8, v8, v28
  v_add_f32 v9, v9, v29
  v_add_f32 v10, v10, v30
  v_add_f32 v11, v11, v31
  v_add_f32 v8, v8, v32
  v_add_f32 v9, v9, v33
  v_add_f32 v10, v10, v34
  v_add_f32 v11, v11, v35
  v_add_f32 v8, v8, v36
  v_add_f32 v9, v9, v37
  v_add_f32 v10, v10, v38
  v_add_f32 v11, v11, v39
  buffer_store_dwordx4 v[8:11], v5, s[28:31], s42 offen sc1
P1_nostat:
P1_END:
  s_waitcnt lgkmcnt(0)
  s_add_u32 s3, s3, 1
  s_lshl_b32 s101, s37, 4
  s_add_u32 s101, s101, s38
  s_waitcnt vmcnt(0) lgkmcnt(0)
  s_barrier
  v_lshrrev_b32 v1, 6, v0
  s_nop 0
  v_readfirstlane_b32 s96, v1
  s_nop 0
  s_cmp_lg_u32 s96, 0
  s_cbranch_scc1 p1_arr_22
  s_cmp_eq_u32 s101, -1
  s_cbranch_scc1 p1_arr_22
  s_lshl_b32 s96, s101, 7
  s_add_u32 s96, s96, 0
  v_mov_b32 v1, s3
  v_mov_b32 v2, 0
  s_mov_b64 exec, 1
  buffer_store_dword v1, v2, s[92:95], s96 offen sc1
  s_mov_b64 exec, -1
p1_arr_22:
  s_cmp_ge_u32 s2, 256
  s_cbranch_scc1 P2_END
  s_load_dwordx2 s[4:5], s[0:1], 80
  s_load_dwordx2 s[6:7], s[0:1], 16
  s_load_dwordx2 s[32:33], s[0:1], 32
  v_lshrrev_b32 v1, 6, v0
  v_and_b32 v2, 63, v0
  v_readfirstlane_b32 s36, v1
  s_and_b32 s47, s2, 7
  s_lshr_b32 s50, s2, 3
  s_mov_b32 s58, s36
  s_waitcnt lgkmcnt(0)
  s_cmp_ge_u32 s50, 16
  s_cbranch_scc1 P2_VROLE
  s_lshr_b32 s51, s47, 2
  s_and_b32 s42, s47, 3
  s_lshr_b32 s37, s42, 1
  s_lshl_b32 s37, s37, 2
  s_and_b32 s43, s50, 3
  s_add_u32 s37, s37, s43
  s_and_b32 s38, s42, 1
  s_lshl_b32 s38, s38, 2
  s_lshr_b32 s44, s50, 2
  s_add_u32 s38, s38, s44
  s_lshl_b32 s43, s43, 1
  s_add_u32 s39, s43, s44
  s_and_b32 s39, s39, 7
  s_mul_i32 s42, s51, 3072000
  s_add_u32 s8, s4, s42
  s_addc_u32 s9, s5, 0
  s_mov_b32 s10, 3072000
  s_mov_b32 s11, 0x20000
  s_lshl_b32 s42, s51, 21
  s_add_u32 s42, s42, 11534336
  s_add_u32 s16, s4, s42
  s_addc_u32 s17, s5, 0
  s_mov_b32 s18, 2048000
  s_mov_b32 s19, 0x20000
  s_mov_b32 s39, 0
  s_add_u32 s20, s4, 10747904
  s_addc_u32 s21, s5, 0
  s_mov_b32 s22, 131072
  s_mov_b32 s23, 0x20000
  s_lshl_b32 s101, s51, 6
  s_lshl_b32 s42, s37, 3
  s_add_u32 s101, s101, s42
  s_add_u32 s101, s101, s38
  s_cmp_ge_u32 s36, 4
  s_cbranch_scc1 P2_S_LOADER
  v_and_b32 v12, 31, v2
  v_lshrrev_b32 v13, 5, v2
  v_lshrrev_b32 v14, 1, v12
  v_and_b32 v14, 7, v14
  v_lshlrev_b32 v15, 7, v12
  s_lshl_b32 s42, s36, 12
  v_add_u32 v15, s42, v15
  v_add_u32 v15, 16384, v15
  v_add_u32 v16, 0, v13
  v_xor_b32 v16, v16, v14
  v_lshl_add_u32 v3, v16, 4, v15
  v_add_u32 v16, 2, v13
  v_xor_b32 v16, v16, v14
  v_lshl_add_u32 v4, v16, 4, v15
  v_add_u32 v16, 4, v13
  v_xor_b32 v16, v16, v14
  v_lshl_add_u32 v5, v16, 4, v15
  v_add_u32 v16, 6, v13
  v_xor_b32 v16, v16, v14
  v_lshl_add_u32 v6, v16, 4, v15
  v_and_b32 v12, 31, v2
  v_lshrrev_b32 v13, 5, v2
  v_lshrrev_b32 v14, 1, v12
  v_and_b32 v14, 7, v14
  v_lshlrev_b32 v15, 7, v12
  v_add_u32 v16, 0, v13
  v_xor_b32 v16, v16, v14
  v_lshl_add_u32 v7, v16, 4, v15
  v_add_u32 v16, 2, v13
  v_xor_b32 v16, v16, v14
  v_lshl_add_u32 v8, v16, 4, v15
  v_add_u32 v16, 4, v13
  v_xor_b32 v16, v16, v14
  v_lshl_add_u32 v9, v16, 4, v15
  v_add_u32 v16, 6, v13
  v_xor_b32 v16, v16, v14
  v_lshl_add_u32 v10, v16, 4, v15
  s_mov_b32 s53, 0
  s_mov_b32 s56, 4294836224
  s_mov_b32 s57, 32768
  v_mov_b32 v100, 0
  v_mov_b32 v101, 0
  v_mov_b32 v102, 0
  v_mov_b32 v103, 0
  v_mov_b32 v104, 0
  v_mov_b32 v105, 0
  v_mov_b32 v106, 0
  v_mov_b32 v107, 0
  v_mov_b32 v108, 0
  v_mov_b32 v109, 0
  v_mov_b32 v110, 0
  v_mov_b32 v111, 0
  v_mov_b32 v112, 0
  v_mov_b32 v113, 0
  v_mov_b32 v114, 0
  v_mov_b32 v115, 0
  v_mov_b32 v116, 0
  v_mov_b32 v117, 0
  v_mov_b32 v118, 0
  v_mov_b32 v119, 0
  v_mov_b32 v120, 0
  v_mov_b32 v121, 0
  v_mov_b32 v122, 0
  v_mov_b32 v123, 0
  v_mov_b32 v124, 0
  v_mov_b32 v125, 0
  v_mov_b32 v126, 0
  v_mov_b32 v127, 0
  v_mov_b32 v128, 0
  v_mov_b32 v129, 0
  v_mov_b32 v130, 0
  v_mov_b32 v131, 0
  v_mov_b32 v132, 0
  v_mov_b32 v133, 0
  v_mov_b32 v134, 0
  v_mov_b32 v135, 0
  v_mov_b32 v136, 0
  v_mov_b32 v137, 0
  v_mov_b32 v138, 0
  v_mov_b32 v139, 0
  v_mov_b32 v140, 0
  v_mov_b32 v141, 0
  v_mov_b32 v142, 0
  v_mov_b32 v143, 0
  v_mov_b32 v144, 0
  v_mov_b32 v145, 0
  v_mov_b32 v146, 0
  v_mov_b32 v147, 0
  v_mov_b32 v148, 0
  v_mov_b32 v149, 0
  v_mov_b32 v150, 0
  v_mov_b32 v151, 0
  v_mov_b32 v152, 0
  v_mov_b32 v153, 0
  v_mov_b32 v154, 0
  v_mov_b32 v155, 0
  v_mov_b32 v156, 0
  v_mov_b32 v157, 0
  v_mov_b32 v158, 0
  v_mov_b32 v159, 0
  v_mov_b32 v160, 0
  v_mov_b32 v161, 0
  v_mov_b32 v162, 0
  v_mov_b32 v163, 0
  s_cmp_lg_u32 s58, 0
  s_cbranch_scc1 p2_gwd_1
  s_mul_i32 s96, s51, 1000
  s_lshl_b32 s97, s37, 7
  s_add_u32 s97, s97, s96
  s_lshr_b32 s97, s97, 7
  s_lshl_b32 s100, s38, 7
  s_add_u32 s100, s100, s96
  s_lshr_b32 s100, s100, 7
  v_min_u32 v13, 23, v2
  v_cmp_lt_u32 vcc, 11, v13
  v_mov_b32 v14, s97
  v_mov_b32 v15, s100
  v_cndmask_b32 v14, v14, v15, vcc
  v_subrev_u32 v15, 12, v13
  v_cndmask_b32 v15, v13, v15, vcc
  v_mov_b32 v16, 0
  v_mov_b32 v17, 5
  v_cndmask_b32 v16, v16, v17, vcc
  v_cmp_lt_u32 vcc, 5, v15
  v_subrev_u32 v17, 6, v15
  s_nop 0
  v_cndmask_b32 v15, v15, v17, vcc
  v_add_u32 v16, v16, v15
  v_mov_b32 v17, 0
  v_mov_b32 v15, s51
  v_cndmask_b32 v17, v17, v15, vcc
  v_add_u32 v14, v14, v17
  v_min_u32 v14, 15, v14
  v_lshl_add_u32 v12, v14, 4, v16
  v_lshlrev_b32 v12, 7, v12
  s_mov_b32 s97, 0
  s_mov_b32 s96, 0x200000
p2_gw_2:
  buffer_load_dword v13, v12, s[92:95], s97 offen sc1
  s_waitcnt vmcnt(0)
  v_cmp_ne_u32 vcc, s3, v13
  s_sub_u32 s96, s96, 1
  s_cmp_eq_u32 s96, 0
  s_cbranch_scc1 p2_gwd_1
  s_nop 1
  s_cbranch_vccnz p2_gw_2
p2_gwd_1:
  s_barrier
  s_barrier
  ds_read_b128 v[20:23], v3
  ds_read_b128 v[36:39], v7 offset:0
  ds_read_b128 v[40:43], v7 offset:4096
  ds_read_b128 v[44:47], v7 offset:8192
  ds_read_b128 v[48:51], v7 offset:12288
  ds_read_b128 v[24:27], v4
  ds_read_b128 v[52:55], v8 offset:0
  ds_read_b128 v[56:59], v8 offset:4096
  ds_read_b128 v[60:63], v8 offset:8192
  ds_read_b128 v[64:67], v8 offset:12288
  s_mov_b32 s41, 7
p2_S_loop_3:
  s_waitcnt lgkmcnt(8)
  v_mfma_f32_32x32x16_bf16 v[100:115], v[36:39], v[20:23], v[100:115]
  ds_read_b128 v[28:31], v5
  ds_read_b128 v[68:71], v9 offset:0
  s_waitcnt lgkmcnt(9)
  v_mfma_f32_32x32x16_bf16 v[116:131], v[40:43], v[20:23], v[116:131]
  ds_read_b128 v[72:75], v9 offset:4096
  ds_read_b128 v[76:79], v9 offset:8192
  s_waitcnt lgkmcnt(10)
  v_mfma_f32_32x32x16_bf16 v[132:147], v[44:47], v[20:23], v[132:147]
  ds_read_b128 v[80:83], v9 offset:12288
  s_waitcnt lgkmcnt(10)
  v_mfma_f32_32x32x16_bf16 v[148:163], v[48:51], v[20:23], v[148:163]
  s_waitcnt lgkmcnt(8)
  v_mfma_f32_32x32x16_bf16 v[100:115], v[52:55], v[24:27], v[100:115]
  ds_read_b128 v[32:35], v6
  ds_read_b128 v[84:87], v10 offset:0
  s_waitcnt lgkmcnt(9)
  v_mfma_f32_32x32x16_bf16 v[116:131], v[56:59], v[24:27], v[116:131]
  ds_read_b128 v[88:91], v10 offset:4096
  ds_read_b128 v[92:95], v10 offset:8192
  s_waitcnt lgkmcnt(10)
  v_mfma_f32_32x32x16_bf16 v[132:147], v[60:63], v[24:27], v[132:147]
  ds_read_b128 v[96:99], v10 offset:12288
  s_waitcnt lgkmcnt(10)
  v_mfma_f32_32x32x16_bf16 v[148:163], v[64:67], v[24:27], v[148:163]
  s_barrier
  s_add_u32 s53, s53, 32768
  s_cmp_eq_u32 s53, 163840
  s_cselect_b32 s52, s56, s57
  s_cselect_b32 s53, 0, s53
  v_add_u32 v3, s52, v3
  v_add_u32 v4, s52, v4
  v_add_u32 v5, s52, v5
  v_add_u32 v6, s52, v6
  v_add_u32 v7, s52, v7
  v_add_u32 v8, s52, v8
  v_add_u32 v9, s52, v9
  v_add_u32 v10, s52, v10
  s_waitcnt lgkmcnt(8)
  v_mfma_f32_32x32x16_bf16 v[100:115], v[68:71], v[28:31], v[100:115]
  ds_read_b128 v[20:23], v3
  ds_read_b128 v[36:39], v7 offset:0
  s_waitcnt lgkmcnt(9)
  v_mfma_f32_32x32x16_bf16 v[116:131], v[72:75], v[28:31], v[116:131]
  ds_read_b128 v[40:43], v7 offset:4096
  ds_read_b128 v[44:47], v7 offset:8192
  s_waitcnt lgkmcnt(10)
  v_mfma_f32_32x32x16_bf16 v[132:147], v[76:79], v[28:31], v[132:147]
  ds_read_b128 v[48:51], v7 offset:12288
  s_waitcnt lgkmcnt(10)
  v_mfma_f32_32x32x16_bf16 v[148:163], v[80:83], v[28:31], v[148:163]
  s_waitcnt lgkmcnt(8)
  v_mfma_f32_32x32x16_bf16 v[100:115], v[84:87], v[32:35], v[100:115]
  ds_read_b128 v[24:27], v4
  ds_read_b128 v[52:55], v8 offset:0
  s_waitcnt lgkmcnt(9)
  v_mfma_f32_32x32x16_bf16 v[116:131], v[88:91], v[32:35], v[116:131]
  ds_read_b128 v[56:59], v8 offset:4096
  ds_read_b128 v[60:63], v8 offset:8192
  s_waitcnt lgkmcnt(10)
  v_mfma_f32_32x32x16_bf16 v[132:147], v[92:95], v[32:35], v[132:147]
  ds_read_b128 v[64:67], v8 offset:12288
  s_waitcnt lgkmcnt(10)
  v_mfma_f32_32x32x16_bf16 v[148:163], v[96:99], v[32:35], v[148:163]
  s_sub_u32 s41, s41, 1
  s_cmp_lg_u32 s41, 0
  s_cbranch_scc1 p2_S_loop_3
  s_waitcnt lgkmcnt(8)
  v_mfma_f32_32x32x16_bf16 v[100:115], v[36:39], v[20:23], v[100:115]
  ds_read_b128 v[28:31], v5
  ds_read_b128 v[68:71], v9 offset:0
  s_waitcnt lgkmcnt(9)
  v_mfma_f32_32x32x16_bf16 v[116:131], v[40:43], v[20:23], v[116:131]
  ds_read_b128 v[72:75], v9 offset:4096
  ds_read_b128 v[76:79], v9 offset:8192
  s_waitcnt lgkmcnt(10)
  v_mfma_f32_32x32x16_bf16 v[132:147], v[44:47], v[20:23], v[132:147]
  ds_read_b128 v[80:83], v9 offset:12288
  s_waitcnt lgkmcnt(10)
  v_mfma_f32_32x32x16_bf16 v[148:163], v[48:51], v[20:23], v[148:163]
  s_waitcnt lgkmcnt(8)
  v_mfma_f32_32x32x16_bf16 v[100:115], v[52:55], v[24:27], v[100:115]
  ds_read_b128 v[32:35], v6
  ds_read_b128 v[84:87], v10 offset:0
  s_waitcnt lgkmcnt(9)
  v_mfma_f32_32x32x16_bf16 v[116:131], v[56:59], v[24:27], v[116:131]
  ds_read_b128 v[88:91], v10 offset:4096
  ds_read_b128 v[92:95], v10 offset:8192
  s_waitcnt lgkmcnt(10)
  v_mfma_f32_32x32x16_bf16 v[132:147], v[60:63], v[24:27], v[132:147]
  ds_read_b128 v[96:99], v10 offset:12288
  s_waitcnt lgkmcnt(10)
  v_mfma_f32_32x32x16_bf16 v[148:163], v[64:67], v[24:27], v[148:163]
  s_waitcnt lgkmcnt(8)
  v_mfma_f32_32x32x16_bf16 v[100:115], v[68:71], v[28:31], v[100:115]
  s_waitcnt lgkmcnt(7)
  v_mfma_f32_32x32x16_bf16 v[116:131], v[72:75], v[28:31], v[116:131]
  s_waitcnt lgkmcnt(6)
  v_mfma_f32_32x32x16_bf16 v[132:147], v[76:79], v[28:31], v[132:147]
  s_waitcnt lgkmcnt(5)
  v_mfma_f32_32x32x16_bf16 v[148:163], v[80:83], v[28:31], v[148:163]
  s_waitcnt lgkmcnt(3)
  v_mfma_f32_32x32x16_bf16 v[100:115], v[84:87], v[32:35], v[100:115]
  s_waitcnt lgkmcnt(2)
  v_mfma_f32_32x32x16_bf16 v[116:131], v[88:91], v[32:35], v[116:131]
  s_waitcnt lgkmcnt(1)
  v_mfma_f32_32x32x16_bf16 v[132:147], v[92:95], v[32:35], v[132:147]
  s_waitcnt lgkmcnt(0)
  v_mfma_f32_32x32x16_bf16 v[148:163], v[96:99], v[32:35], v[148:163]
  s_cmp_lg_u32 s38, 7
  s_nop 3
  s_cbranch_scc1 P2_S_nomask
  s_nop 9
  v_mov_b32 v152, 0xff800000
  v_mov_b32 v153, 0xff800000
  v_mov_b32 v154, 0xff800000
  v_mov_b32 v155, 0xff800000
  v_mov_b32 v156, 0xff800000
  v_mov_b32 v157, 0xff800000
  v_mov_b32 v158, 0xff800000
  v_mov_b32 v159, 0xff800000
  v_mov_b32 v160, 0xff800000
  v_mov_b32 v161, 0xff800000
  v_mov_b32 v162, 0xff800000
  v_mov_b32 v163, 0xff800000
P2_S_nomask:
  v_max3_f32 v164, v100, v101, v102
  v_max3_f32 v165, v103, v104, v105
  v_max3_f32 v164, v106, v107, v164
  v_max3_f32 v165, v108, v109, v165
  v_max3_f32 v164, v110, v111, v164
  v_max3_f32 v165, v112, v113, v165
  v_max3_f32 v164, v114, v115, v164
  v_max3_f32 v165, v116, v117, v165
  v_max3_f32 v164, v118, v119, v164
  v_max3_f32 v165, v120, v121, v165
  v_max3_f32 v164, v122, v123, v164
  v_max3_f32 v165, v124, v125, v165
  v_max3_f32 v164, v126, v127, v164
  v_max3_f32 v165, v128, v129, v165
  v_max3_f32 v164, v130, v131, v164
  v_max3_f32 v165, v132, v133, v165
  v_max3_f32 v164, v134, v135, v164
  v_max3_f32 v165, v136, v137, v165
  v_max3_f32 v164, v138, v139, v164
  v_max3_f32 v165, v140, v141, v165
  v_max3_f32 v164, v142, v143, v164
  v_max3_f32 v165, v144, v145, v165
  v_max3_f32 v164, v146, v147, v164
  v_max3_f32 v165, v148, v149, v165
  v_max3_f32 v164, v150, v151, v164
  v_max3_f32 v165, v152, v153, v165
  v_max3_f32 v164, v154, v155, v164
  v_max3_f32 v165, v156, v157, v165
  v_max3_f32 v164, v158, v159, v164
  v_max3_f32 v165, v160, v161, v165
  v_max3_f32 v164, v162, v163, v164
  v_max_f32 v164, v164, v165
  v_mov_b32 v165, v164
  s_nop 1
  v_permlane32_swap_b32 v164, v165
  v_max_f32 v164, v164, v165
  v_mul_f32 v164, 0x3d8293ee, v164
  v_sub_f32 v165, 0, v164
  v_mov_b32 v172, 0x3d8293ee
  v_mov_b32 v173, 0x3d8293ee
  v_mov_b32 v168, 0
  v_mov_b32 v169, 0
  v_mov_b32 v170, 0
  v_mov_b32 v171, 0
  v_and_b32 v12, 31, v2
  s_lshl_b32 s42, s36, 5
  v_add_u32 v12, s42, v12
  v_mul_u32_u24 v180, 272, v12
  v_lshrrev_b32 v13, 5, v2
  v_lshl_add_u32 v180, v13, 3, v180
  s_barrier
  v_pk_fma_f32 v[100:101], v[100:101], v[172:173], v[164:165] op_sel:[0,0,1] op_sel_hi:[1,1,1]
  v_pk_fma_f32 v[102:103], v[102:103], v[172:173], v[164:165] op_sel:[0,0,1] op_sel_hi:[1,1,1]
  v_exp_f32 v100, v100
  v_exp_f32 v101, v101
  v_exp_f32 v102, v102
  v_exp_f32 v103, v103
  v_pk_add_f32 v[168:169], v[168:169], v[100:101]
  v_pk_add_f32 v[170:171], v[170:171], v[102:103]
  v_cvt_pk_bf16_f32 v176, v100, v101
  v_cvt_pk_bf16_f32 v177, v102, v103
  ds_write_b64 v180, v[176:177] offset:0
  v_pk_fma_f32 v[104:105], v[104:105], v[172:173], v[164:165] op_sel:[0,0,1] op_sel_hi:[1,1,1]
  v_pk_fma_f32 v[106:107], v[106:107], v[172:173], v[164:165] op_sel:[0,0,1] op_sel_hi:[1,1,1]
  v_exp_f32 v104, v104
  v_exp_f32 v105, v105
  v_exp_f32 v106, v106
  v_exp_f32 v107, v107
  v_pk_add_f32 v[168:169], v[168:169], v[104:105]
  v_pk_add_f32 v[170:171], v[170:171], v[106:107]
  v_cvt_pk_bf16_f32 v178, v104, v105
  v_cvt_pk_bf16_f32 v179, v106, v107
  ds_write_b64 v180, v[178:179] offset:16
  v_pk_fma_f32 v[108:109], v[108:109], v[172:173], v[164:165] op_sel:[0,0,1] op_sel_hi:[1,1,1]
  v_pk_fma_f32 v[110:111], v[110:111], v[172:173], v[164:165] op_sel:[0,0,1] op_sel_hi:[1,1,1]
  v_exp_f32 v108, v108
  v_exp_f32 v109, v109
  v_exp_f32 v110, v110
  v_exp_f32 v111, v111
  v_pk_add_f32 v[168:169], v[168:169], v[108:109]
  v_pk_add_f32 v[170:171], v[170:171], v[110:111]
  v_cvt_pk_bf16_f32 v176, v108, v109
  v_cvt_pk_bf16_f32 v177, v110, v111
  ds_write_b64 v180, v[176:177] offset:32
  v_pk_fma_f32 v[112:113], v[112:113], v[172:173], v[164:165] op_sel:[0,0,1] op_sel_hi:[1,1,1]
  v_pk_fma_f32 v[114:115], v[114:115], v[172:173], v[164:165] op_sel:[0,0,1] op_sel_hi:[1,1,1]
  v_exp_f32 v112, v112
  v_exp_f32 v113, v113
  v_exp_f32 v114, v114
  v_exp_f32 v115, v115
  v_pk_add_f32 v[168:169], v[168:169], v[112:113]
  v_pk_add_f32 v[170:171], v[170:171], v[114:115]
  v_cvt_pk_bf16_f32 v178, v112, v113
  v_cvt_pk_bf16_f32 v179, v114, v115
  ds_write_b64 v180, v[178:179] offset:48
  v_pk_fma_f32 v[116:117], v[116:117], v[172:173], v[164:165] op_sel:[0,0,1] op_sel_hi:[1,1,1]
  v_pk_fma_f32 v[118:119], v[118:119], v[172:173], v[164:165] op_sel:[0,0,1] op_sel_hi:[1,1,1]
  v_exp_f32 v116, v116
  v_exp_f32 v117, v117
  v_exp_f32 v118, v118
  v_exp_f32 v119, v119
  v_pk_add_f32 v[168:169], v[168:169], v[116:117]
  v_pk_add_f32 v[170:171], v[170:171], v[118:119]
  v_cvt_pk_bf16_f32 v176, v116, v117
  v_cvt_pk_bf16_f32 v177, v118, v119
  ds_write_b64 v180, v[176:177] offset:64
  v_pk_fma_f32 v[120:121], v[120:121], v[172:173], v[164:165] op_sel:[0,0,1] op_sel_hi:[1,1,1]
  v_pk_fma_f32 v[122:123], v[122:123], v[172:173], v[164:165] op_sel:[0,0,1] op_sel_hi:[1,1,1]
  v_exp_f32 v120, v120
  v_exp_f32 v121, v121
  v_exp_f32 v122, v122
  v_exp_f32 v123, v123
  v_pk_add_f32 v[168:169], v[168:169], v[120:121]
  v_pk_add_f32 v[170:171], v[170:171], v[122:123]
  v_cvt_pk_bf16_f32 v178, v120, v121
  v_cvt_pk_bf16_f32 v179, v122, v123
  ds_write_b64 v180, v[178:179] offset:80
  v_pk_fma_f32 v[124:125], v[124:125], v[172:173], v[164:165] op_sel:[0,0,1] op_sel_hi:[1,1,1]
  v_pk_fma_f32 v[126:127], v[126:127], v[172:173], v[164:165] op_sel:[0,0,1] op_sel_hi:[1,1,1]
  v_exp_f32 v124, v124
  v_exp_f32 v125, v125
  v_exp_f32 v126, v126
  v_exp_f32 v127, v127
  v_pk_add_f32 v[168:169], v[168:169], v[124:125]
  v_pk_add_f32 v[170:171], v[170:171], v[126:127]
  v_cvt_pk_bf16_f32 v176, v124, v125
  v_cvt_pk_bf16_f32 v177, v126, v127
  ds_write_b64 v180, v[176:177] offset:96
  v_pk_fma_f32 v[128:129], v[128:129], v[172:173], v[164:165] op_sel:[0,0,1] op_sel_hi:[1,1,1]
  v_pk_fma_f32 v[130:131], v[130:131], v[172:173], v[164:165] op_sel:[0,0,1] op_sel_hi:[1,1,1]
  v_exp_f32 v128, v128
  v_exp_f32 v129, v129
  v_exp_f32 v130, v130
  v_exp_f32 v131, v131
  v_pk_add_f32 v[168:169], v[168:169], v[128:129]
  v_pk_add_f32 v[170:171], v[170:171], v[130:131]
  v_cvt_pk_bf16_f32 v178, v128, v129
  v_cvt_pk_bf16_f32 v179, v130, v131
  ds_write_b64 v180, v[178:179] offset:112
  v_pk_fma_f32 v[132:133], v[132:133], v[172:173], v[164:165] op_sel:[0,0,1] op_sel_hi:[1,1,1]
  v_pk_fma_f32 v[134:135], v[134:135], v[172:173], v[164:165] op_sel:[0,0,1] op_sel_hi:[1,1,1]
  v_exp_f32 v132, v132
  v_exp_f32 v133, v133
  v_exp_f32 v134, v134
  v_exp_f32 v135, v135
  v_pk_add_f32 v[168:169], v[168:169], v[132:133]
  v_pk_add_f32 v[170:171], v[170:171], v[134:135]
  v_cvt_pk_bf16_f32 v176, v132, v133
  v_cvt_pk_bf16_f32 v177, v134, v135
  ds_write_b64 v180, v[176:177] offset:128
  v_pk_fma_f32 v[136:137], v[136:137], v[172:173], v[164:165] op_sel:[0,0,1] op_sel_hi:[1,1,1]
  v_pk_fma_f32 v[138:139], v[138:139], v[172:173], v[164:165] op_sel:[0,0,1] op_sel_hi:[1,1,1]
  v_exp_f32 v136, v136
  v_exp_f32 v137, v137
  v_exp_f32 v138, v138
  v_exp_f32 v139, v139
  v_pk_add_f32 v[168:169], v[168:169], v[136:137]
  v_pk_add_f32 v[170:171], v[170:171], v[138:139]
  v_cvt_pk_bf16_f32 v178, v136, v137
  v_cvt_pk_bf16_f32 v179, v138, v139
  ds_write_b64 v180, v[178:179] offset:144
  v_pk_fma_f32 v[140:141], v[140:141], v[172:173], v[164:165] op_sel:[0,0,1] op_sel_hi:[1,1,1]
  v_pk_fma_f32 v[142:143], v[142:143], v[172:173], v[164:165] op_sel:[0,0,1] op_sel_hi:[1,1,1]
  v_exp_f32 v140, v140
  v_exp_f32 v141, v141
  v_exp_f32 v142, v142
  v_exp_f32 v143, v143
  v_pk_add_f32 v[168:169], v[168:169], v[140:141]
  v_pk_add_f32 v[170:171], v[170:171], v[142:143]
  v_cvt_pk_bf16_f32 v176, v140, v141
  v_cvt_pk_bf16_f32 v177, v142, v143
  ds_write_b64 v180, v[176:177] offset:160
  v_pk_fma_f32 v[144:145], v[144:145], v[172:173], v[164:165] op_sel:[0,0,1] op_sel_hi:[1,1,1]
  v_pk_fma_f32 v[146:147], v[146:147], v[172:173], v[164:165] op_sel:[0,0,1] op_sel_hi:[1,1,1]
  v_exp_f32 v144, v144
  v_exp_f32 v145, v145
  v_exp_f32 v146, v146
  v_exp_f32 v147, v147
  v_pk_add_f32 v[168:169], v[168:169], v[144:145]
  v_pk_add_f32 v[170:171], v[170:171], v[146:147]
  v_cvt_pk_bf16_f32 v178, v144, v145
  v_cvt_pk_bf16_f32 v179, v146, v147
  ds_write_b64 v180, v[178:179] offset:176
  v_pk_fma_f32 v[148:149], v[148:149], v[172:173], v[164:165] op_sel:[0,0,1] op_sel_hi:[1,1,1]
  v_pk_fma_f32 v[150:151], v[150:151], v[172:173], v[164:165] op_sel:[0,0,1] op_sel_hi:[1,1,1]
  v_exp_f32 v148, v148
  v_exp_f32 v149, v149
  v_exp_f32 v150, v150
  v_exp_f32 v151, v151
  v_pk_add_f32 v[168:169], v[168:169], v[148:149]
  v_pk_add_f32 v[170:171], v[170:171], v[150:151]
  v_cvt_pk_bf16_f32 v176, v148, v149
  v_cvt_pk_bf16_f32 v177, v150, v151
  ds_write_b64 v180, v[176:177] offset:192
  v_pk_fma_f32 v[152:153], v[152:153], v[172:173], v[164:165] op_sel:[0,0,1] op_sel_hi:[1,1,1]
  v_pk_fma_f32 v[154:155], v[154:155], v[172:173], v[164:165] op_sel:[0,0,1] op_sel_hi:[1,1,1]
  v_exp_f32 v152, v152
  v_exp_f32 v153, v153
  v_exp_f32 v154, v154
  v_exp_f32 v155, v155
  v_pk_add_f32 v[168:169], v[168:169], v[152:153]
  v_pk_add_f32 v[170:171], v[170:171], v[154:155]
  v_cvt_pk_bf16_f32 v178, v152, v153
  v_cvt_pk_bf16_f32 v179, v154, v155
  ds_write_b64 v180, v[178:179] offset:208
  v_pk_fma_f32 v[156:157], v[156:157], v[172:173], v[164:165] op_sel:[0,0,1] op_sel_hi:[1,1,1]
  v_pk_fma_f32 v[158:159], v[158:159], v[172:173], v[164:165] op_sel:[0,0,1] op_sel_hi:[1,1,1]
  v_exp_f32 v156, v156
  v_exp_f32 v157, v157
  v_exp_f32 v158, v158
  v_exp_f32 v159, v159
  v_pk_add_f32 v[168:169], v[168:169], v[156:157]
  v_pk_add_f32 v[170:171], v[170:171], v[158:159]
  v_cvt_pk_bf16_f32 v176, v156, v157
  v_cvt_pk_bf16_f32 v177, v158, v159
  ds_write_b64 v180, v[176:177] offset:224
  v_pk_fma_f32 v[160:161], v[160:161], v[172:173], v[164:165] op_sel:[0,0,1] op_sel_hi:[1,1,1]
  v_pk_fma_f32 v[162:163], v[162:163], v[172:173], v[164:165] op_sel:[0,0,1] op_sel_hi:[1,1,1]
  v_exp_f32 v160, v160
  v_exp_f32 v161, v161
  v_exp_f32 v162, v162
  v_exp_f32 v163, v163
  v_pk_add_f32 v[168:169], v[168:169], v[160:161]
  v_pk_add_f32 v[170:171], v[170:171], v[162:163]
  v_cvt_pk_bf16_f32 v178, v160, v161
  v_cvt_pk_bf16_f32 v179, v162, v163
  ds_write_b64 v180, v[178:179] offset:240
  v_add_f32 v168, v168, v169
  v_add_f32 v170, v170, v171
  v_add_f32 v168, v168, v170
  v_mov_b32 v169, v168
  s_nop 1
  v_permlane32_swap_b32 v168, v169
  v_add_f32 v168, v168, v169
  v_cmp_gt_u32 vcc, 32, v2
  s_nop 1
  v_cndmask_b32 v168, v168, v164, vcc
  s_lshl_b32 s42, s37, 7
  v_add_u32 v12, s42, v12
  v_lshlrev_b32 v12, 2, v12
  v_lshrrev_b32 v13, 5, v2
  v_lshl_add_u32 v12, v13, 12, v12
  s_lshl_b32 s42, s51, 3
  s_add_u32 s42, s42, s38
  s_lshl_b32 s42, s42, 13
  buffer_store_dword v168, v12, s[20:23], s42 offen sc1
  s_waitcnt lgkmcnt(0)
  s_barrier
  s_branch P2_S_STORE
P2_S_LOADER:
  s_sub_u32 s36, s36, 4
  v_lshrrev_b32 v8, 3, v2
  v_lshrrev_b32 v9, 4, v2
  s_and_b32 s42, s36, 1
  s_lshl_b32 s42, s42, 2
  v_add_u32 v9, s42, v9
  v_and_b32 v10, 7, v2
  v_xor_b32 v10, v10, v9
  v_lshlrev_b32 v10, 4, v10
  v_mul_u32_u24 v8, 3072, v8
  v_add_u32 v3, v8, v10
  s_lshl_b32 s45, s38, 7
  s_lshl_b32 s42, s36, 3
  s_add_u32 s45, s45, s42
  s_mul_i32 s45, s45, 3072
  s_add_u32 s45, s45, 1024
  s_lshl_b32 s46, s37, 7
  s_add_u32 s46, s46, s42
  s_mul_i32 s46, s46, 3072
  s_lshl_b32 s48, s36, 10
  s_barrier
  s_mov_b32 s40, 0
  s_mul_i32 s42, s39, 128
  s_add_u32 s42, s42, s46
  s_add_u32 s43, s40, s48
  s_add_u32 m0, s43, 16384
  s_nop 0
  buffer_load_dwordx4 v3, s[8:11], s42 offen sc1 lds
  s_add_u32 m0, s43, 20480
  s_add_u32 s44, s42, 98304
  buffer_load_dwordx4 v3, s[8:11], s44 offen sc1 lds
  s_add_u32 m0, s43, 24576
  s_add_u32 s44, s42, 196608
  buffer_load_dwordx4 v3, s[8:11], s44 offen sc1 lds
  s_add_u32 m0, s43, 28672
  s_add_u32 s44, s42, 294912
  buffer_load_dwordx4 v3, s[8:11], s44 offen sc1 lds
  s_mul_i32 s42, s39, 128
  s_add_u32 s42, s42, s45
  s_add_u32 s43, s40, s48
  s_mov_b32 m0, s43
  s_nop 0
  buffer_load_dwordx4 v3, s[8:11], s42 offen sc1 lds
  s_add_u32 m0, s43, 4096
  s_add_u32 s44, s42, 98304
  buffer_load_dwordx4 v3, s[8:11], s44 offen sc1 lds
  s_add_u32 m0, s43, 8192
  s_add_u32 s44, s42, 196608
  buffer_load_dwordx4 v3, s[8:11], s44 offen sc1 lds
  s_add_u32 m0, s43, 12288
  s_add_u32 s44, s42, 294912
  buffer_load_dwordx4 v3, s[8:11], s44 offen sc1 lds
  s_add_u32 s39, s39, 1
  s_and_b32 s39, s39, 7
  s_add_u32 s40, s40, 32768
  s_cmp_eq_u32 s40, 163840
  s_cselect_b32 s40, 0, s40
  s_mul_i32 s42, s39, 128
  s_add_u32 s42, s42, s46
  s_add_u32 s43, s40, s48
  s_add_u32 m0, s43, 16384
  s_nop 0
  buffer_load_dwordx4 v3, s[8:11], s42 offen sc1 lds
  s_add_u32 m0, s43, 20480
  s_add_u32 s44, s42, 98304
  buffer_load_dwordx4 v3, s[8:11], s44 offen sc1 lds
  s_add_u32 m0, s43, 24576
  s_add_u32 s44, s42, 196608
  buffer_load_dwordx4 v3, s[8:11], s44 offen sc1 lds
  s_add_u32 m0, s43, 28672
  s_add_u32 s44, s42, 294912
  buffer_load_dwordx4 v3, s[8:11], s44 offen sc1 lds
  s_mul_i32 s42, s39, 128
  s_add_u32 s42, s42, s45
  s_add_u32 s43, s40, s48
  s_mov_b32 m0, s43
  s_nop 0
  buffer_load_dwordx4 v3, s[8:11], s42 offen sc1 lds
  s_add_u32 m0, s43, 4096
  s_add_u32 s44, s42, 98304
  buffer_load_dwordx4 v3, s[8:11], s44 offen sc1 lds
  s_add_u32 m0, s43, 8192
  s_add_u32 s44, s42, 196608
  buffer_load_dwordx4 v3, s[8:11], s44 offen sc1 lds
  s_add_u32 m0, s43, 12288
  s_add_u32 s44, s42, 294912
  buffer_load_dwordx4 v3, s[8:11], s44 offen sc1 lds
  s_add_u32 s39, s39, 1
  s_and_b32 s39, s39, 7
  s_add_u32 s40, s40, 32768
  s_cmp_eq_u32 s40, 163840
  s_cselect_b32 s40, 0, s40
  s_mul_i32 s42, s39, 128
  s_add_u32 s42, s42, s46
  s_add_u32 s43, s40, s48
  s_add_u32 m0, s43, 16384
  s_nop 0
  buffer_load_dwordx4 v3, s[8:11], s42 offen sc1 lds
  s_add_u32 m0, s43, 20480
  s_add_u32 s44, s42, 98304
  buffer_load_dwordx4 v3, s[8:11], s44 offen sc1 lds
  s_add_u32 m0, s43, 24576
  s_add_u32 s44, s42, 196608
  buffer_load_dwordx4 v3, s[8:11], s44 offen sc1 lds
  s_add_u32 m0, s43, 28672
  s_add_u32 s44, s42, 294912
  buffer_load_dwordx4 v3, s[8:11], s44 offen sc1 lds
  s_mul_i32 s42, s39, 128
  s_add_u32 s42, s42, s45
  s_add_u32 s43, s40, s48
  s_mov_b32 m0, s43
  s_nop 0
  buffer_load_dwordx4 v3, s[8:11], s42 offen sc1 lds
  s_add_u32 m0, s43, 4096
  s_add_u32 s44, s42, 98304
  buffer_load_dwordx4 v3, s[8:11], s44 offen sc1 lds
  s_add_u32 m0, s43, 8192
  s_add_u32 s44, s42, 196608
  buffer_load_dwordx4 v3, s[8:11], s44 offen sc1 lds
  s_add_u32 m0, s43, 12288
  s_add_u32 s44, s42, 294912
  buffer_load_dwordx4 v3, s[8:11], s44 offen sc1 lds
  s_add_u32 s39, s39, 1
  s_and_b32 s39, s39, 7
  s_add_u32 s40, s40, 32768
  s_cmp_eq_u32 s40, 163840
  s_cselect_b32 s40, 0, s40
  s_waitcnt vmcnt(16)
  s_barrier
  s_mov_b32 s41, 5
p2_LD_st_4:
  s_mul_i32 s42, s39, 128
  s_add_u32 s42, s42, s46
  s_add_u32 s43, s40, s48
  s_add_u32 m0, s43, 16384
  s_nop 0
  buffer_load_dwordx4 v3, s[8:11], s42 offen sc1 lds
  s_add_u32 m0, s43, 20480
  s_add_u32 s44, s42, 98304
  buffer_load_dwordx4 v3, s[8:11], s44 offen sc1 lds
  s_add_u32 m0, s43, 24576
  s_add_u32 s44, s42, 196608
  buffer_load_dwordx4 v3, s[8:11], s44 offen sc1 lds
  s_add_u32 m0, s43, 28672
  s_add_u32 s44, s42, 294912
  buffer_load_dwordx4 v3, s[8:11], s44 offen sc1 lds
  s_mul_i32 s42, s39, 128
  s_add_u32 s42, s42, s45
  s_add_u32 s43, s40, s48
  s_mov_b32 m0, s43
  s_nop 0
  buffer_load_dwordx4 v3, s[8:11], s42 offen sc1 lds
  s_add_u32 m0, s43, 4096
  s_add_u32 s44, s42, 98304
  buffer_load_dwordx4 v3, s[8:11], s44 offen sc1 lds
  s_add_u32 m0, s43, 8192
  s_add_u32 s44, s42, 196608
  buffer_load_dwordx4 v3, s[8:11], s44 offen sc1 lds
  s_add_u32 m0, s43, 12288
  s_add_u32 s44, s42, 294912
  buffer_load_dwordx4 v3, s[8:11], s44 offen sc1 lds
  s_add_u32 s39, s39, 1
  s_and_b32 s39, s39, 7
  s_add_u32 s40, s40, 32768
  s_cmp_eq_u32 s40, 163840
  s_cselect_b32 s40, 0, s40
  s_waitcnt vmcnt(16)
  s_barrier
  s_sub_u32 s41, s41, 1
  s_cmp_lg_u32 s41, 0
  s_cbranch_scc1 p2_LD_st_4
  s_waitcnt vmcnt(8)
  s_barrier
  s_waitcnt vmcnt(0)
  s_barrier
  s_barrier
  s_barrier
P2_S_STORE:
  s_lshl_b32 s43, s37, 18
  s_lshl_b32 s44, s38, 8
  s_add_u32 s43, s43, s44
  v_add_u32 v3, 0, v0
  v_lshrrev_b32 v4, 4, v3
  v_and_b32 v5, 15, v3
  v_lshlrev_b32 v5, 4, v5
  v_mul_u32_u24 v6, 272, v4
  v_add_u32 v6, v6, v5
  ds_read_b128 v[8:11], v6
  v_lshl_add_u32 v40, v4, 11, v5
  v_add_u32 v3, 512, v0
  v_lshrrev_b32 v4, 4, v3
  v_and_b32 v5, 15, v3
  v_lshlrev_b32 v5, 4, v5
  v_mul_u32_u24 v6, 272, v4
  v_add_u32 v6, v6, v5
  ds_read_b128 v[12:15], v6
  v_lshl_add_u32 v41, v4, 11, v5
  v_add_u32 v3, 1024, v0
  v_lshrrev_b32 v4, 4, v3
  v_and_b32 v5, 15, v3
  v_lshlrev_b32 v5, 4, v5
  v_mul_u32_u24 v6, 272, v4
  v_add_u32 v6, v6, v5
  ds_read_b128 v[16:19], v6
  v_lshl_add_u32 v42, v4, 11, v5
  v_add_u32 v3, 1536, v0
  v_lshrrev_b32 v4, 4, v3
  v_and_b32 v5, 15, v3
  v_lshlrev_b32 v5, 4, v5
  v_mul_u32_u24 v6, 272, v4
  v_add_u32 v6, v6, v5
  ds_read_b128 v[20:23], v6
  v_lshl_add_u32 v43, v4, 11, v5
  s_waitcnt lgkmcnt(0)
  buffer_store_dwordx4 v[8:11], v40, s[16:19], s43 offen sc1
  buffer_store_dwordx4 v[12:15], v41, s[16:19], s43 offen sc1
  buffer_store_dwordx4 v[16:19], v42, s[16:19], s43 offen sc1
  buffer_store_dwordx4 v[20:23], v43, s[16:19], s43 offen sc1
  s_branch P2_FIN
P2_VROLE:
  s_cmp_ge_u32 s50, 24
  s_cbranch_scc1 P2_ZROLE
  s_sub_u32 s50, s50, 16
  s_lshr_b32 s42, s50, 2
  s_lshl_b32 s37, s47, 1
  s_add_u32 s37, s37, s42
  s_and_b32 s38, s50, 3
  s_mov_b32 s39, s50
  s_mov_b32 s39, 0
  s_mov_b32 s8, s4
  s_mov_b32 s9, s5
  s_mov_b32 s10, 6144000
  s_mov_b32 s11, 0x20000
  s_mov_b32 s12, s6
  s_mov_b32 s13, s7
  s_mov_b32 s14, 524288
  s_mov_b32 s15, 0x20000
  s_add_u32 s16, s4, 15728640
  s_addc_u32 s17, s5, 0
  s_mov_b32 s18, 2048000
  s_mov_b32 s19, 0x20000
  s_lshl_b32 s101, s37, 2
  s_add_u32 s101, s101, s38
  s_add_u32 s101, s101, 128
  s_cmp_ge_u32 s36, 4
  s_cbranch_scc1 P2_V_LOADER
  s_and_b32 s24, s36, 1
  s_lshl_b32 s24, s24, 1
  s_lshr_b32 s25, s36, 1
  s_lshl_b32 s25, s25, 1
  v_and_b32 v10, 31, v2
  v_lshrrev_b32 v11, 5, v2
  v_lshrrev_b32 v12, 1, v10
  v_and_b32 v12, 7, v12
  v_lshlrev_b32 v13, 7, v10
  s_lshl_b32 s42, s25, 12
  v_add_u32 v13, s42, v13
  v_add_u32 v14, 0, v11
  v_xor_b32 v14, v14, v12
  v_lshl_add_u32 v3, v14, 4, v13
  v_add_u32 v14, 2, v11
  v_xor_b32 v14, v14, v12
  v_lshl_add_u32 v4, v14, 4, v13
  v_add_u32 v14, 4, v11
  v_xor_b32 v14, v14, v12
  v_lshl_add_u32 v5, v14, 4, v13
  v_add_u32 v14, 6, v11
  v_xor_b32 v14, v14, v12
  v_lshl_add_u32 v6, v14, 4, v13
  v_lshrrev_b32 v10, 5, v2
  v_lshlrev_b32 v10, 3, v10
  v_bfe_u32 v11, v2, 2, 2
  v_add_u32 v10, v10, v11
  v_bfe_u32 v12, v2, 4, 1
  v_lshlrev_b32 v12, 5, v12
  v_and_b32 v13, 3, v2
  v_lshl_add_u32 v12, v13, 3, v12
  v_lshlrev_b32 v13, 8, v10
  v_add_u32 v13, v13, v12
  v_add_u32 v13, 16384, v13
  v_bfe_u32 v14, v2, 2, 2
  v_xor_b32 v14, s24, v14
  v_lshlrev_b32 v14, 6, v14
  v_add_u32 v7, v13, v14
  s_add_u32 s43, s24, 1
  v_lshrrev_b32 v10, 5, v2
  v_lshlrev_b32 v10, 3, v10
  v_bfe_u32 v11, v2, 2, 2
  v_add_u32 v10, v10, v11
  v_bfe_u32 v12, v2, 4, 1
  v_lshlrev_b32 v12, 5, v12
  v_and_b32 v13, 3, v2
  v_lshl_add_u32 v12, v13, 3, v12
  v_lshlrev_b32 v13, 8, v10
  v_add_u32 v13, v13, v12
  v_add_u32 v13, 16384, v13
  v_bfe_u32 v14, v2, 2, 2
  v_xor_b32 v14, s43, v14
  v_lshlrev_b32 v14, 6, v14
  v_add_u32 v8, v13, v14
  s_mov_b32 s53, 0
  s_mov_b32 s56, 4294836224
  s_mov_b32 s57, 32768
  v_mov_b32 v84, 0
  v_mov_b32 v85, 0
  v_mov_b32 v86, 0
  v_mov_b32 v87, 0
  v_mov_b32 v88, 0
  v_mov_b32 v89, 0
  v_mov_b32 v90, 0
  v_mov_b32 v91, 0
  v_mov_b32 v92, 0
  v_mov_b32 v93, 0
  v_mov_b32 v94, 0
  v_mov_b32 v95, 0
  v_mov_b32 v96, 0
  v_mov_b32 v97, 0
  v_mov_b32 v98, 0
  v_mov_b32 v99, 0
  v_mov_b32 v100, 0
  v_mov_b32 v101, 0
  v_mov_b32 v102, 0
  v_mov_b32 v103, 0
  v_mov_b32 v104, 0
  v_mov_b32 v105, 0
  v_mov_b32 v106, 0
  v_mov_b32 v107, 0
  v_mov_b32 v108, 0
  v_mov_b32 v109, 0
  v_mov_b32 v110, 0
  v_mov_b32 v111, 0
  v_mov_b32 v112, 0
  v_mov_b32 v113, 0
  v_mov_b32 v114, 0
  v_mov_b32 v115, 0
  v_mov_b32 v116, 0
  v_mov_b32 v117, 0
  v_mov_b32 v118, 0
  v_mov_b32 v119, 0
  v_mov_b32 v120, 0
  v_mov_b32 v121, 0
  v_mov_b32 v122, 0
  v_mov_b32 v123, 0
  v_mov_b32 v124, 0
  v_mov_b32 v125, 0
  v_mov_b32 v126, 0
  v_mov_b32 v127, 0
  v_mov_b32 v128, 0
  v_mov_b32 v129, 0
  v_mov_b32 v130, 0
  v_mov_b32 v131, 0
  v_mov_b32 v132, 0
  v_mov_b32 v133, 0
  v_mov_b32 v134, 0
  v_mov_b32 v135, 0
  v_mov_b32 v136, 0
  v_mov_b32 v137, 0
  v_mov_b32 v138, 0
  v_mov_b32 v139, 0
  v_mov_b32 v140, 0
  v_mov_b32 v141, 0
  v_mov_b32 v142, 0
  v_mov_b32 v143, 0
  v_mov_b32 v144, 0
  v_mov_b32 v145, 0
  v_mov_b32 v146, 0
  v_mov_b32 v147, 0
  s_cmp_lg_u32 s58, 0
  s_cbranch_scc1 p2_gwd_5
  v_min_u32 v11, 5, v2
  s_lshl_b32 s96, s37, 4
  s_add_u32 s96, s96, 10
  v_add_u32 v10, s96, v11
  v_lshlrev_b32 v10, 7, v10
  s_mov_b32 s97, 0
  s_mov_b32 s96, 0x200000
p2_gw_6:
  buffer_load_dword v11, v10, s[92:95], s97 offen sc1
  s_waitcnt vmcnt(0)
  v_cmp_ne_u32 vcc, s3, v11
  s_sub_u32 s96, s96, 1
  s_cmp_eq_u32 s96, 0
  s_cbranch_scc1 p2_gwd_5
  s_nop 1
  s_cbranch_vccnz p2_gw_6
p2_gwd_5:
  s_barrier
  s_barrier
  ds_read_b128 v[20:23], v3
  ds_read_b64_tr_b16 v[52:53], v7 offset:0
  ds_read_b64_tr_b16 v[54:55], v7 offset:1024
  ds_read_b128 v[24:27], v3 offset:4096
  ds_read_b64_tr_b16 v[56:57], v8 offset:0
  ds_read_b64_tr_b16 v[58:59], v8 offset:1024
  ds_read_b128 v[28:31], v4
  ds_read_b64_tr_b16 v[60:61], v7 offset:4096
  ds_read_b64_tr_b16 v[62:63], v7 offset:5120
  ds_read_b128 v[32:35], v4 offset:4096
  ds_read_b64_tr_b16 v[64:65], v8 offset:4096
  ds_read_b64_tr_b16 v[66:67], v8 offset:5120
  s_mov_b32 s41, 7
p2_V_loop_7:
  s_waitcnt lgkmcnt(9)
  v_mfma_f32_32x32x16_bf16 v[84:99], v[52:55], v[20:23], v[84:99]
  ds_read_b128 v[36:39], v5
  ds_read_b64_tr_b16 v[68:69], v7 offset:8192
  s_waitcnt lgkmcnt(10)
  v_mfma_f32_32x32x16_bf16 v[100:115], v[52:55], v[24:27], v[100:115]
  ds_read_b64_tr_b16 v[70:71], v7 offset:9216
  ds_read_b128 v[40:43], v5 offset:4096
  s_waitcnt lgkmcnt(10)
  v_mfma_f32_32x32x16_bf16 v[116:131], v[56:59], v[20:23], v[116:131]
  ds_read_b64_tr_b16 v[72:73], v8 offset:8192
  ds_read_b64_tr_b16 v[74:75], v8 offset:9216
  s_waitcnt lgkmcnt(12)
  v_mfma_f32_32x32x16_bf16 v[132:147], v[56:59], v[24:27], v[132:147]
  s_waitcnt lgkmcnt(9)
  v_mfma_f32_32x32x16_bf16 v[84:99], v[60:63], v[28:31], v[84:99]
  ds_read_b128 v[44:47], v6
  ds_read_b64_tr_b16 v[76:77], v7 offset:12288
  s_waitcnt lgkmcnt(10)
  v_mfma_f32_32x32x16_bf16 v[100:115], v[60:63], v[32:35], v[100:115]
  ds_read_b64_tr_b16 v[78:79], v7 offset:13312
  ds_read_b128 v[48:51], v6 offset:4096
  s_waitcnt lgkmcnt(10)
  v_mfma_f32_32x32x16_bf16 v[116:131], v[64:67], v[28:31], v[116:131]
  ds_read_b64_tr_b16 v[80:81], v8 offset:12288
  ds_read_b64_tr_b16 v[82:83], v8 offset:13312
  s_waitcnt lgkmcnt(12)
  v_mfma_f32_32x32x16_bf16 v[132:147], v[64:67], v[32:35], v[132:147]
  s_barrier
  s_add_u32 s53, s53, 32768
  s_cmp_eq_u32 s53, 163840
  s_cselect_b32 s52, s56, s57
  s_cselect_b32 s53, 0, s53
  v_add_u32 v3, s52, v3
  v_add_u32 v4, s52, v4
  v_add_u32 v5, s52, v5
  v_add_u32 v6, s52, v6
  v_add_u32 v7, s52, v7
  v_add_u32 v8, s52, v8
  s_waitcnt lgkmcnt(9)
  v_mfma_f32_32x32x16_bf16 v[84:99], v[68:71], v[36:39], v[84:99]
  ds_read_b128 v[20:23], v3
  ds_read_b64_tr_b16 v[52:53], v7 offset:0
  s_waitcnt lgkmcnt(10)
  v_mfma_f32_32x32x16_bf16 v[100:115], v[68:71], v[40:43], v[100:115]
  ds_read_b64_tr_b16 v[54:55], v7 offset:1024
  ds_read_b128 v[24:27], v3 offset:4096
  s_waitcnt lgkmcnt(10)
  v_mfma_f32_32x32x16_bf16 v[116:131], v[72:75], v[36:39], v[116:131]
  ds_read_b64_tr_b16 v[56:57], v8 offset:0
  ds_read_b64_tr_b16 v[58:59], v8 offset:1024
  s_waitcnt lgkmcnt(12)
  v_mfma_f32_32x32x16_bf16 v[132:147], v[72:75], v[40:43], v[132:147]
  s_waitcnt lgkmcnt(9)
  v_mfma_f32_32x32x16_bf16 v[84:99], v[76:79], v[44:47], v[84:99]
  ds_read_b128 v[28:31], v4
  ds_read_b64_tr_b16 v[60:61], v7 offset:4096
  s_waitcnt lgkmcnt(10)
  v_mfma_f32_32x32x16_bf16 v[100:115], v[76:79], v[48:51], v[100:115]
  ds_read_b64_tr_b16 v[62:63], v7 offset:5120
  ds_read_b128 v[32:35], v4 offset:4096
  s_waitcnt lgkmcnt(10)
  v_mfma_f32_32x32x16_bf16 v[116:131], v[80:83], v[44:47], v[116:131]
  ds_read_b64_tr_b16 v[64:65], v8 offset:4096
  ds_read_b64_tr_b16 v[66:67], v8 offset:5120
  s_waitcnt lgkmcnt(12)
  v_mfma_f32_32x32x16_bf16 v[132:147], v[80:83], v[48:51], v[132:147]
  s_sub_u32 s41, s41, 1
  s_cmp_lg_u32 s41, 0
  s_cbranch_scc1 p2_V_loop_7
  s_waitcnt lgkmcnt(9)
  v_mfma_f32_32x32x16_bf16 v[84:99], v[52:55], v[20:23], v[84:99]
  ds_read_b128 v[36:39], v5
  ds_read_b64_tr_b16 v[68:69], v7 offset:8192
  s_waitcnt lgkmcnt(10)
  v_mfma_f32_32x32x16_bf16 v[100:115], v[52:55], v[24:27], v[100:115]
  ds_read_b64_tr_b16 v[70:71], v7 offset:9216
  ds_read_b128 v[40:43], v5 offset:4096
  s_waitcnt lgkmcnt(10)
  v_mfma_f32_32x32x16_bf16 v[116:131], v[56:59], v[20:23], v[116:131]
  ds_read_b64_tr_b16 v[72:73], v8 offset:8192
  ds_read_b64_tr_b16 v[74:75], v8 offset:9216
  s_waitcnt lgkmcnt(12)
  v_mfma_f32_32x32x16_bf16 v[132:147], v[56:59], v[24:27], v[132:147]
  s_waitcnt lgkmcnt(9)
  v_mfma_f32_32x32x16_bf16 v[84:99], v[60:63], v[28:31], v[84:99]
  ds_read_b128 v[44:47], v6
  ds_read_b64_tr_b16 v[76:77], v7 offset:12288
  s_waitcnt lgkmcnt(10)
  v_mfma_f32_32x32x16_bf16 v[100:115], v[60:63], v[32:35], v[100:115]
  ds_read_b64_tr_b16 v[78:79], v7 offset:13312
  ds_read_b128 v[48:51], v6 offset:4096
  s_waitcnt lgkmcnt(10)
  v_mfma_f32_32x32x16_bf16 v[116:131], v[64:67], v[28:31], v[116:131]
  ds_read_b64_tr_b16 v[80:81], v8 offset:12288
  ds_read_b64_tr_b16 v[82:83], v8 offset:13312
  s_waitcnt lgkmcnt(12)
  v_mfma_f32_32x32x16_bf16 v[132:147], v[64:67], v[32:35], v[132:147]
  s_waitcnt lgkmcnt(9)
  v_mfma_f32_32x32x16_bf16 v[84:99], v[68:71], v[36:39], v[84:99]
  s_waitcnt lgkmcnt(8)
  v_mfma_f32_32x32x16_bf16 v[100:115], v[68:71], v[40:43], v[100:115]
  s_waitcnt lgkmcnt(6)
  v_mfma_f32_32x32x16_bf16 v[116:131], v[72:75], v[36:39], v[116:131]
  s_waitcnt lgkmcnt(6)
  v_mfma_f32_32x32x16_bf16 v[132:147], v[72:75], v[40:43], v[132:147]
  s_waitcnt lgkmcnt(3)
  v_mfma_f32_32x32x16_bf16 v[84:99], v[76:79], v[44:47], v[84:99]
  s_waitcnt lgkmcnt(2)
  v_mfma_f32_32x32x16_bf16 v[100:115], v[76:79], v[48:51], v[100:115]
  s_waitcnt lgkmcnt(0)
  v_mfma_f32_32x32x16_bf16 v[116:131], v[80:83], v[44:47], v[116:131]
  s_waitcnt lgkmcnt(0)
  v_mfma_f32_32x32x16_bf16 v[132:147], v[80:83], v[48:51], v[132:147]
  v_and_b32 v10, 31, v2
  s_lshl_b32 s42, s25, 5
  v_add_u32 v10, s42, v10
  v_mul_u32_u24 v152, 272, v10
  s_lshl_b32 s42, s24, 6
  v_add_u32 v152, s42, v152
  v_lshrrev_b32 v11, 5, v2
  v_lshl_add_u32 v152, v11, 3, v152
  s_barrier
  v_cvt_pk_bf16_f32 v148, v84, v85
  v_cvt_pk_bf16_f32 v149, v86, v87
  ds_write_b64 v152, v[148:149] offset:0
  v_cvt_pk_bf16_f32 v150, v88, v89
  v_cvt_pk_bf16_f32 v151, v90, v91
  ds_write_b64 v152, v[150:151] offset:16
  v_cvt_pk_bf16_f32 v148, v92, v93
  v_cvt_pk_bf16_f32 v149, v94, v95
  ds_write_b64 v152, v[148:149] offset:32
  v_cvt_pk_bf16_f32 v150, v96, v97
  v_cvt_pk_bf16_f32 v151, v98, v99
  ds_write_b64 v152, v[150:151] offset:48
  v_cvt_pk_bf16_f32 v148, v100, v101
  v_cvt_pk_bf16_f32 v149, v102, v103
  ds_write_b64 v152, v[148:149] offset:8704
  v_cvt_pk_bf16_f32 v150, v104, v105
  v_cvt_pk_bf16_f32 v151, v106, v107
  ds_write_b64 v152, v[150:151] offset:8720
  v_cvt_pk_bf16_f32 v148, v108, v109
  v_cvt_pk_bf16_f32 v149, v110, v111
  ds_write_b64 v152, v[148:149] offset:8736
  v_cvt_pk_bf16_f32 v150, v112, v113
  v_cvt_pk_bf16_f32 v151, v114, v115
  ds_write_b64 v152, v[150:151] offset:8752
  v_cvt_pk_bf16_f32 v148, v116, v117
  v_cvt_pk_bf16_f32 v149, v118, v119
  ds_write_b64 v152, v[148:149] offset:64
  v_cvt_pk_bf16_f32 v150, v120, v121
  v_cvt_pk_bf16_f32 v151, v122, v123
  ds_write_b64 v152, v[150:151] offset:80
  v_cvt_pk_bf16_f32 v148, v124, v125
  v_cvt_pk_bf16_f32 v149, v126, v127
  ds_write_b64 v152, v[148:149] offset:96
  v_cvt_pk_bf16_f32 v150, v128, v129
  v_cvt_pk_bf16_f32 v151, v130, v131
  ds_write_b64 v152, v[150:151] offset:112
  v_cvt_pk_bf16_f32 v148, v132, v133
  v_cvt_pk_bf16_f32 v149, v134, v135
  ds_write_b64 v152, v[148:149] offset:8768
  v_cvt_pk_bf16_f32 v150, v136, v137
  v_cvt_pk_bf16_f32 v151, v138, v139
  ds_write_b64 v152, v[150:151] offset:8784
  v_cvt_pk_bf16_f32 v148, v140, v141
  v_cvt_pk_bf16_f32 v149, v142, v143
  ds_write_b64 v152, v[148:149] offset:8800
  v_cvt_pk_bf16_f32 v150, v144, v145
  v_cvt_pk_bf16_f32 v151, v146, v147
  ds_write_b64 v152, v[150:151] offset:8816
  s_waitcnt lgkmcnt(0)
  s_barrier
  s_branch P2_V_STORE
P2_V_LOADER:
  s_sub_u32 s36, s36, 4
  v_lshrrev_b32 v8, 3, v2
  v_lshrrev_b32 v9, 4, v2
  s_and_b32 s42, s36, 1
  s_lshl_b32 s42, s42, 2
  v_add_u32 v9, s42, v9
  v_and_b32 v10, 7, v2
  v_xor_b32 v10, v10, v9
  v_lshlrev_b32 v10, 4, v10
  v_mul_u32_u24 v8, 3072, v8
  v_add_u32 v3, v8, v10
  v_lshrrev_b32 v8, 4, v2
  v_lshlrev_b32 v9, 2, v8
  v_and_b32 v10, 15, v2
  v_xor_b32 v10, v10, v9
  v_lshlrev_b32 v10, 4, v10
  v_mul_u32_u24 v8, 1024, v8
  v_add_u32 v4, v8, v10
  s_lshl_b32 s45, s37, 7
  s_lshl_b32 s42, s36, 3
  s_add_u32 s45, s45, s42
  s_mul_i32 s45, s45, 3072
  s_add_u32 s45, s45, 2048
  s_lshl_b32 s46, s36, 14
  s_lshl_b32 s42, s38, 8
  s_add_u32 s46, s46, s42
  s_lshl_b32 s48, s36, 10
  s_lshl_b32 s49, s36, 12
  s_add_u32 s49, s49, 16384
  s_barrier
  s_mov_b32 s40, 0
  s_mul_i32 s42, s39, 128
  s_add_u32 s42, s42, s45
  s_add_u32 s43, s40, s48
  s_mov_b32 m0, s43
  s_nop 0
  buffer_load_dwordx4 v3, s[8:11], s42 offen sc1 lds
  s_add_u32 m0, s43, 4096
  s_add_u32 s44, s42, 98304
  buffer_load_dwordx4 v3, s[8:11], s44 offen sc1 lds
  s_add_u32 m0, s43, 8192
  s_add_u32 s44, s42, 196608
  buffer_load_dwordx4 v3, s[8:11], s44 offen sc1 lds
  s_add_u32 m0, s43, 12288
  s_add_u32 s44, s42, 294912
  buffer_load_dwordx4 v3, s[8:11], s44 offen sc1 lds
  s_mul_i32 s42, s39, 65536
  s_add_u32 s42, s42, s46
  s_add_u32 s43, s40, s49
  s_mov_b32 m0, s43
  s_nop 0
  buffer_load_dwordx4 v4, s[12:15], s42 offen  lds
  s_add_u32 m0, s43, 1024
  s_add_u32 s44, s42, 4096
  buffer_load_dwordx4 v4, s[12:15], s44 offen  lds
  s_add_u32 m0, s43, 2048
  s_add_u32 s44, s42, 8192
  buffer_load_dwordx4 v4, s[12:15], s44 offen  lds
  s_add_u32 m0, s43, 3072
  s_add_u32 s44, s42, 12288
  buffer_load_dwordx4 v4, s[12:15], s44 offen  lds
  s_add_u32 s39, s39, 1
  s_and_b32 s39, s39, 7
  s_add_u32 s40, s40, 32768
  s_cmp_eq_u32 s40, 163840
  s_cselect_b32 s40, 0, s40
  s_mul_i32 s42, s39, 128
  s_add_u32 s42, s42, s45
  s_add_u32 s43, s40, s48
  s_mov_b32 m0, s43
  s_nop 0
  buffer_load_dwordx4 v3, s[8:11], s42 offen sc1 lds
  s_add_u32 m0, s43, 4096
  s_add_u32 s44, s42, 98304
  buffer_load_dwordx4 v3, s[8:11], s44 offen sc1 lds
  s_add_u32 m0, s43, 8192
  s_add_u32 s44, s42, 196608
  buffer_load_dwordx4 v3, s[8:11], s44 offen sc1 lds
  s_add_u32 m0, s43, 12288
  s_add_u32 s44, s42, 294912
  buffer_load_dwordx4 v3, s[8:11], s44 offen sc1 lds
  s_mul_i32 s42, s39, 65536
  s_add_u32 s42, s42, s46
  s_add_u32 s43, s40, s49
  s_mov_b32 m0, s43
  s_nop 0
  buffer_load_dwordx4 v4, s[12:15], s42 offen  lds
  s_add_u32 m0, s43, 1024
  s_add_u32 s44, s42, 4096
  buffer_load_dwordx4 v4, s[12:15], s44 offen  lds
  s_add_u32 m0, s43, 2048
  s_add_u32 s44, s42, 8192
  buffer_load_dwordx4 v4, s[12:15], s44 offen  lds
  s_add_u32 m0, s43, 3072
  s_add_u32 s44, s42, 12288
  buffer_load_dwordx4 v4, s[12:15], s44 offen  lds
  s_add_u32 s39, s39, 1
  s_and_b32 s39, s39, 7
  s_add_u32 s40, s40, 32768
  s_cmp_eq_u32 s40, 163840
  s_cselect_b32 s40, 0, s40
  s_mul_i32 s42, s39, 128
  s_add_u32 s42, s42, s45
  s_add_u32 s43, s40, s48
  s_mov_b32 m0, s43
  s_nop 0
  buffer_load_dwordx4 v3, s[8:11], s42 offen sc1 lds
  s_add_u32 m0, s43, 4096
  s_add_u32 s44, s42, 98304
  buffer_load_dwordx4 v3, s[8:11], s44 offen sc1 lds
  s_add_u32 m0, s43, 8192
  s_add_u32 s44, s42, 196608
  buffer_load_dwordx4 v3, s[8:11], s44 offen sc1 lds
  s_add_u32 m0, s43, 12288
  s_add_u32 s44, s42, 294912
  buffer_load_dwordx4 v3, s[8:11], s44 offen sc1 lds
  s_mul_i32 s42, s39, 65536
  s_add_u32 s42, s42, s46
  s_add_u32 s43, s40, s49
  s_mov_b32 m0, s43
  s_nop 0
  buffer_load_dwordx4 v4, s[12:15], s42 offen  lds
  s_add_u32 m0, s43, 1024
  s_add_u32 s44, s42, 4096
  buffer_load_dwordx4 v4, s[12:15], s44 offen  lds
  s_add_u32 m0, s43, 2048
  s_add_u32 s44, s42, 8192
  buffer_load_dwordx4 v4, s[12:15], s44 offen  lds
  s_add_u32 m0, s43, 3072
  s_add_u32 s44, s42, 12288
  buffer_load_dwordx4 v4, s[12:15], s44 offen  lds
  s_add_u32 s39, s39, 1
  s_and_b32 s39, s39, 7
  s_add_u32 s40, s40, 32768
  s_cmp_eq_u32 s40, 163840
  s_cselect_b32 s40, 0, s40
  s_waitcnt vmcnt(16)
  s_barrier
  s_mov_b32 s41, 5
p2_LD_st_8:
  s_mul_i32 s42, s39, 128
  s_add_u32 s42, s42, s45
  s_add_u32 s43, s40, s48
  s_mov_b32 m0, s43
  s_nop 0
  buffer_load_dwordx4 v3, s[8:11], s42 offen sc1 lds
  s_add_u32 m0, s43, 4096
  s_add_u32 s44, s42, 98304
  buffer_load_dwordx4 v3, s[8:11], s44 offen sc1 lds
  s_add_u32 m0, s43, 8192
  s_add_u32 s44, s42, 196608
  buffer_load_dwordx4 v3, s[8:11], s44 offen sc1 lds
  s_add_u32 m0, s43, 12288
  s_add_u32 s44, s42, 294912
  buffer_load_dwordx4 v3, s[8:11], s44 offen sc1 lds
  s_mul_i32 s42, s39, 65536
  s_add_u32 s42, s42, s46
  s_add_u32 s43, s40, s49
  s_mov_b32 m0, s43
  s_nop 0
  buffer_load_dwordx4 v4, s[12:15], s42 offen  lds
  s_add_u32 m0, s43, 1024
  s_add_u32 s44, s42, 4096
  buffer_load_dwordx4 v4, s[12:15], s44 offen  lds
  s_add_u32 m0, s43, 2048
  s_add_u32 s44, s42, 8192
  buffer_load_dwordx4 v4, s[12:15], s44 offen  lds
  s_add_u32 m0, s43, 3072
  s_add_u32 s44, s42, 12288
  buffer_load_dwordx4 v4, s[12:15], s44 offen  lds
  s_add_u32 s39, s39, 1
  s_and_b32 s39, s39, 7
  s_add_u32 s40, s40, 32768
  s_cmp_eq_u32 s40, 163840
  s_cselect_b32 s40, 0, s40
  s_waitcnt vmcnt(16)
  s_barrier
  s_sub_u32 s41, s41, 1
  s_cmp_lg_u32 s41, 0
  s_cbranch_scc1 p2_LD_st_8
  s_waitcnt vmcnt(8)
  s_barrier
  s_waitcnt vmcnt(0)
  s_barrier
  s_barrier
  s_barrier
P2_V_STORE:
  s_lshl_b32 s43, s37, 17
  s_lshl_b32 s44, s38, 8
  s_add_u32 s43, s43, s44
  v_add_u32 v3, 0, v0
  v_lshrrev_b32 v4, 4, v3
  v_and_b32 v5, 15, v3
  v_lshlrev_b32 v5, 4, v5
  v_mul_u32_u24 v6, 272, v4
  v_add_u32 v6, v6, v5
  ds_read_b128 v[8:11], v6
  v_lshl_add_u32 v40, v4, 10, v5
  v_add_u32 v3, 512, v0
  v_lshrrev_b32 v4, 4, v3
  v_and_b32 v5, 15, v3
  v_lshlrev_b32 v5, 4, v5
  v_mul_u32_u24 v6, 272, v4
  v_add_u32 v6, v6, v5
  ds_read_b128 v[12:15], v6
  v_lshl_add_u32 v41, v4, 10, v5
  v_add_u32 v3, 1024, v0
  v_lshrrev_b32 v4, 4, v3
  v_and_b32 v5, 15, v3
  v_lshlrev_b32 v5, 4, v5
  v_mul_u32_u24 v6, 272, v4
  v_add_u32 v6, v6, v5
  ds_read_b128 v[16:19], v6
  v_lshl_add_u32 v42, v4, 10, v5
  v_add_u32 v3, 1536, v0
  v_lshrrev_b32 v4, 4, v3
  v_and_b32 v5, 15, v3
  v_lshlrev_b32 v5, 4, v5
  v_mul_u32_u24 v6, 272, v4
  v_add_u32 v6, v6, v5
  ds_read_b128 v[20:23], v6
  v_lshl_add_u32 v43, v4, 10, v5
  s_waitcnt lgkmcnt(0)
  buffer_store_dwordx4 v[8:11], v40, s[16:19], s43 offen sc1
  buffer_store_dwordx4 v[12:15], v41, s[16:19], s43 offen sc1
  buffer_store_dwordx4 v[16:19], v42, s[16:19], s43 offen sc1
  buffer_store_dwordx4 v[20:23], v43, s[16:19], s43 offen sc1
  s_branch P2_FIN
P2_ZROLE:
  s_lshl_b32 s37, s47, 6
  s_sub_u32 s42, s50, 24
  s_lshr_b32 s51, s42, 2
  s_and_b32 s38, s42, 3
  s_lshl_b32 s38, s38, 8
  s_mul_i32 s45, s51, 1000
  s_add_u32 s45, s45, s38
  s_add_u32 s28, s4, 10485760
  s_addc_u32 s29, s5, 0
  s_mov_b32 s30, 131072
  s_mov_b32 s31, 0x20000
  s_add_u32 s24, s4, 6291456
  s_addc_u32 s25, s5, 0
  s_mov_b32 s26, 4194304
  s_mov_b32 s27, 0x20000
  s_add_u32 s20, s4, 17825792
  s_addc_u32 s21, s5, 0
  s_mov_b32 s22, 2097152
  s_mov_b32 s23, 0x20000
  s_mov_b32 s12, s32
  s_mov_b32 s13, s33
  s_mov_b32 s14, 31744
  s_mov_b32 s15, 0x20000
  s_lshl_b32 s101, s47, 3
  s_add_u32 s101, s101, s50
  s_add_u32 s101, s101, 168
  s_cmp_lg_u32 s58, 0
  s_cbranch_scc1 p2_gwd_9
  s_max_u32 s96, s45, 16
  s_sub_u32 s96, s96, 16
  s_lshr_b32 s96, s96, 7
  s_add_u32 s97, s45, 271
  s_lshr_b32 s97, s97, 7
  s_min_u32 s97, s97, 15
  v_min_u32 v9, 35, v2
  v_mul_u32_u24 v10, 7282, v9
  v_lshrrev_b32 v10, 16, v10
  v_mul_u32_u24 v11, 9, v10
  v_sub_u32 v11, v9, v11
  v_add_u32 v10, s96, v10
  v_min_u32 v10, s97, v10
  v_add_u32 v12, 8, v11
  v_mov_b32 v13, s47
  v_cmp_eq_u32 vcc, 8, v11
  s_nop 1
  v_cndmask_b32 v12, v12, v13, vcc
  v_lshl_add_u32 v8, v10, 4, v12
  v_lshlrev_b32 v8, 7, v8
  s_mov_b32 s97, 0
  s_mov_b32 s96, 0x200000
p2_gw_10:
  buffer_load_dword v9, v8, s[92:95], s97 offen sc1
  s_waitcnt vmcnt(0)
  v_cmp_ne_u32 vcc, s3, v9
  s_sub_u32 s96, s96, 1
  s_cmp_eq_u32 s96, 0
  s_cbranch_scc1 p2_gwd_9
  s_nop 1
  s_cbranch_vccnz p2_gw_10
p2_gwd_9:
  s_barrier
  v_mul_u32_u24 v6, 58255, v0
  v_lshrrev_b32 v6, 21, v6
  v_mul_u32_u24 v7, 36, v6
  v_sub_u32 v7, v0, v7
  v_lshlrev_b32 v5, 4, v7
  v_lshlrev_b32 v49, 1, v5
  s_add_u32 s43, s37, 512
  s_lshl_b32 s43, s43, 12
  s_lshl_b32 s44, s45, 1
  s_add_u32 s43, s43, s44
  s_sub_u32 s43, s43, 32
  v_add_u32 v3, 0, v6
  v_lshl_add_u32 v54, v3, 12, v5
  v_mul_u32_u24 v4, 608, v3
  v_add_u32 v44, v4, v5
  v_cmp_gt_u32 vcc, 64, v3
  v_mov_b32 v4, 504
  v_cmp_gt_u32 s[54:55], v4, v0
  s_nop 0
  s_and_b64 vcc, vcc, s[54:55]
  v_cndmask_b32 v54, -1, v54, vcc
  v_mov_b32 v4, 38912
  v_cndmask_b32 v44, v4, v44, vcc
  buffer_load_dwordx4 v[24:27], v54, s[24:27], s43 offen sc1
  v_add_u32 v3, 14, v6
  v_lshl_add_u32 v54, v3, 12, v5
  v_mul_u32_u24 v4, 608, v3
  v_add_u32 v45, v4, v5
  v_cmp_gt_u32 vcc, 64, v3
  v_mov_b32 v4, 504
  v_cmp_gt_u32 s[54:55], v4, v0
  s_nop 0
  s_and_b64 vcc, vcc, s[54:55]
  v_cndmask_b32 v54, -1, v54, vcc
  v_mov_b32 v4, 38912
  v_cndmask_b32 v45, v4, v45, vcc
  buffer_load_dwordx4 v[28:31], v54, s[24:27], s43 offen sc1
  v_add_u32 v3, 28, v6
  v_lshl_add_u32 v54, v3, 12, v5
  v_mul_u32_u24 v4, 608, v3
  v_add_u32 v46, v4, v5
  v_cmp_gt_u32 vcc, 64, v3
  v_mov_b32 v4, 504
  v_cmp_gt_u32 s[54:55], v4, v0
  s_nop 0
  s_and_b64 vcc, vcc, s[54:55]
  v_cndmask_b32 v54, -1, v54, vcc
  v_mov_b32 v4, 38912
  v_cndmask_b32 v46, v4, v46, vcc
  buffer_load_dwordx4 v[32:35], v54, s[24:27], s43 offen sc1
  v_add_u32 v3, 42, v6
  v_lshl_add_u32 v54, v3, 12, v5
  v_mul_u32_u24 v4, 608, v3
  v_add_u32 v47, v4, v5
  v_cmp_gt_u32 vcc, 64, v3
  v_mov_b32 v4, 504
  v_cmp_gt_u32 s[54:55], v4, v0
  s_nop 0
  s_and_b64 vcc, vcc, s[54:55]
  v_cndmask_b32 v54, -1, v54, vcc
  v_mov_b32 v4, 38912
  v_cndmask_b32 v47, v4, v47, vcc
  buffer_load_dwordx4 v[36:39], v54, s[24:27], s43 offen sc1
  v_add_u32 v3, 56, v6
  v_lshl_add_u32 v54, v3, 12, v5
  v_mul_u32_u24 v4, 608, v3
  v_add_u32 v48, v4, v5
  v_cmp_gt_u32 vcc, 64, v3
  v_mov_b32 v4, 504
  v_cmp_gt_u32 s[54:55], v4, v0
  s_nop 0
  s_and_b64 vcc, vcc, s[54:55]
  v_cndmask_b32 v54, -1, v54, vcc
  v_mov_b32 v4, 38912
  v_cndmask_b32 v48, v4, v48, vcc
  buffer_load_dwordx4 v[40:43], v54, s[24:27], s43 offen sc1
  v_add_u32 v3, s38, v0
  v_subrev_u32 v3, 16, v3
  v_cmp_gt_u32 vcc, 1000, v3
  s_nop 0
  s_mov_b64 s[98:99], vcc
  v_add_u32 v4, s45, v0
  v_subrev_u32 v4, 16, v4
  v_lshlrev_b32 v4, 2, v4
  v_cndmask_b32 v4, -1, v4, vcc
  s_mov_b32 s42, 0
  buffer_load_dword v8, v4, s[28:31], s42 offen sc1
  s_mov_b32 s42, 8192
  buffer_load_dword v9, v4, s[28:31], s42 offen sc1
  s_mov_b32 s42, 16384
  buffer_load_dword v10, v4, s[28:31], s42 offen sc1
  s_mov_b32 s42, 24576
  buffer_load_dword v11, v4, s[28:31], s42 offen sc1
  s_mov_b32 s42, 32768
  buffer_load_dword v12, v4, s[28:31], s42 offen sc1
  s_mov_b32 s42, 40960
  buffer_load_dword v13, v4, s[28:31], s42 offen sc1
  s_mov_b32 s42, 49152
  buffer_load_dword v14, v4, s[28:31], s42 offen sc1
  s_mov_b32 s42, 57344
  buffer_load_dword v15, v4, s[28:31], s42 offen sc1
  s_mov_b32 s42, 65536
  buffer_load_dword v16, v4, s[28:31], s42 offen sc1
  s_mov_b32 s42, 73728
  buffer_load_dword v17, v4, s[28:31], s42 offen sc1
  s_mov_b32 s42, 81920
  buffer_load_dword v18, v4, s[28:31], s42 offen sc1
  s_mov_b32 s42, 90112
  buffer_load_dword v19, v4, s[28:31], s42 offen sc1
  s_mov_b32 s42, 98304
  buffer_load_dword v20, v4, s[28:31], s42 offen sc1
  s_mov_b32 s42, 106496
  buffer_load_dword v21, v4, s[28:31], s42 offen sc1
  s_mov_b32 s42, 114688
  buffer_load_dword v22, v4, s[28:31], s42 offen sc1
  s_mov_b32 s42, 122880
  buffer_load_dword v23, v4, s[28:31], s42 offen sc1
  s_lshl_b32 s44, s37, 1
  v_lshrrev_b32 v65, 6, v0
  v_add_u32 v65, 0, v65
  v_and_b32 v66, 63, v0
  v_mul_u32_u24 v67, 1024, v65
  v_lshl_add_u32 v67, v66, 1, v67
  v_cmp_gt_u32 vcc, 31, v65
  s_nop 1
  v_cndmask_b32 v67, -1, v67, vcc
  buffer_load_ushort v68, v67, s[12:15], s44 offen
  v_mul_u32_u24 v66, 388, v66
  v_lshl_add_u32 v72, v65, 1, v66
  v_lshrrev_b32 v65, 6, v0
  v_add_u32 v65, 8, v65
  v_and_b32 v66, 63, v0
  v_mul_u32_u24 v67, 1024, v65
  v_lshl_add_u32 v67, v66, 1, v67
  v_cmp_gt_u32 vcc, 31, v65
  s_nop 1
  v_cndmask_b32 v67, -1, v67, vcc
  buffer_load_ushort v69, v67, s[12:15], s44 offen
  v_mul_u32_u24 v66, 388, v66
  v_lshl_add_u32 v73, v65, 1, v66
  v_lshrrev_b32 v65, 6, v0
  v_add_u32 v65, 16, v65
  v_and_b32 v66, 63, v0
  v_mul_u32_u24 v67, 1024, v65
  v_lshl_add_u32 v67, v66, 1, v67
  v_cmp_gt_u32 vcc, 31, v65
  s_nop 1
  v_cndmask_b32 v67, -1, v67, vcc
  buffer_load_ushort v70, v67, s[12:15], s44 offen
  v_mul_u32_u24 v66, 388, v66
  v_lshl_add_u32 v74, v65, 1, v66
  v_lshrrev_b32 v65, 6, v0
  v_add_u32 v65, 24, v65
  v_and_b32 v66, 63, v0
  v_mul_u32_u24 v67, 1024, v65
  v_lshl_add_u32 v67, v66, 1, v67
  v_cmp_gt_u32 vcc, 31, v65
  s_nop 1
  v_cndmask_b32 v67, -1, v67, vcc
  buffer_load_ushort v71, v67, s[12:15], s44 offen
  v_mul_u32_u24 v66, 388, v66
  v_lshl_add_u32 v75, v65, 1, v66
  v_and_b32 v5, 15, v2
  v_lshlrev_b32 v5, 5, v5
  v_lshrrev_b32 v6, 4, v2
  v_lshl_add_u32 v92, v6, 3, v5
  v_lshrrev_b32 v7, 1, v92
  v_add_u32 v7, s38, v7
  v_cmp_gt_u32 vcc, 1000, v7
  s_nop 1
  v_cndmask_b32 v93, -1, v92, vcc
  s_lshl_b32 s42, s36, 3
  s_add_u32 s42, s42, s37
  s_lshl_b32 s42, s42, 12
  s_lshl_b32 s43, s45, 1
  s_add_u32 s48, s42, s43
  s_add_u32 s43, s48, 0
  buffer_load_dwordx2 v[96:97], v92, s[24:27], s43 offen sc1
  s_add_u32 s43, s48, 4096
  buffer_load_dwordx2 v[98:99], v92, s[24:27], s43 offen sc1
  s_add_u32 s43, s48, 8192
  buffer_load_dwordx2 v[100:101], v92, s[24:27], s43 offen sc1
  s_add_u32 s43, s48, 12288
  buffer_load_dwordx2 v[102:103], v92, s[24:27], s43 offen sc1
  s_add_u32 s43, s48, 16384
  buffer_load_dwordx2 v[104:105], v92, s[24:27], s43 offen sc1
  s_add_u32 s43, s48, 20480
  buffer_load_dwordx2 v[106:107], v92, s[24:27], s43 offen sc1
  s_add_u32 s43, s48, 24576
  buffer_load_dwordx2 v[108:109], v92, s[24:27], s43 offen sc1
  s_add_u32 s43, s48, 28672
  buffer_load_dwordx2 v[110:111], v92, s[24:27], s43 offen sc1
  v_mov_b32 v60, 0
  v_mov_b32 v61, 0
  v_mov_b32 v62, 0
  v_mov_b32 v63, 0
  v_add_u32 v65, 0, v0
  v_lshlrev_b32 v64, 4, v65
  v_cmp_gt_u32 vcc, 1552, v65
  s_nop 0
  s_and_saveexec_b64 s[54:55], vcc
  ds_write_b128 v64, v[60:63] offset:2304
  s_mov_b64 exec, s[54:55]
  v_add_u32 v65, 512, v0
  v_lshlrev_b32 v64, 4, v65
  v_cmp_gt_u32 vcc, 1552, v65
  s_nop 0
  s_and_saveexec_b64 s[54:55], vcc
  ds_write_b128 v64, v[60:63] offset:2304
  s_mov_b64 exec, s[54:55]
  v_add_u32 v65, 1024, v0
  v_lshlrev_b32 v64, 4, v65
  v_cmp_gt_u32 vcc, 1552, v65
  s_nop 0
  s_and_saveexec_b64 s[54:55], vcc
  ds_write_b128 v64, v[60:63] offset:2304
  s_mov_b64 exec, s[54:55]
  v_add_u32 v65, 1536, v0
  v_lshlrev_b32 v64, 4, v65
  v_cmp_gt_u32 vcc, 1552, v65
  s_nop 0
  s_and_saveexec_b64 s[54:55], vcc
  ds_write_b128 v64, v[60:63] offset:2304
  s_mov_b64 exec, s[54:55]
  v_lshrrev_b32 v3, 1, v0
  v_mul_u32_u24 v3, 608, v3
  v_and_b32 v4, 1, v0
  v_lshl_add_u32 v3, v4, 4, v3
  v_cmp_gt_u32 vcc, 128, v0
  s_nop 0
  s_and_saveexec_b64 s[54:55], vcc
  ds_write_b128 v3, v[60:63] offset:27712
  s_mov_b64 exec, s[54:55]
  s_waitcnt lgkmcnt(0)
  s_barrier
  s_waitcnt vmcnt(8)
  v_lshrrev_b32 v65, 6, v0
  v_add_u32 v65, 0, v65
  v_cmp_gt_u32 vcc, 31, v65
  s_nop 0
  s_and_saveexec_b64 s[54:55], vcc
  ds_write_b16 v72, v68 offset:2336
  ds_write_b16 v72, v68 offset:2526
  s_mov_b64 exec, s[54:55]
  v_lshrrev_b32 v65, 6, v0
  v_add_u32 v65, 8, v65
  v_cmp_gt_u32 vcc, 31, v65
  s_nop 0
  s_and_saveexec_b64 s[54:55], vcc
  ds_write_b16 v73, v69 offset:2336
  ds_write_b16 v73, v69 offset:2526
  s_mov_b64 exec, s[54:55]
  v_lshrrev_b32 v65, 6, v0
  v_add_u32 v65, 16, v65
  v_cmp_gt_u32 vcc, 31, v65
  s_nop 0
  s_and_saveexec_b64 s[54:55], vcc
  ds_write_b16 v74, v70 offset:2336
  ds_write_b16 v74, v70 offset:2526
  s_mov_b64 exec, s[54:55]
  v_lshrrev_b32 v65, 6, v0
  v_add_u32 v65, 24, v65
  v_cmp_gt_u32 vcc, 31, v65
  s_nop 0
  s_and_saveexec_b64 s[54:55], vcc
  ds_write_b16 v75, v71 offset:2336
  ds_write_b16 v75, v71 offset:2526
  s_mov_b64 exec, s[54:55]
  v_add_f32 v8, v8, v10
  v_add_f32 v9, v9, v11
  v_add_f32 v12, v12, v14
  v_add_f32 v13, v13, v15
  v_add_f32 v16, v16, v18
  v_add_f32 v17, v17, v19
  v_add_f32 v20, v20, v22
  v_add_f32 v21, v21, v23
  v_add_f32 v8, v8, v12
  v_add_f32 v9, v9, v13
  v_add_f32 v16, v16, v20
  v_add_f32 v17, v17, v21
  v_add_f32 v8, v8, v16
  v_add_f32 v9, v9, v17
  v_mul_f32 v8, 0x3b000000, v8
  v_mul_f32 v9, 0x3b000000, v9
  v_fma_f32 v9, -v8, v8, v9
  v_max_f32 v9, 0, v9
  v_add_f32 v9, 0x3727c5ac, v9
  v_rsq_f32 v9, v9
  s_nop 0
  v_cndmask_b32 v9, 0, v9, s[98:99]
  v_mul_f32 v8, -1.0, v8
  v_mul_f32 v8, v8, v9
  v_lshlrev_b32 v10, 2, v0
  v_cmp_gt_u32 vcc, 288, v0
  s_nop 0
  s_and_saveexec_b64 s[54:55], vcc
  ds_write_b32 v10, v9 offset:0
  ds_write_b32 v10, v8 offset:1152
  s_mov_b64 exec, s[54:55]
  s_waitcnt lgkmcnt(0)
  s_barrier
  ds_read_b128 v[8:11], v49 offset:0
  ds_read_b128 v[12:15], v49 offset:16
  ds_read_b128 v[16:19], v49 offset:1152
  ds_read_b128 v[20:23], v49 offset:1168
  s_waitcnt lgkmcnt(0)
  v_lshlrev_b32 v56, 16, v24
  v_and_b32 v57, 0xffff0000, v24
  v_fma_f32 v56, v56, v8, v16
  v_fma_f32 v57, v57, v9, v17
  v_cvt_pk_bf16_f32 v24, v56, v57
  v_lshlrev_b32 v58, 16, v25
  v_and_b32 v59, 0xffff0000, v25
  v_fma_f32 v58, v58, v10, v18
  v_fma_f32 v59, v59, v11, v19
  v_cvt_pk_bf16_f32 v25, v58, v59
  v_lshlrev_b32 v56, 16, v26
  v_and_b32 v57, 0xffff0000, v26
  v_fma_f32 v56, v56, v12, v20
  v_fma_f32 v57, v57, v13, v21
  v_cvt_pk_bf16_f32 v26, v56, v57
  v_lshlrev_b32 v58, 16, v27
  v_and_b32 v59, 0xffff0000, v27
  v_fma_f32 v58, v58, v14, v22
  v_fma_f32 v59, v59, v15, v23
  v_cvt_pk_bf16_f32 v27, v58, v59
  ds_write_b128 v44, v[24:27] offset:27136
  v_lshlrev_b32 v56, 16, v28
  v_and_b32 v57, 0xffff0000, v28
  v_fma_f32 v56, v56, v8, v16
  v_fma_f32 v57, v57, v9, v17
  v_cvt_pk_bf16_f32 v28, v56, v57
  v_lshlrev_b32 v58, 16, v29
  v_and_b32 v59, 0xffff0000, v29
  v_fma_f32 v58, v58, v10, v18
  v_fma_f32 v59, v59, v11, v19
  v_cvt_pk_bf16_f32 v29, v58, v59
  v_lshlrev_b32 v56, 16, v30
  v_and_b32 v57, 0xffff0000, v30
  v_fma_f32 v56, v56, v12, v20
  v_fma_f32 v57, v57, v13, v21
  v_cvt_pk_bf16_f32 v30, v56, v57
  v_lshlrev_b32 v58, 16, v31
  v_and_b32 v59, 0xffff0000, v31
  v_fma_f32 v58, v58, v14, v22
  v_fma_f32 v59, v59, v15, v23
  v_cvt_pk_bf16_f32 v31, v58, v59
  ds_write_b128 v45, v[28:31] offset:27136
  v_lshlrev_b32 v56, 16, v32
  v_and_b32 v57, 0xffff0000, v32
  v_fma_f32 v56, v56, v8, v16
  v_fma_f32 v57, v57, v9, v17
  v_cvt_pk_bf16_f32 v32, v56, v57
  v_lshlrev_b32 v58, 16, v33
  v_and_b32 v59, 0xffff0000, v33
  v_fma_f32 v58, v58, v10, v18
  v_fma_f32 v59, v59, v11, v19
  v_cvt_pk_bf16_f32 v33, v58, v59
  v_lshlrev_b32 v56, 16, v34
  v_and_b32 v57, 0xffff0000, v34
  v_fma_f32 v56, v56, v12, v20
  v_fma_f32 v57, v57, v13, v21
  v_cvt_pk_bf16_f32 v34, v56, v57
  v_lshlrev_b32 v58, 16, v35
  v_and_b32 v59, 0xffff0000, v35
  v_fma_f32 v58, v58, v14, v22
  v_fma_f32 v59, v59, v15, v23
  v_cvt_pk_bf16_f32 v35, v58, v59
  ds_write_b128 v46, v[32:35] offset:27136
  v_lshlrev_b32 v56, 16, v36
  v_and_b32 v57, 0xffff0000, v36
  v_fma_f32 v56, v56, v8, v16
  v_fma_f32 v57, v57, v9, v17
  v_cvt_pk_bf16_f32 v36, v56, v57
  v_lshlrev_b32 v58, 16, v37
  v_and_b32 v59, 0xffff0000, v37
  v_fma_f32 v58, v58, v10, v18
  v_fma_f32 v59, v59, v11, v19
  v_cvt_pk_bf16_f32 v37, v58, v59
  v_lshlrev_b32 v56, 16, v38
  v_and_b32 v57, 0xffff0000, v38
  v_fma_f32 v56, v56, v12, v20
  v_fma_f32 v57, v57, v13, v21
  v_cvt_pk_bf16_f32 v38, v56, v57
  v_lshlrev_b32 v58, 16, v39
  v_and_b32 v59, 0xffff0000, v39
  v_fma_f32 v58, v58, v14, v22
  v_fma_f32 v59, v59, v15, v23
  v_cvt_pk_bf16_f32 v39, v58, v59
  ds_write_b128 v47, v[36:39] offset:27136
  v_lshlrev_b32 v56, 16, v40
  v_and_b32 v57, 0xffff0000, v40
  v_fma_f32 v56, v56, v8, v16
  v_fma_f32 v57, v57, v9, v17
  v_cvt_pk_bf16_f32 v40, v56, v57
  v_lshlrev_b32 v58, 16, v41
  v_and_b32 v59, 0xffff0000, v41
  v_fma_f32 v58, v58, v10, v18
  v_fma_f32 v59, v59, v11, v19
  v_cvt_pk_bf16_f32 v41, v58, v59
  v_lshlrev_b32 v56, 16, v42
  v_and_b32 v57, 0xffff0000, v42
  v_fma_f32 v56, v56, v12, v20
  v_fma_f32 v57, v57, v13, v21
  v_cvt_pk_bf16_f32 v42, v56, v57
  v_lshlrev_b32 v58, 16, v43
  v_and_b32 v59, 0xffff0000, v43
  v_fma_f32 v58, v58, v14, v22
  v_fma_f32 v59, v59, v15, v23
  v_cvt_pk_bf16_f32 v43, v58, v59
  ds_write_b128 v48, v[40:43] offset:27136
  s_waitcnt lgkmcnt(0)
  s_barrier
  v_lshrrev_b32 v12, 4, v2
  v_lshlrev_b32 v12, 3, v12
  v_and_b32 v13, 15, v2
  v_sub_u32 v12, v12, v13
  v_add_u32 v12, 15, v12
  v_lshlrev_b32 v12, 1, v12
  v_and_b32 v13, 1, v13
  v_xor_b32 v13, 1, v13
  v_mul_u32_u24 v13, 190, v13
  v_add_u32 v12, v12, v13
  v_add_u32 v8, 2304, v12
  s_mul_i32 s42, s36, 3104
  v_add_u32 v8, s42, v8
  v_and_b32 v12, 15, v2
  v_lshlrev_b32 v12, 5, v12
  v_lshrrev_b32 v13, 4, v2
  v_lshl_add_u32 v9, v13, 4, v12
  s_mul_i32 s42, s36, 4864
  s_add_u32 s42, s42, 27136
  v_add_u32 v9, s42, v9
  v_add_u32 v10, 1164, v8
  v_add_u32 v11, 2328, v8
  ds_read2_b32 v[16:17], v8 offset0:0 offset1:1
  ds_read2_b32 v[18:19], v8 offset0:2 offset1:3
  ds_read_b128 v[20:23], v9 offset:0
  ds_read2_b32 v[24:25], v8 offset0:16 offset1:17
  ds_read2_b32 v[26:27], v8 offset0:18 offset1:19
  ds_read_b128 v[28:31], v9 offset:64
  ds_read2_b32 v[32:33], v8 offset0:97 offset1:98
  ds_read2_b32 v[34:35], v8 offset0:99 offset1:100
  ds_read_b128 v[36:39], v9 offset:608
  ds_read2_b32 v[40:41], v8 offset0:113 offset1:114
  ds_read2_b32 v[42:43], v8 offset0:115 offset1:116
  ds_read_b128 v[44:47], v9 offset:672
  s_waitcnt lgkmcnt(6)
  ds_read2_b32 v[48:49], v8 offset0:194 offset1:195
  ds_read2_b32 v[50:51], v8 offset0:196 offset1:197
  ds_read_b128 v[52:55], v9 offset:1216
  ds_read2_b32 v[56:57], v8 offset0:210 offset1:211
  ds_read2_b32 v[58:59], v8 offset0:212 offset1:213
  ds_read_b128 v[60:63], v9 offset:1280
  s_waitcnt lgkmcnt(9)
  ds_read2_b32 v[64:65], v10 offset0:0 offset1:1
  ds_read2_b32 v[66:67], v10 offset0:2 offset1:3
  ds_read_b128 v[68:71], v9 offset:1824
  ds_read2_b32 v[72:73], v10 offset0:16 offset1:17
  ds_read2_b32 v[74:75], v10 offset0:18 offset1:19
  ds_read_b128 v[76:79], v9 offset:1888
  s_waitcnt vmcnt(0)
  s_waitcnt lgkmcnt(15)
  v_mfma_f32_16x16x32_bf16 v[112:115], v[16:19], v[20:23], 0
  v_mfma_f32_16x16x32_bf16 v[112:115], v[24:27], v[28:31], v[112:115]
  s_waitcnt lgkmcnt(12)
  v_mfma_f32_16x16x32_bf16 v[116:119], v[32:35], v[36:39], 0
  v_mfma_f32_16x16x32_bf16 v[116:119], v[40:43], v[44:47], v[116:119]
  s_waitcnt lgkmcnt(6)
  v_mfma_f32_16x16x32_bf16 v[120:123], v[48:51], v[52:55], 0
  v_mfma_f32_16x16x32_bf16 v[120:123], v[56:59], v[60:63], v[120:123]
  s_waitcnt lgkmcnt(0)
  v_mfma_f32_16x16x32_bf16 v[124:127], v[64:67], v[68:71], 0
  v_mfma_f32_16x16x32_bf16 v[124:127], v[72:75], v[76:79], v[124:127]
  v_lshlrev_b32 v84, 16, v96
  v_and_b32 v85, 0xffff0000, v96
  v_lshlrev_b32 v86, 16, v97
  v_and_b32 v87, 0xffff0000, v97
  v_mul_f32 v84, v84, v112
  v_mul_f32 v85, v85, v113
  v_mul_f32 v86, v86, v114
  v_mul_f32 v87, v87, v115
  v_cvt_pk_bf16_f32 v96, v84, v85
  v_cvt_pk_bf16_f32 v97, v86, v87
  s_add_u32 s43, s48, 0
  buffer_store_dwordx2 v[96:97], v93, s[20:23], s43 offen sc1
  v_lshlrev_b32 v84, 16, v98
  v_and_b32 v85, 0xffff0000, v98
  v_lshlrev_b32 v86, 16, v99
  v_and_b32 v87, 0xffff0000, v99
  v_mul_f32 v84, v84, v116
  v_mul_f32 v85, v85, v117
  v_mul_f32 v86, v86, v118
  v_mul_f32 v87, v87, v119
  v_cvt_pk_bf16_f32 v98, v84, v85
  v_cvt_pk_bf16_f32 v99, v86, v87
  s_add_u32 s43, s48, 4096
  buffer_store_dwordx2 v[98:99], v93, s[20:23], s43 offen sc1
  v_lshlrev_b32 v84, 16, v100
  v_and_b32 v85, 0xffff0000, v100
  v_lshlrev_b32 v86, 16, v101
  v_and_b32 v87, 0xffff0000, v101
  v_mul_f32 v84, v84, v120
  v_mul_f32 v85, v85, v121
  v_mul_f32 v86, v86, v122
  v_mul_f32 v87, v87, v123
  v_cvt_pk_bf16_f32 v100, v84, v85
  v_cvt_pk_bf16_f32 v101, v86, v87
  s_add_u32 s43, s48, 8192
  buffer_store_dwordx2 v[100:101], v93, s[20:23], s43 offen sc1
  v_lshlrev_b32 v84, 16, v102
  v_and_b32 v85, 0xffff0000, v102
  v_lshlrev_b32 v86, 16, v103
  v_and_b32 v87, 0xffff0000, v103
  v_mul_f32 v84, v84, v124
  v_mul_f32 v85, v85, v125
  v_mul_f32 v86, v86, v126
  v_mul_f32 v87, v87, v127
  v_cvt_pk_bf16_f32 v102, v84, v85
  v_cvt_pk_bf16_f32 v103, v86, v87
  s_add_u32 s43, s48, 12288
  buffer_store_dwordx2 v[102:103], v93, s[20:23], s43 offen sc1
  ds_read2_b32 v[16:17], v10 offset0:97 offset1:98
  ds_read2_b32 v[18:19], v10 offset0:99 offset1:100
  ds_read_b128 v[20:23], v9 offset:2432
  ds_read2_b32 v[24:25], v10 offset0:113 offset1:114
  ds_read2_b32 v[26:27], v10 offset0:115 offset1:116
  ds_read_b128 v[28:31], v9 offset:2496
  ds_read2_b32 v[32:33], v10 offset0:194 offset1:195
  ds_read2_b32 v[34:35], v10 offset0:196 offset1:197
  ds_read_b128 v[36:39], v9 offset:3040
  ds_read2_b32 v[40:41], v10 offset0:210 offset1:211
  ds_read2_b32 v[42:43], v10 offset0:212 offset1:213
  ds_read_b128 v[44:47], v9 offset:3104
  s_waitcnt lgkmcnt(6)
  ds_read2_b32 v[48:49], v11 offset0:0 offset1:1
  ds_read2_b32 v[50:51], v11 offset0:2 offset1:3
  ds_read_b128 v[52:55], v9 offset:3648
  ds_read2_b32 v[56:57], v11 offset0:16 offset1:17
  ds_read2_b32 v[58:59], v11 offset0:18 offset1:19
  ds_read_b128 v[60:63], v9 offset:3712
  s_waitcnt lgkmcnt(9)
  ds_read2_b32 v[64:65], v11 offset0:97 offset1:98
  ds_read2_b32 v[66:67], v11 offset0:99 offset1:100
  ds_read_b128 v[68:71], v9 offset:4256
  ds_read2_b32 v[72:73], v11 offset0:113 offset1:114
  ds_read2_b32 v[74:75], v11 offset0:115 offset1:116
  ds_read_b128 v[76:79], v9 offset:4320
  s_waitcnt lgkmcnt(15)
  v_mfma_f32_16x16x32_bf16 v[112:115], v[16:19], v[20:23], 0
  v_mfma_f32_16x16x32_bf16 v[112:115], v[24:27], v[28:31], v[112:115]
  s_waitcnt lgkmcnt(12)
  v_mfma_f32_16x16x32_bf16 v[116:119], v[32:35], v[36:39], 0
  v_mfma_f32_16x16x32_bf16 v[116:119], v[40:43], v[44:47], v[116:119]
  s_waitcnt lgkmcnt(6)
  v_mfma_f32_16x16x32_bf16 v[120:123], v[48:51], v[52:55], 0
  v_mfma_f32_16x16x32_bf16 v[120:123], v[56:59], v[60:63], v[120:123]
  s_waitcnt lgkmcnt(0)
  v_mfma_f32_16x16x32_bf16 v[124:127], v[64:67], v[68:71], 0
  v_mfma_f32_16x16x32_bf16 v[124:127], v[72:75], v[76:79], v[124:127]
  v_lshlrev_b32 v84, 16, v104
  v_and_b32 v85, 0xffff0000, v104
  v_lshlrev_b32 v86, 16, v105
  v_and_b32 v87, 0xffff0000, v105
  v_mul_f32 v84, v84, v112
  v_mul_f32 v85, v85, v113
  v_mul_f32 v86, v86, v114
  v_mul_f32 v87, v87, v115
  v_cvt_pk_bf16_f32 v104, v84, v85
  v_cvt_pk_bf16_f32 v105, v86, v87
  s_add_u32 s43, s48, 16384
  buffer_store_dwordx2 v[104:105], v93, s[20:23], s43 offen sc1
  v_lshlrev_b32 v84, 16, v106
  v_and_b32 v85, 0xffff0000, v106
  v_lshlrev_b32 v86, 16, v107
  v_and_b32 v87, 0xffff0000, v107
  v_mul_f32 v84, v84, v116
  v_mul_f32 v85, v85, v117
  v_mul_f32 v86, v86, v118
  v_mul_f32 v87, v87, v119
  v_cvt_pk_bf16_f32 v106, v84, v85
  v_cvt_pk_bf16_f32 v107, v86, v87
  s_add_u32 s43, s48, 20480
  buffer_store_dwordx2 v[106:107], v93, s[20:23], s43 offen sc1
  v_lshlrev_b32 v84, 16, v108
  v_and_b32 v85, 0xffff0000, v108
  v_lshlrev_b32 v86, 16, v109
  v_and_b32 v87, 0xffff0000, v109
  v_mul_f32 v84, v84, v120
  v_mul_f32 v85, v85, v121
  v_mul_f32 v86, v86, v122
  v_mul_f32 v87, v87, v123
  v_cvt_pk_bf16_f32 v108, v84, v85
  v_cvt_pk_bf16_f32 v109, v86, v87
  s_add_u32 s43, s48, 24576
  buffer_store_dwordx2 v[108:109], v93, s[20:23], s43 offen sc1
  v_lshlrev_b32 v84, 16, v110
  v_and_b32 v85, 0xffff0000, v110
  v_lshlrev_b32 v86, 16, v111
  v_and_b32 v87, 0xffff0000, v111
  v_mul_f32 v84, v84, v124
  v_mul_f32 v85, v85, v125
  v_mul_f32 v86, v86, v126
  v_mul_f32 v87, v87, v127
  v_cvt_pk_bf16_f32 v110, v84, v85
  v_cvt_pk_bf16_f32 v111, v86, v87
  s_add_u32 s43, s48, 28672
  buffer_store_dwordx2 v[110:111], v93, s[20:23], s43 offen sc1
P2_FIN:
P2_END:
  s_waitcnt vmcnt(0) lgkmcnt(0)
  s_barrier
  v_lshrrev_b32 v1, 6, v0
  s_nop 0
  v_readfirstlane_b32 s96, v1
  s_nop 0
  s_cmp_lg_u32 s96, 0
  s_cbranch_scc1 p2_arr_11
  s_cmp_eq_u32 s101, -1
  s_cbranch_scc1 p2_arr_11
  s_lshl_b32 s96, s101, 7
  s_add_u32 s96, s96, 32768
  v_mov_b32 v1, s3
  v_mov_b32 v2, 0
  s_mov_b64 exec, 1
  buffer_store_dword v1, v2, s[92:95], s96 offen sc1
  s_mov_b64 exec, -1
p2_arr_11:
  s_cmp_ge_u32 s2, 256
  s_cbranch_scc1 P3_END
  s_load_dwordx2 s[4:5], s[0:1], 80
  s_load_dwordx2 s[6:7], s[0:1], 40
  s_load_dwordx2 s[32:33], s[0:1], 48
  v_lshrrev_b32 v1, 6, v0
  v_and_b32 v2, 63, v0
  v_readfirstlane_b32 s36, v1
  s_and_b32 s47, s2, 7
  s_lshr_b32 s50, s2, 3
  s_mov_b32 s58, s36
  s_waitcnt lgkmcnt(0)
  s_mov_b32 s101, -1
  s_cmp_lt_u32 s50, 30
  s_cbranch_scc1 P3_WORK
  s_cmp_lg_u32 s2, 255
  s_cbranch_scc1 P3_END
  s_cmp_lg_u32 s58, 0
  s_cbranch_scc1 p3_ebx_3
  v_lshlrev_b32 v4, 7, v2
  v_add_u32 v5, 8192, v4
  v_add_u32 v6, 16384, v4
  v_add_u32 v7, 24576, v4
  s_mov_b32 s96, 0x200000
p3_eb_1:
  buffer_load_dword v8, v4, s[92:95], 0 offen sc1
  buffer_load_dword v9, v5, s[92:95], 0 offen sc1
  buffer_load_dword v10, v6, s[92:95], 0 offen sc1
  buffer_load_dword v11, v7, s[92:95], 0 offen sc1
  s_waitcnt vmcnt(0)
  v_xor_b32 v8, s3, v8
  v_xor_b32 v9, s3, v9
  v_xor_b32 v10, s3, v10
  v_xor_b32 v11, s3, v11
  v_or_b32 v8, v8, v9
  v_or_b32 v10, v10, v11
  v_or_b32 v8, v8, v10
  v_cmp_ne_u32 vcc, 0, v8
  s_sub_u32 s96, s96, 1
  s_cmp_eq_u32 s96, 0
  s_cbranch_scc1 p3_ebd_2
  s_nop 1
  s_cbranch_vccnz p3_eb_1
p3_ebd_2:
  v_mov_b32 v8, s3
  v_mov_b32 v9, 0
  s_mov_b32 s97, 131072
  s_mov_b64 exec, 1
  buffer_store_dword v8, v9, s[92:95], s97 offen sc1
  s_mov_b64 exec, -1
p3_ebx_3:
  s_branch P3_END
P3_WORK:
  s_add_u32 s16, s4, 24117248
  s_addc_u32 s17, s5, 0
  s_mov_b32 s18, 4194304
  s_mov_b32 s19, 0x20000
  s_mov_b32 s28, s32
  s_mov_b32 s29, s33
  s_mov_b32 s30, 63488
  s_mov_b32 s31, 0x20000
  s_lshr_b32 s51, s47, 2
  s_cmp_ge_u32 s50, 22
  s_cbranch_scc1 P3_LOC
  s_and_b32 s42, s47, 3
  s_mul_i32 s42, s42, 22
  s_add_u32 s42, s42, s50
  s_lshr_b32 s37, s42, 3
  s_and_b32 s38, s42, 7
  s_mov_b32 s24, s38
  s_mov_b32 s24, 0
  s_lshl_b32 s39, s24, 1
  s_lshl_b32 s42, s51, 21
  s_add_u32 s42, s42, 11501568
  s_add_u32 s8, s4, s42
  s_addc_u32 s9, s5, 0
  s_mov_b32 s10, 2080768
  s_mov_b32 s11, 0x20000
  s_mul_i32 s42, s51, 1024000
  s_add_u32 s42, s42, 15728640
  s_add_u32 s12, s4, s42
  s_addc_u32 s13, s5, 0
  s_mov_b32 s14, 1024000
  s_mov_b32 s15, 0x20000
  s_mul_i32 s43, s37, 96
  s_lshl_b32 s25, s38, 18
  s_mul_i32 s42, s51, 1000
  s_add_u32 s42, s42, s43
  s_lshl_b32 s42, s42, 1
  s_add_u32 s25, s25, s42
  s_sub_u32 s26, 1000, s43
  s_min_u32 s26, s26, 96
  s_lshl_b32 s27, s38, 7
  s_add_u32 s20, s4, 10747904
  s_addc_u32 s21, s5, 0
  s_mov_b32 s22, 131072
  s_mov_b32 s23, 0x20000
  s_mul_i32 s101, s51, 88
  s_lshl_b32 s42, s37, 3
  s_add_u32 s101, s101, s42
  s_add_u32 s101, s101, s38
  v_lshrrev_b32 v16, 6, v0
  v_add_u32 v16, 0, v16
  v_and_b32 v17, 63, v0
  v_lshlrev_b32 v18, 11, v16
  v_lshl_add_u32 v18, v17, 1, v18
  v_cmp_gt_u32 vcc, 31, v16
  s_nop 1
  v_cndmask_b32 v18, -1, v18, vcc
  buffer_load_ushort v24, v18, s[28:31], s27 offen
  v_lshrrev_b32 v16, 6, v0
  v_add_u32 v16, 8, v16
  v_and_b32 v17, 63, v0
  v_lshlrev_b32 v18, 11, v16
  v_lshl_add_u32 v18, v17, 1, v18
  v_cmp_gt_u32 vcc, 31, v16
  s_nop 1
  v_cndmask_b32 v18, -1, v18, vcc
  buffer_load_ushort v25, v18, s[28:31], s27 offen
  v_lshrrev_b32 v16, 6, v0
  v_add_u32 v16, 16, v16
  v_and_b32 v17, 63, v0
  v_lshlrev_b32 v18, 11, v16
  v_lshl_add_u32 v18, v17, 1, v18
  v_cmp_gt_u32 vcc, 31, v16
  s_nop 1
  v_cndmask_b32 v18, -1, v18, vcc
  buffer_load_ushort v26, v18, s[28:31], s27 offen
  v_lshrrev_b32 v16, 6, v0
  v_add_u32 v16, 24, v16
  v_and_b32 v17, 63, v0
  v_lshlrev_b32 v18, 11, v16
  v_lshl_add_u32 v18, v17, 1, v18
  v_cmp_gt_u32 vcc, 31, v16
  s_nop 1
  v_cndmask_b32 v18, -1, v18, vcc
  buffer_load_ushort v27, v18, s[28:31], s27 offen
  v_mov_b32 v8, 0
  v_mov_b32 v9, 0
  v_mov_b32 v10, 0
  v_mov_b32 v11, 0
  v_add_u32 v13, 0, v0
  v_lshlrev_b32 v12, 4, v13
  v_add_u32 v12, 126976, v12
  ds_write_b128 v12, v[8:11] offset:0
  v_add_u32 v13, 512, v0
  v_lshlrev_b32 v12, 4, v13
  v_add_u32 v12, 126976, v12
  ds_write_b128 v12, v[8:11] offset:0
  v_add_u32 v13, 1024, v0
  v_lshlrev_b32 v12, 4, v13
  v_add_u32 v12, 126976, v12
  ds_write_b128 v12, v[8:11] offset:0
  v_add_u32 v13, 1536, v0
  v_lshlrev_b32 v12, 4, v13
  v_add_u32 v12, 126976, v12
  v_cmp_gt_u32 vcc, 1552, v13
  s_nop 0
  s_and_saveexec_b64 s[54:55], vcc
  ds_write_b128 v12, v[8:11] offset:0
  s_mov_b64 exec, s[54:55]
  s_waitcnt vmcnt(0) lgkmcnt(0)
  s_barrier
  v_and_b32 v17, 63, v0
  v_mul_u32_u24 v17, 388, v17
  v_lshrrev_b32 v16, 6, v0
  v_lshl_add_u32 v17, v16, 1, v17
  v_add_u32 v17, 126976, v17
  ds_write_b16 v17, v24 offset:32
  ds_write_b16 v17, v24 offset:222
  ds_write_b16 v17, v25 offset:48
  ds_write_b16 v17, v25 offset:238
  ds_write_b16 v17, v26 offset:64
  ds_write_b16 v17, v26 offset:254
  v_add_u32 v18, 24, v16
  v_cmp_gt_u32 vcc, 31, v18
  s_nop 0
  s_and_saveexec_b64 s[54:55], vcc
  ds_write_b16 v17, v27 offset:80
  ds_write_b16 v17, v27 offset:270
  s_mov_b64 exec, s[54:55]
  s_waitcnt lgkmcnt(0)
  s_cmp_ge_u32 s36, 4
  s_cbranch_scc1 P3_PV_LOADER
  v_and_b32 v10, 31, v2
  v_lshrrev_b32 v11, 5, v2
  v_lshrrev_b32 v12, 1, v10
  v_and_b32 v12, 7, v12
  v_lshlrev_b32 v13, 7, v10
  s_lshl_b32 s42, s36, 12
  v_add_u32 v13, s42, v13
  v_add_u32 v13, 4096, v13
  v_add_u32 v14, 0, v11
  v_xor_b32 v14, v14, v12
  v_lshl_add_u32 v3, v14, 4, v13
  v_add_u32 v14, 2, v11
  v_xor_b32 v14, v14, v12
  v_lshl_add_u32 v4, v14, 4, v13
  v_add_u32 v14, 4, v11
  v_xor_b32 v14, v14, v12
  v_lshl_add_u32 v5, v14, 4, v13
  v_add_u32 v14, 6, v11
  v_xor_b32 v14, v14, v12
  v_lshl_add_u32 v6, v14, 4, v13
  v_lshrrev_b32 v10, 5, v2
  v_lshlrev_b32 v10, 3, v10
  v_bfe_u32 v11, v2, 2, 2
  v_add_u32 v10, v10, v11
  v_bfe_u32 v12, v2, 4, 1
  v_lshlrev_b32 v12, 5, v12
  v_and_b32 v13, 3, v2
  v_lshl_add_u32 v12, v13, 3, v12
  v_lshlrev_b32 v13, 7, v10
  v_add_u32 v13, v13, v12
  v_add_u32 v13, 20480, v13
  v_bfe_u32 v14, v2, 3, 1
  v_lshlrev_b32 v14, 6, v14
  v_add_u32 v7, v13, v14
  v_xor_b32 v14, 64, v14
  v_add_u32 v8, v13, v14
  v_mov_b32 v132, 0
  v_mov_b32 v133, 0
  v_mov_b32 v134, 0
  v_mov_b32 v135, 0
  v_mov_b32 v136, 0
  v_mov_b32 v137, 0
  v_mov_b32 v138, 0
  v_mov_b32 v139, 0
  v_mov_b32 v140, 0
  v_mov_b32 v141, 0
  v_mov_b32 v142, 0
  v_mov_b32 v143, 0
  v_mov_b32 v144, 0
  v_mov_b32 v145, 0
  v_mov_b32 v146, 0
  v_mov_b32 v147, 0
  v_mov_b32 v148, 0
  v_mov_b32 v149, 0
  v_mov_b32 v150, 0
  v_mov_b32 v151, 0
  v_mov_b32 v152, 0
  v_mov_b32 v153, 0
  v_mov_b32 v154, 0
  v_mov_b32 v155, 0
  v_mov_b32 v156, 0
  v_mov_b32 v157, 0
  v_mov_b32 v158, 0
  v_mov_b32 v159, 0
  v_mov_b32 v160, 0
  v_mov_b32 v161, 0
  v_mov_b32 v162, 0
  v_mov_b32 v163, 0
  s_cmp_lg_u32 s58, 0
  s_cbranch_scc1 p3_gwd_4
  s_mul_i32 s96, s37, 96
  s_add_u32 s97, s96, 111
  s_min_u32 s97, s97, 999
  s_lshr_b32 s97, s97, 7
  s_max_u32 s96, s96, 16
  s_sub_u32 s96, s96, 16
  s_lshr_b32 s96, s96, 7
  v_mov_b32 v101, s96
  v_mov_b32 v102, s97
  v_cmp_lt_u32 vcc, 7, v2
  s_nop 1
  v_cndmask_b32 v101, v101, v102, vcc
  v_and_b32 v102, 7, v2
  v_lshl_add_u32 v101, v101, 3, v102
  s_lshl_b32 s96, s51, 6
  v_add_u32 v101, s96, v101
  v_min_u32 v102, 24, v2
  v_subrev_u32 v102, 16, v102
  s_mul_i32 s96, s51, 7
  v_add_u32 v102, s96, v102
  s_lshl_b32 s97, s51, 3
  s_add_u32 s97, s97, 7
  v_min_u32 v102, s97, v102
  s_lshr_b32 s96, s38, 1
  s_add_u32 s96, s96, 128
  v_lshl_add_u32 v102, v102, 2, s96
  v_cmp_lt_u32 vcc, 15, v2
  s_nop 1
  v_cndmask_b32 v100, v101, v102, vcc
  v_lshlrev_b32 v100, 7, v100
  s_mov_b32 s97, 32768
  s_mov_b32 s96, 0x200000
p3_gw_5:
  buffer_load_dword v101, v100, s[92:95], s97 offen sc1
  s_waitcnt vmcnt(0)
  v_cmp_ne_u32 vcc, s3, v101
  s_sub_u32 s96, s96, 1
  s_cmp_eq_u32 s96, 0
  s_cbranch_scc1 p3_gwd_4
  s_nop 1
  s_cbranch_vccnz p3_gw_5
p3_gwd_4:
  s_barrier
  s_cmp_ge_u32 s36, 2
  s_cbranch_scc1 P3_noscale
  s_mul_i32 s42, s37, 96
  v_add_u32 v10, s42, v0
  v_subrev_u32 v10, 16, v10
  v_cmp_gt_u32 vcc, 1000, v10
  s_nop 0
  s_mov_b64 s[98:99], vcc
  v_lshlrev_b32 v10, 2, v10
  v_cndmask_b32 v10, -1, v10, vcc
  s_lshl_b32 s43, s51, 16
  s_add_u32 s44, s43, 0
  buffer_load_dword v68, v10, s[20:23], s44 offen sc1
  s_add_u32 s44, s43, 4096
  buffer_load_dword v84, v10, s[20:23], s44 offen sc1
  s_add_u32 s44, s43, 8192
  buffer_load_dword v69, v10, s[20:23], s44 offen sc1
  s_add_u32 s44, s43, 12288
  buffer_load_dword v85, v10, s[20:23], s44 offen sc1
  s_add_u32 s44, s43, 16384
  buffer_load_dword v70, v10, s[20:23], s44 offen sc1
  s_add_u32 s44, s43, 20480
  buffer_load_dword v86, v10, s[20:23], s44 offen sc1
  s_add_u32 s44, s43, 24576
  buffer_load_dword v71, v10, s[20:23], s44 offen sc1
  s_add_u32 s44, s43, 28672
  buffer_load_dword v87, v10, s[20:23], s44 offen sc1
  s_add_u32 s44, s43, 32768
  buffer_load_dword v72, v10, s[20:23], s44 offen sc1
  s_add_u32 s44, s43, 36864
  buffer_load_dword v88, v10, s[20:23], s44 offen sc1
  s_add_u32 s44, s43, 40960
  buffer_load_dword v73, v10, s[20:23], s44 offen sc1
  s_add_u32 s44, s43, 45056
  buffer_load_dword v89, v10, s[20:23], s44 offen sc1
  s_add_u32 s44, s43, 49152
  buffer_load_dword v74, v10, s[20:23], s44 offen sc1
  s_add_u32 s44, s43, 53248
  buffer_load_dword v90, v10, s[20:23], s44 offen sc1
  s_add_u32 s44, s43, 57344
  buffer_load_dword v75, v10, s[20:23], s44 offen sc1
  s_add_u32 s44, s43, 61440
  buffer_load_dword v91, v10, s[20:23], s44 offen sc1
  s_waitcnt vmcnt(0)
  v_max3_f32 v11, v68, v69, v70
  v_max3_f32 v11, v71, v72, v11
  v_max3_f32 v11, v73, v74, v11
  v_max_f32 v11, v75, v11
  v_sub_f32 v68, v68, v11
  v_sub_f32 v69, v69, v11
  v_sub_f32 v70, v70, v11
  v_sub_f32 v71, v71, v11
  v_sub_f32 v72, v72, v11
  v_sub_f32 v73, v73, v11
  v_sub_f32 v74, v74, v11
  v_sub_f32 v75, v75, v11
  v_exp_f32 v68, v68
  v_exp_f32 v69, v69
  v_exp_f32 v70, v70
  v_exp_f32 v71, v71
  v_exp_f32 v72, v72
  v_exp_f32 v73, v73
  v_exp_f32 v74, v74
  v_exp_f32 v75, v75
  v_mul_f32 v12, v68, v84
  v_fma_f32 v12, v69, v85, v12
  v_fma_f32 v12, v70, v86, v12
  v_fma_f32 v12, v71, v87, v12
  v_fma_f32 v12, v72, v88, v12
  v_fma_f32 v12, v73, v89, v12
  v_fma_f32 v12, v74, v90, v12
  v_fma_f32 v12, v75, v91, v12
  v_rcp_f32 v12, v12
  v_lshlrev_b32 v13, 2, v0
  v_cndmask_b32 v12, 0, v12, s[98:99]
  v_mul_f32 v68, v68, v12
  ds_write_b32 v13, v68 offset:0
  v_mul_f32 v69, v69, v12
  ds_write_b32 v13, v69 offset:512
  v_mul_f32 v70, v70, v12
  ds_write_b32 v13, v70 offset:1024
  v_mul_f32 v71, v71, v12
  ds_write_b32 v13, v71 offset:1536
  v_mul_f32 v72, v72, v12
  ds_write_b32 v13, v72 offset:2048
  v_mul_f32 v73, v73, v12
  ds_write_b32 v13, v73 offset:2560
  v_mul_f32 v74, v74, v12
  ds_write_b32 v13, v74 offset:3072
  v_mul_f32 v75, v75, v12
  ds_write_b32 v13, v75 offset:3584
  s_waitcnt lgkmcnt(0)
P3_noscale:
  s_mov_b32 s53, 0
  s_mov_b32 s56, 4294868992
  s_mov_b32 s57, 24576
  v_lshrrev_b32 v180, 5, v2
  v_lshlrev_b32 v180, 4, v180
  s_lshl_b32 s42, s36, 7
  v_add_u32 v180, s42, v180
  v_mov_b32 v100, 0
  v_mov_b32 v101, 0
  v_mov_b32 v102, 0
  v_mov_b32 v103, 0
  v_mov_b32 v104, 0
  v_mov_b32 v105, 0
  v_mov_b32 v106, 0
  v_mov_b32 v107, 0
  v_mov_b32 v108, 0
  v_mov_b32 v109, 0
  v_mov_b32 v110, 0
  v_mov_b32 v111, 0
  v_mov_b32 v112, 0
  v_mov_b32 v113, 0
  v_mov_b32 v114, 0
  v_mov_b32 v115, 0
  v_mov_b32 v116, 0
  v_mov_b32 v117, 0
  v_mov_b32 v118, 0
  v_mov_b32 v119, 0
  v_mov_b32 v120, 0
  v_mov_b32 v121, 0
  v_mov_b32 v122, 0
  v_mov_b32 v123, 0
  v_mov_b32 v124, 0
  v_mov_b32 v125, 0
  v_mov_b32 v126, 0
  v_mov_b32 v127, 0
  v_mov_b32 v128, 0
  v_mov_b32 v129, 0
  v_mov_b32 v130, 0
  v_mov_b32 v131, 0
  v_mov_b32 v164, 0
  v_mov_b32 v165, 0
  v_mov_b32 v166, 0
  v_mov_b32 v167, 0
  v_mov_b32 v168, 0
  v_mov_b32 v169, 0
  v_mov_b32 v170, 0
  v_mov_b32 v171, 0
  v_mov_b32 v172, 0
  v_mov_b32 v173, 0
  v_mov_b32 v174, 0
  v_mov_b32 v175, 0
  v_mov_b32 v176, 0
  v_mov_b32 v177, 0
  v_mov_b32 v178, 0
  v_mov_b32 v179, 0
  s_barrier
  ds_read_b128 v[20:23], v3
  ds_read_b64_tr_b16 v[36:37], v7 offset:0
  ds_read_b64_tr_b16 v[38:39], v7 offset:512
  ds_read_b64_tr_b16 v[40:41], v8 offset:0
  ds_read_b64_tr_b16 v[42:43], v8 offset:512
  ds_read_b128 v[24:27], v4
  ds_read_b64_tr_b16 v[44:45], v7 offset:2048
  ds_read_b64_tr_b16 v[46:47], v7 offset:2560
  ds_read_b64_tr_b16 v[48:49], v8 offset:2048
  ds_read_b64_tr_b16 v[50:51], v8 offset:2560
  s_mov_b32 s41, 3
p3_PV_loop_6:
  s_waitcnt lgkmcnt(7)
  v_mfma_f32_32x32x16_bf16 v[68:83], v[20:23], v[36:39], 0
  ds_read_b128 v[28:31], v5
  ds_read_b64_tr_b16 v[52:53], v7 offset:4096
  ds_read_b64_tr_b16 v[54:55], v7 offset:4608
  s_waitcnt lgkmcnt(8)
  v_mfma_f32_32x32x16_bf16 v[84:99], v[20:23], v[40:43], 0
  ds_read_b64_tr_b16 v[56:57], v8 offset:4096
  ds_read_b64_tr_b16 v[58:59], v8 offset:4608
  s_waitcnt lgkmcnt(7)
  v_mfma_f32_32x32x16_bf16 v[68:83], v[24:27], v[44:47], v[68:83]
  ds_read_b128 v[32:35], v6
  ds_read_b64_tr_b16 v[60:61], v7 offset:6144
  ds_read_b64_tr_b16 v[62:63], v7 offset:6656
  v_fma_f32 v132, v100, v164, v132
  v_fma_f32 v133, v101, v165, v133
  v_fma_f32 v134, v102, v166, v134
  v_fma_f32 v135, v103, v167, v135
  v_fma_f32 v136, v104, v168, v136
  s_waitcnt lgkmcnt(8)
  v_mfma_f32_32x32x16_bf16 v[84:99], v[24:27], v[48:51], v[84:99]
  ds_read_b64_tr_b16 v[64:65], v8 offset:6144
  ds_read_b64_tr_b16 v[66:67], v8 offset:6656
  v_fma_f32 v137, v105, v169, v137
  v_fma_f32 v138, v106, v170, v138
  v_fma_f32 v139, v107, v171, v139
  v_fma_f32 v140, v108, v172, v140
  v_fma_f32 v141, v109, v173, v141
  v_fma_f32 v142, v110, v174, v142
  s_barrier
  s_add_u32 s53, s53, 24576
  s_cmp_eq_u32 s53, 122880
  s_cselect_b32 s52, s56, s57
  s_cselect_b32 s53, 0, s53
  v_add_u32 v3, s52, v3
  v_add_u32 v4, s52, v4
  v_add_u32 v5, s52, v5
  v_add_u32 v6, s52, v6
  v_add_u32 v7, s52, v7
  v_add_u32 v8, s52, v8
  s_waitcnt lgkmcnt(7)
  v_mfma_f32_32x32x16_bf16 v[68:83], v[28:31], v[52:55], v[68:83]
  ds_read_b128 v[20:23], v3
  ds_read_b64_tr_b16 v[36:37], v7 offset:0
  ds_read_b64_tr_b16 v[38:39], v7 offset:512
  v_fma_f32 v143, v111, v175, v143
  v_fma_f32 v144, v112, v176, v144
  v_fma_f32 v145, v113, v177, v145
  v_fma_f32 v146, v114, v178, v146
  v_fma_f32 v147, v115, v179, v147
  s_waitcnt lgkmcnt(8)
  v_mfma_f32_32x32x16_bf16 v[84:99], v[28:31], v[56:59], v[84:99]
  ds_read_b64_tr_b16 v[40:41], v8 offset:0
  ds_read_b64_tr_b16 v[42:43], v8 offset:512
  v_fma_f32 v148, v116, v164, v148
  v_fma_f32 v149, v117, v165, v149
  v_fma_f32 v150, v118, v166, v150
  v_fma_f32 v151, v119, v167, v151
  v_fma_f32 v152, v120, v168, v152
  v_fma_f32 v153, v121, v169, v153
  s_waitcnt lgkmcnt(7)
  v_mfma_f32_32x32x16_bf16 v[68:83], v[32:35], v[60:63], v[68:83]
  ds_read_b128 v[24:27], v4
  ds_read_b64_tr_b16 v[44:45], v7 offset:2048
  ds_read_b64_tr_b16 v[46:47], v7 offset:2560
  v_fma_f32 v154, v122, v170, v154
  v_fma_f32 v155, v123, v171, v155
  v_fma_f32 v156, v124, v172, v156
  v_fma_f32 v157, v125, v173, v157
  v_fma_f32 v158, v126, v174, v158
  s_waitcnt lgkmcnt(8)
  v_mfma_f32_32x32x16_bf16 v[84:99], v[32:35], v[64:67], v[84:99]
  ds_read_b64_tr_b16 v[48:49], v8 offset:2048
  ds_read_b64_tr_b16 v[50:51], v8 offset:2560
  v_fma_f32 v159, v127, v175, v159
  v_fma_f32 v160, v128, v176, v160
  v_fma_f32 v161, v129, v177, v161
  v_fma_f32 v162, v130, v178, v162
  v_fma_f32 v163, v131, v179, v163
  s_waitcnt lgkmcnt(7)
  v_mfma_f32_32x32x16_bf16 v[68:83], v[20:23], v[36:39], v[68:83]
  ds_read_b128 v[28:31], v5
  ds_read_b64_tr_b16 v[52:53], v7 offset:4096
  ds_read_b64_tr_b16 v[54:55], v7 offset:4608
  s_waitcnt lgkmcnt(8)
  v_mfma_f32_32x32x16_bf16 v[84:99], v[20:23], v[40:43], v[84:99]
  ds_read_b64_tr_b16 v[56:57], v8 offset:4096
  ds_read_b64_tr_b16 v[58:59], v8 offset:4608
  s_lshl_b32 s42, s24, 9
  v_add_u32 v10, s42, v180
  ds_read_b128 v[164:167], v10 offset:0
  ds_read_b128 v[168:171], v10 offset:32
  ds_read_b128 v[172:175], v10 offset:64
  ds_read_b128 v[176:179], v10 offset:96
  s_add_u32 s24, s24, 1
  s_and_b32 s24, s24, 7
  s_waitcnt lgkmcnt(7)
  v_mfma_f32_32x32x16_bf16 v[68:83], v[24:27], v[44:47], v[68:83]
  ds_read_b128 v[32:35], v6
  ds_read_b64_tr_b16 v[60:61], v7 offset:6144
  ds_read_b64_tr_b16 v[62:63], v7 offset:6656
  s_waitcnt lgkmcnt(8)
  v_mfma_f32_32x32x16_bf16 v[84:99], v[24:27], v[48:51], v[84:99]
  ds_read_b64_tr_b16 v[64:65], v8 offset:6144
  ds_read_b64_tr_b16 v[66:67], v8 offset:6656
  s_barrier
  s_add_u32 s53, s53, 24576
  s_cmp_eq_u32 s53, 122880
  s_cselect_b32 s52, s56, s57
  s_cselect_b32 s53, 0, s53
  v_add_u32 v3, s52, v3
  v_add_u32 v4, s52, v4
  v_add_u32 v5, s52, v5
  v_add_u32 v6, s52, v6
  v_add_u32 v7, s52, v7
  v_add_u32 v8, s52, v8
  s_waitcnt lgkmcnt(7)
  v_mfma_f32_32x32x16_bf16 v[68:83], v[28:31], v[52:55], v[68:83]
  ds_read_b128 v[20:23], v3
  ds_read_b64_tr_b16 v[36:37], v7 offset:0
  ds_read_b64_tr_b16 v[38:39], v7 offset:512
  s_waitcnt lgkmcnt(8)
  v_mfma_f32_32x32x16_bf16 v[84:99], v[28:31], v[56:59], v[84:99]
  ds_read_b64_tr_b16 v[40:41], v8 offset:0
  ds_read_b64_tr_b16 v[42:43], v8 offset:512
  s_waitcnt lgkmcnt(7)
  v_mfma_f32_32x32x16_bf16 v[68:83], v[32:35], v[60:63], v[68:83]
  ds_read_b128 v[24:27], v4
  ds_read_b64_tr_b16 v[44:45], v7 offset:2048
  ds_read_b64_tr_b16 v[46:47], v7 offset:2560
  s_waitcnt lgkmcnt(8)
  v_mfma_f32_32x32x16_bf16 v[84:99], v[32:35], v[64:67], v[84:99]
  ds_read_b64_tr_b16 v[48:49], v8 offset:2048
  ds_read_b64_tr_b16 v[50:51], v8 offset:2560
  s_waitcnt lgkmcnt(7)
  v_mfma_f32_32x32x16_bf16 v[100:115], v[20:23], v[36:39], 0
  ds_read_b128 v[28:31], v5
  ds_read_b64_tr_b16 v[52:53], v7 offset:4096
  ds_read_b64_tr_b16 v[54:55], v7 offset:4608
  s_waitcnt lgkmcnt(8)
  v_mfma_f32_32x32x16_bf16 v[116:131], v[20:23], v[40:43], 0
  ds_read_b64_tr_b16 v[56:57], v8 offset:4096
  ds_read_b64_tr_b16 v[58:59], v8 offset:4608
  s_waitcnt lgkmcnt(7)
  v_mfma_f32_32x32x16_bf16 v[100:115], v[24:27], v[44:47], v[100:115]
  ds_read_b128 v[32:35], v6
  ds_read_b64_tr_b16 v[60:61], v7 offset:6144
  ds_read_b64_tr_b16 v[62:63], v7 offset:6656
  v_fma_f32 v132, v68, v164, v132
  v_fma_f32 v133, v69, v165, v133
  v_fma_f32 v134, v70, v166, v134
  v_fma_f32 v135, v71, v167, v135
  v_fma_f32 v136, v72, v168, v136
  s_waitcnt lgkmcnt(8)
  v_mfma_f32_32x32x16_bf16 v[116:131], v[24:27], v[48:51], v[116:131]
  ds_read_b64_tr_b16 v[64:65], v8 offset:6144
  ds_read_b64_tr_b16 v[66:67], v8 offset:6656
  v_fma_f32 v137, v73, v169, v137
  v_fma_f32 v138, v74, v170, v138
  v_fma_f32 v139, v75, v171, v139
  v_fma_f32 v140, v76, v172, v140
  v_fma_f32 v141, v77, v173, v141
  v_fma_f32 v142, v78, v174, v142
  s_barrier
  s_add_u32 s53, s53, 24576
  s_cmp_eq_u32 s53, 122880
  s_cselect_b32 s52, s56, s57
  s_cselect_b32 s53, 0, s53
  v_add_u32 v3, s52, v3
  v_add_u32 v4, s52, v4
  v_add_u32 v5, s52, v5
  v_add_u32 v6, s52, v6
  v_add_u32 v7, s52, v7
  v_add_u32 v8, s52, v8
  s_waitcnt lgkmcnt(7)
  v_mfma_f32_32x32x16_bf16 v[100:115], v[28:31], v[52:55], v[100:115]
  ds_read_b128 v[20:23], v3
  ds_read_b64_tr_b16 v[36:37], v7 offset:0
  ds_read_b64_tr_b16 v[38:39], v7 offset:512
  v_fma_f32 v143, v79, v175, v143
  v_fma_f32 v144, v80, v176, v144
  v_fma_f32 v145, v81, v177, v145
  v_fma_f32 v146, v82, v178, v146
  v_fma_f32 v147, v83, v179, v147
  s_waitcnt lgkmcnt(8)
  v_mfma_f32_32x32x16_bf16 v[116:131], v[28:31], v[56:59], v[116:131]
  ds_read_b64_tr_b16 v[40:41], v8 offset:0
  ds_read_b64_tr_b16 v[42:43], v8 offset:512
  v_fma_f32 v148, v84, v164, v148
  v_fma_f32 v149, v85, v165, v149
  v_fma_f32 v150, v86, v166, v150
  v_fma_f32 v151, v87, v167, v151
  v_fma_f32 v152, v88, v168, v152
  v_fma_f32 v153, v89, v169, v153
  s_waitcnt lgkmcnt(7)
  v_mfma_f32_32x32x16_bf16 v[100:115], v[32:35], v[60:63], v[100:115]
  ds_read_b128 v[24:27], v4
  ds_read_b64_tr_b16 v[44:45], v7 offset:2048
  ds_read_b64_tr_b16 v[46:47], v7 offset:2560
  v_fma_f32 v154, v90, v170, v154
  v_fma_f32 v155, v91, v171, v155
  v_fma_f32 v156, v92, v172, v156
  v_fma_f32 v157, v93, v173, v157
  v_fma_f32 v158, v94, v174, v158
  s_waitcnt lgkmcnt(8)
  v_mfma_f32_32x32x16_bf16 v[116:131], v[32:35], v[64:67], v[116:131]
  ds_read_b64_tr_b16 v[48:49], v8 offset:2048
  ds_read_b64_tr_b16 v[50:51], v8 offset:2560
  v_fma_f32 v159, v95, v175, v159
  v_fma_f32 v160, v96, v176, v160
  v_fma_f32 v161, v97, v177, v161
  v_fma_f32 v162, v98, v178, v162
  v_fma_f32 v163, v99, v179, v163
  s_waitcnt lgkmcnt(7)
  v_mfma_f32_32x32x16_bf16 v[100:115], v[20:23], v[36:39], v[100:115]
  ds_read_b128 v[28:31], v5
  ds_read_b64_tr_b16 v[52:53], v7 offset:4096
  ds_read_b64_tr_b16 v[54:55], v7 offset:4608
  s_waitcnt lgkmcnt(8)
  v_mfma_f32_32x32x16_bf16 v[116:131], v[20:23], v[40:43], v[116:131]
  ds_read_b64_tr_b16 v[56:57], v8 offset:4096
  ds_read_b64_tr_b16 v[58:59], v8 offset:4608
  s_lshl_b32 s42, s24, 9
  v_add_u32 v10, s42, v180
  ds_read_b128 v[164:167], v10 offset:0
  ds_read_b128 v[168:171], v10 offset:32
  ds_read_b128 v[172:175], v10 offset:64
  ds_read_b128 v[176:179], v10 offset:96
  s_add_u32 s24, s24, 1
  s_and_b32 s24, s24, 7
  s_waitcnt lgkmcnt(7)
  v_mfma_f32_32x32x16_bf16 v[100:115], v[24:27], v[44:47], v[100:115]
  ds_read_b128 v[32:35], v6
  ds_read_b64_tr_b16 v[60:61], v7 offset:6144
  ds_read_b64_tr_b16 v[62:63], v7 offset:6656
  s_waitcnt lgkmcnt(8)
  v_mfma_f32_32x32x16_bf16 v[116:131], v[24:27], v[48:51], v[116:131]
  ds_read_b64_tr_b16 v[64:65], v8 offset:6144
  ds_read_b64_tr_b16 v[66:67], v8 offset:6656
  s_barrier
  s_add_u32 s53, s53, 24576
  s_cmp_eq_u32 s53, 122880
  s_cselect_b32 s52, s56, s57
  s_cselect_b32 s53, 0, s53
  v_add_u32 v3, s52, v3
  v_add_u32 v4, s52, v4
  v_add_u32 v5, s52, v5
  v_add_u32 v6, s52, v6
  v_add_u32 v7, s52, v7
  v_add_u32 v8, s52, v8
  s_waitcnt lgkmcnt(7)
  v_mfma_f32_32x32x16_bf16 v[100:115], v[28:31], v[52:55], v[100:115]
  ds_read_b128 v[20:23], v3
  ds_read_b64_tr_b16 v[36:37], v7 offset:0
  ds_read_b64_tr_b16 v[38:39], v7 offset:512
  s_waitcnt lgkmcnt(8)
  v_mfma_f32_32x32x16_bf16 v[116:131], v[28:31], v[56:59], v[116:131]
  ds_read_b64_tr_b16 v[40:41], v8 offset:0
  ds_read_b64_tr_b16 v[42:43], v8 offset:512
  s_waitcnt lgkmcnt(7)
  v_mfma_f32_32x32x16_bf16 v[100:115], v[32:35], v[60:63], v[100:115]
  ds_read_b128 v[24:27], v4
  ds_read_b64_tr_b16 v[44:45], v7 offset:2048
  ds_read_b64_tr_b16 v[46:47], v7 offset:2560
  s_waitcnt lgkmcnt(8)
  v_mfma_f32_32x32x16_bf16 v[116:131], v[32:35], v[64:67], v[116:131]
  ds_read_b64_tr_b16 v[48:49], v8 offset:2048
  ds_read_b64_tr_b16 v[50:51], v8 offset:2560
  s_sub_u32 s41, s41, 1
  s_cmp_lg_u32 s41, 0
  s_cbranch_scc1 p3_PV_loop_6
  s_waitcnt lgkmcnt(7)
  v_mfma_f32_32x32x16_bf16 v[68:83], v[20:23], v[36:39], 0
  ds_read_b128 v[28:31], v5
  ds_read_b64_tr_b16 v[52:53], v7 offset:4096
  ds_read_b64_tr_b16 v[54:55], v7 offset:4608
  s_waitcnt lgkmcnt(8)
  v_mfma_f32_32x32x16_bf16 v[84:99], v[20:23], v[40:43], 0
  ds_read_b64_tr_b16 v[56:57], v8 offset:4096
  ds_read_b64_tr_b16 v[58:59], v8 offset:4608
  s_waitcnt lgkmcnt(7)
  v_mfma_f32_32x32x16_bf16 v[68:83], v[24:27], v[44:47], v[68:83]
  ds_read_b128 v[32:35], v6
  ds_read_b64_tr_b16 v[60:61], v7 offset:6144
  ds_read_b64_tr_b16 v[62:63], v7 offset:6656
  v_fma_f32 v132, v100, v164, v132
  v_fma_f32 v133, v101, v165, v133
  v_fma_f32 v134, v102, v166, v134
  v_fma_f32 v135, v103, v167, v135
  v_fma_f32 v136, v104, v168, v136
  s_waitcnt lgkmcnt(8)
  v_mfma_f32_32x32x16_bf16 v[84:99], v[24:27], v[48:51], v[84:99]
  ds_read_b64_tr_b16 v[64:65], v8 offset:6144
  ds_read_b64_tr_b16 v[66:67], v8 offset:6656
  v_fma_f32 v137, v105, v169, v137
  v_fma_f32 v138, v106, v170, v138
  v_fma_f32 v139, v107, v171, v139
  v_fma_f32 v140, v108, v172, v140
  v_fma_f32 v141, v109, v173, v141
  v_fma_f32 v142, v110, v174, v142
  s_barrier
  s_add_u32 s53, s53, 24576
  s_cmp_eq_u32 s53, 122880
  s_cselect_b32 s52, s56, s57
  s_cselect_b32 s53, 0, s53
  v_add_u32 v3, s52, v3
  v_add_u32 v4, s52, v4
  v_add_u32 v5, s52, v5
  v_add_u32 v6, s52, v6
  v_add_u32 v7, s52, v7
  v_add_u32 v8, s52, v8
  s_waitcnt lgkmcnt(7)
  v_mfma_f32_32x32x16_bf16 v[68:83], v[28:31], v[52:55], v[68:83]
  ds_read_b128 v[20:23], v3
  ds_read_b64_tr_b16 v[36:37], v7 offset:0
  ds_read_b64_tr_b16 v[38:39], v7 offset:512
  v_fma_f32 v143, v111, v175, v143
  v_fma_f32 v144, v112, v176, v144
  v_fma_f32 v145, v113, v177, v145
  v_fma_f32 v146, v114, v178, v146
  v_fma_f32 v147, v115, v179, v147
  s_waitcnt lgkmcnt(8)
  v_mfma_f32_32x32x16_bf16 v[84:99], v[28:31], v[56:59], v[84:99]
  ds_read_b64_tr_b16 v[40:41], v8 offset:0
  ds_read_b64_tr_b16 v[42:43], v8 offset:512
  v_fma_f32 v148, v116, v164, v148
  v_fma_f32 v149, v117, v165, v149
  v_fma_f32 v150, v118, v166, v150
  v_fma_f32 v151, v119, v167, v151
  v_fma_f32 v152, v120, v168, v152
  v_fma_f32 v153, v121, v169, v153
  s_waitcnt lgkmcnt(7)
  v_mfma_f32_32x32x16_bf16 v[68:83], v[32:35], v[60:63], v[68:83]
  ds_read_b128 v[24:27], v4
  ds_read_b64_tr_b16 v[44:45], v7 offset:2048
  ds_read_b64_tr_b16 v[46:47], v7 offset:2560
  v_fma_f32 v154, v122, v170, v154
  v_fma_f32 v155, v123, v171, v155
  v_fma_f32 v156, v124, v172, v156
  v_fma_f32 v157, v125, v173, v157
  v_fma_f32 v158, v126, v174, v158
  s_waitcnt lgkmcnt(8)
  v_mfma_f32_32x32x16_bf16 v[84:99], v[32:35], v[64:67], v[84:99]
  ds_read_b64_tr_b16 v[48:49], v8 offset:2048
  ds_read_b64_tr_b16 v[50:51], v8 offset:2560
  v_fma_f32 v159, v127, v175, v159
  v_fma_f32 v160, v128, v176, v160
  v_fma_f32 v161, v129, v177, v161
  v_fma_f32 v162, v130, v178, v162
  v_fma_f32 v163, v131, v179, v163
  s_waitcnt lgkmcnt(7)
  v_mfma_f32_32x32x16_bf16 v[68:83], v[20:23], v[36:39], v[68:83]
  ds_read_b128 v[28:31], v5
  ds_read_b64_tr_b16 v[52:53], v7 offset:4096
  ds_read_b64_tr_b16 v[54:55], v7 offset:4608
  s_waitcnt lgkmcnt(8)
  v_mfma_f32_32x32x16_bf16 v[84:99], v[20:23], v[40:43], v[84:99]
  ds_read_b64_tr_b16 v[56:57], v8 offset:4096
  ds_read_b64_tr_b16 v[58:59], v8 offset:4608
  s_lshl_b32 s42, s24, 9
  v_add_u32 v10, s42, v180
  ds_read_b128 v[164:167], v10 offset:0
  ds_read_b128 v[168:171], v10 offset:32
  ds_read_b128 v[172:175], v10 offset:64
  ds_read_b128 v[176:179], v10 offset:96
  s_add_u32 s24, s24, 1
  s_and_b32 s24, s24, 7
  s_waitcnt lgkmcnt(7)
  v_mfma_f32_32x32x16_bf16 v[68:83], v[24:27], v[44:47], v[68:83]
  ds_read_b128 v[32:35], v6
  ds_read_b64_tr_b16 v[60:61], v7 offset:6144
  ds_read_b64_tr_b16 v[62:63], v7 offset:6656
  s_waitcnt lgkmcnt(8)
  v_mfma_f32_32x32x16_bf16 v[84:99], v[24:27], v[48:51], v[84:99]
  ds_read_b64_tr_b16 v[64:65], v8 offset:6144
  ds_read_b64_tr_b16 v[66:67], v8 offset:6656
  s_barrier
  s_add_u32 s53, s53, 24576
  s_cmp_eq_u32 s53, 122880
  s_cselect_b32 s52, s56, s57
  s_cselect_b32 s53, 0, s53
  v_add_u32 v3, s52, v3
  v_add_u32 v4, s52, v4
  v_add_u32 v5, s52, v5
  v_add_u32 v6, s52, v6
  v_add_u32 v7, s52, v7
  v_add_u32 v8, s52, v8
  s_waitcnt lgkmcnt(7)
  v_mfma_f32_32x32x16_bf16 v[68:83], v[28:31], v[52:55], v[68:83]
  ds_read_b128 v[20:23], v3
  ds_read_b64_tr_b16 v[36:37], v7 offset:0
  ds_read_b64_tr_b16 v[38:39], v7 offset:512
  s_waitcnt lgkmcnt(8)
  v_mfma_f32_32x32x16_bf16 v[84:99], v[28:31], v[56:59], v[84:99]
  ds_read_b64_tr_b16 v[40:41], v8 offset:0
  ds_read_b64_tr_b16 v[42:43], v8 offset:512
  s_waitcnt lgkmcnt(7)
  v_mfma_f32_32x32x16_bf16 v[68:83], v[32:35], v[60:63], v[68:83]
  ds_read_b128 v[24:27], v4
  ds_read_b64_tr_b16 v[44:45], v7 offset:2048
  ds_read_b64_tr_b16 v[46:47], v7 offset:2560
  s_waitcnt lgkmcnt(8)
  v_mfma_f32_32x32x16_bf16 v[84:99], v[32:35], v[64:67], v[84:99]
  ds_read_b64_tr_b16 v[48:49], v8 offset:2048
  ds_read_b64_tr_b16 v[50:51], v8 offset:2560
  s_waitcnt lgkmcnt(7)
  v_mfma_f32_32x32x16_bf16 v[100:115], v[20:23], v[36:39], 0
  ds_read_b128 v[28:31], v5
  ds_read_b64_tr_b16 v[52:53], v7 offset:4096
  ds_read_b64_tr_b16 v[54:55], v7 offset:4608
  s_waitcnt lgkmcnt(8)
  v_mfma_f32_32x32x16_bf16 v[116:131], v[20:23], v[40:43], 0
  ds_read_b64_tr_b16 v[56:57], v8 offset:4096
  ds_read_b64_tr_b16 v[58:59], v8 offset:4608
  s_waitcnt lgkmcnt(7)
  v_mfma_f32_32x32x16_bf16 v[100:115], v[24:27], v[44:47], v[100:115]
  ds_read_b128 v[32:35], v6
  ds_read_b64_tr_b16 v[60:61], v7 offset:6144
  ds_read_b64_tr_b16 v[62:63], v7 offset:6656
  v_fma_f32 v132, v68, v164, v132
  v_fma_f32 v133, v69, v165, v133
  v_fma_f32 v134, v70, v166, v134
  v_fma_f32 v135, v71, v167, v135
  v_fma_f32 v136, v72, v168, v136
  s_waitcnt lgkmcnt(8)
  v_mfma_f32_32x32x16_bf16 v[116:131], v[24:27], v[48:51], v[116:131]
  ds_read_b64_tr_b16 v[64:65], v8 offset:6144
  ds_read_b64_tr_b16 v[66:67], v8 offset:6656
  v_fma_f32 v137, v73, v169, v137
  v_fma_f32 v138, v74, v170, v138
  v_fma_f32 v139, v75, v171, v139
  v_fma_f32 v140, v76, v172, v140
  v_fma_f32 v141, v77, v173, v141
  v_fma_f32 v142, v78, v174, v142
  s_barrier
  s_add_u32 s53, s53, 24576
  s_cmp_eq_u32 s53, 122880
  s_cselect_b32 s52, s56, s57
  s_cselect_b32 s53, 0, s53
  v_add_u32 v3, s52, v3
  v_add_u32 v4, s52, v4
  v_add_u32 v5, s52, v5
  v_add_u32 v6, s52, v6
  v_add_u32 v7, s52, v7
  v_add_u32 v8, s52, v8
  s_waitcnt lgkmcnt(7)
  v_mfma_f32_32x32x16_bf16 v[100:115], v[28:31], v[52:55], v[100:115]
  ds_read_b128 v[20:23], v3
  ds_read_b64_tr_b16 v[36:37], v7 offset:0
  ds_read_b64_tr_b16 v[38:39], v7 offset:512
  v_fma_f32 v143, v79, v175, v143
  v_fma_f32 v144, v80, v176, v144
  v_fma_f32 v145, v81, v177, v145
  v_fma_f32 v146, v82, v178, v146
  v_fma_f32 v147, v83, v179, v147
  s_waitcnt lgkmcnt(8)
  v_mfma_f32_32x32x16_bf16 v[116:131], v[28:31], v[56:59], v[116:131]
  ds_read_b64_tr_b16 v[40:41], v8 offset:0
  ds_read_b64_tr_b16 v[42:43], v8 offset:512
  v_fma_f32 v148, v84, v164, v148
  v_fma_f32 v149, v85, v165, v149
  v_fma_f32 v150, v86, v166, v150
  v_fma_f32 v151, v87, v167, v151
  v_fma_f32 v152, v88, v168, v152
  v_fma_f32 v153, v89, v169, v153
  s_waitcnt lgkmcnt(7)
  v_mfma_f32_32x32x16_bf16 v[100:115], v[32:35], v[60:63], v[100:115]
  ds_read_b128 v[24:27], v4
  ds_read_b64_tr_b16 v[44:45], v7 offset:2048
  ds_read_b64_tr_b16 v[46:47], v7 offset:2560
  v_fma_f32 v154, v90, v170, v154
  v_fma_f32 v155, v91, v171, v155
  v_fma_f32 v156, v92, v172, v156
  v_fma_f32 v157, v93, v173, v157
  v_fma_f32 v158, v94, v174, v158
  s_waitcnt lgkmcnt(8)
  v_mfma_f32_32x32x16_bf16 v[116:131], v[32:35], v[64:67], v[116:131]
  ds_read_b64_tr_b16 v[48:49], v8 offset:2048
  ds_read_b64_tr_b16 v[50:51], v8 offset:2560
  v_fma_f32 v159, v95, v175, v159
  v_fma_f32 v160, v96, v176, v160
  v_fma_f32 v161, v97, v177, v161
  v_fma_f32 v162, v98, v178, v162
  v_fma_f32 v163, v99, v179, v163
  s_waitcnt lgkmcnt(7)
  v_mfma_f32_32x32x16_bf16 v[100:115], v[20:23], v[36:39], v[100:115]
  ds_read_b128 v[28:31], v5
  ds_read_b64_tr_b16 v[52:53], v7 offset:4096
  ds_read_b64_tr_b16 v[54:55], v7 offset:4608
  s_waitcnt lgkmcnt(8)
  v_mfma_f32_32x32x16_bf16 v[116:131], v[20:23], v[40:43], v[116:131]
  ds_read_b64_tr_b16 v[56:57], v8 offset:4096
  ds_read_b64_tr_b16 v[58:59], v8 offset:4608
  s_lshl_b32 s42, s24, 9
  v_add_u32 v10, s42, v180
  ds_read_b128 v[164:167], v10 offset:0
  ds_read_b128 v[168:171], v10 offset:32
  ds_read_b128 v[172:175], v10 offset:64
  ds_read_b128 v[176:179], v10 offset:96
  s_add_u32 s24, s24, 1
  s_and_b32 s24, s24, 7
  s_waitcnt lgkmcnt(7)
  v_mfma_f32_32x32x16_bf16 v[100:115], v[24:27], v[44:47], v[100:115]
  ds_read_b128 v[32:35], v6
  ds_read_b64_tr_b16 v[60:61], v7 offset:6144
  ds_read_b64_tr_b16 v[62:63], v7 offset:6656
  s_waitcnt lgkmcnt(8)
  v_mfma_f32_32x32x16_bf16 v[116:131], v[24:27], v[48:51], v[116:131]
  ds_read_b64_tr_b16 v[64:65], v8 offset:6144
  ds_read_b64_tr_b16 v[66:67], v8 offset:6656
  s_waitcnt lgkmcnt(7)
  v_mfma_f32_32x32x16_bf16 v[100:115], v[28:31], v[52:55], v[100:115]
  s_waitcnt lgkmcnt(5)
  v_mfma_f32_32x32x16_bf16 v[116:131], v[28:31], v[56:59], v[116:131]
  s_waitcnt lgkmcnt(2)
  v_mfma_f32_32x32x16_bf16 v[100:115], v[32:35], v[60:63], v[100:115]
  s_waitcnt lgkmcnt(0)
  v_mfma_f32_32x32x16_bf16 v[116:131], v[32:35], v[64:67], v[116:131]
  s_waitcnt lgkmcnt(0)
  s_nop 8
  v_fma_f32 v132, v100, v164, v132
  v_fma_f32 v133, v101, v165, v133
  v_fma_f32 v134, v102, v166, v134
  v_fma_f32 v135, v103, v167, v135
  v_fma_f32 v136, v104, v168, v136
  v_fma_f32 v137, v105, v169, v137
  v_fma_f32 v138, v106, v170, v138
  v_fma_f32 v139, v107, v171, v139
  v_fma_f32 v140, v108, v172, v140
  v_fma_f32 v141, v109, v173, v141
  v_fma_f32 v142, v110, v174, v142
  v_fma_f32 v143, v111, v175, v143
  v_fma_f32 v144, v112, v176, v144
  v_fma_f32 v145, v113, v177, v145
  v_fma_f32 v146, v114, v178, v146
  v_fma_f32 v147, v115, v179, v147
  v_fma_f32 v148, v116, v164, v148
  v_fma_f32 v149, v117, v165, v149
  v_fma_f32 v150, v118, v166, v150
  v_fma_f32 v151, v119, v167, v151
  v_fma_f32 v152, v120, v168, v152
  v_fma_f32 v153, v121, v169, v153
  v_fma_f32 v154, v122, v170, v154
  v_fma_f32 v155, v123, v171, v155
  v_fma_f32 v156, v124, v172, v156
  v_fma_f32 v157, v125, v173, v157
  v_fma_f32 v158, v126, v174, v158
  v_fma_f32 v159, v127, v175, v159
  v_fma_f32 v160, v128, v176, v160
  v_fma_f32 v161, v129, v177, v161
  v_fma_f32 v162, v130, v178, v162
  v_fma_f32 v163, v131, v179, v163
  v_and_b32 v10, 31, v2
  v_mul_u32_u24 v188, 272, v10
  s_lshl_b32 s42, s36, 6
  v_add_u32 v188, s42, v188
  v_lshrrev_b32 v11, 5, v2
  v_lshl_add_u32 v188, v11, 3, v188
  s_barrier
  v_cvt_pk_bf16_f32 v184, v132, v133
  v_cvt_pk_bf16_f32 v185, v134, v135
  ds_write_b64 v188, v[184:185] offset:0
  v_cvt_pk_bf16_f32 v186, v136, v137
  v_cvt_pk_bf16_f32 v187, v138, v139
  ds_write_b64 v188, v[186:187] offset:16
  v_cvt_pk_bf16_f32 v184, v140, v141
  v_cvt_pk_bf16_f32 v185, v142, v143
  ds_write_b64 v188, v[184:185] offset:32
  v_cvt_pk_bf16_f32 v186, v144, v145
  v_cvt_pk_bf16_f32 v187, v146, v147
  ds_write_b64 v188, v[186:187] offset:48
  v_cvt_pk_bf16_f32 v184, v148, v149
  v_cvt_pk_bf16_f32 v185, v150, v151
  ds_write_b64 v188, v[184:185] offset:8704
  v_cvt_pk_bf16_f32 v186, v152, v153
  v_cvt_pk_bf16_f32 v187, v154, v155
  ds_write_b64 v188, v[186:187] offset:8720
  v_cvt_pk_bf16_f32 v184, v156, v157
  v_cvt_pk_bf16_f32 v185, v158, v159
  ds_write_b64 v188, v[184:185] offset:8736
  v_cvt_pk_bf16_f32 v186, v160, v161
  v_cvt_pk_bf16_f32 v187, v162, v163
  ds_write_b64 v188, v[186:187] offset:8752
  s_waitcnt lgkmcnt(0)
  s_barrier
  s_branch P3_PV_CONV
P3_PV_LOADER:
  s_sub_u32 s36, s36, 4
  v_lshrrev_b32 v8, 3, v2
  v_lshrrev_b32 v9, 4, v2
  s_and_b32 s42, s36, 1
  s_lshl_b32 s42, s42, 2
  v_add_u32 v9, s42, v9
  v_and_b32 v10, 7, v2
  v_xor_b32 v10, v10, v9
  v_lshlrev_b32 v10, 4, v10
  v_mul_u32_u24 v8, 2048, v8
  v_add_u32 v3, v8, v10
  v_lshrrev_b32 v8, 3, v2
  v_bfe_u32 v9, v2, 4, 1
  v_lshlrev_b32 v9, 2, v9
  v_and_b32 v10, 7, v2
  v_xor_b32 v10, v10, v9
  v_lshlrev_b32 v10, 4, v10
  v_mul_u32_u24 v8, 1024, v8
  v_add_u32 v4, v8, v10
  v_mov_b32 v5, v3
  s_cmp_lg_u32 s37, 0
  s_cbranch_scc1 P3_pv_v
  s_cmp_ge_u32 s36, 2
  s_cbranch_scc1 P3_pv_v
  v_mov_b32 v5, 0x7ff00000
P3_pv_v:
  s_mul_i32 s45, s37, 96
  s_lshl_b32 s42, s36, 3
  s_add_u32 s45, s45, s42
  s_lshl_b32 s45, s45, 11
  s_lshl_b32 s46, s36, 14
  s_lshl_b32 s42, s38, 7
  s_add_u32 s46, s46, s42
  s_lshl_b32 s48, s36, 10
  s_lshl_b32 s49, s36, 11
  s_add_u32 s49, s49, 16384
  s_barrier
  s_mov_b32 s40, 4096
  s_mul_i32 s42, s39, 128
  s_add_u32 s42, s42, s45
  s_add_u32 s43, s40, s48
  s_mov_b32 m0, s43
  s_nop 0
  buffer_load_dwordx4 v5, s[8:11], s42 offen sc1 lds
  s_add_u32 m0, s43, 4096
  s_add_u32 s44, s42, 65536
  buffer_load_dwordx4 v3, s[8:11], s44 offen sc1 lds
  s_add_u32 m0, s43, 8192
  s_add_u32 s44, s42, 131072
  buffer_load_dwordx4 v3, s[8:11], s44 offen sc1 lds
  s_add_u32 m0, s43, 12288
  s_add_u32 s44, s42, 196608
  buffer_load_dwordx4 v3, s[8:11], s44 offen sc1 lds
  s_mul_i32 s42, s39, 65536
  s_add_u32 s42, s42, s46
  s_add_u32 s43, s40, s49
  s_mov_b32 m0, s43
  s_nop 0
  buffer_load_dwordx4 v4, s[12:15], s42 offen sc1 lds
  s_add_u32 m0, s43, 1024
  s_add_u32 s44, s42, 8192
  buffer_load_dwordx4 v4, s[12:15], s44 offen sc1 lds
  s_add_u32 s39, s39, 1
  s_and_b32 s39, s39, 15
  s_add_u32 s40, s40, 24576
  s_cmp_eq_u32 s40, 126976
  s_cselect_b32 s40, 4096, s40
  s_mul_i32 s42, s39, 128
  s_add_u32 s42, s42, s45
  s_add_u32 s43, s40, s48
  s_mov_b32 m0, s43
  s_nop 0
  buffer_load_dwordx4 v5, s[8:11], s42 offen sc1 lds
  s_add_u32 m0, s43, 4096
  s_add_u32 s44, s42, 65536
  buffer_load_dwordx4 v3, s[8:11], s44 offen sc1 lds
  s_add_u32 m0, s43, 8192
  s_add_u32 s44, s42, 131072
  buffer_load_dwordx4 v3, s[8:11], s44 offen sc1 lds
  s_add_u32 m0, s43, 12288
  s_add_u32 s44, s42, 196608
  buffer_load_dwordx4 v3, s[8:11], s44 offen sc1 lds
  s_mul_i32 s42, s39, 65536
  s_add_u32 s42, s42, s46
  s_add_u32 s43, s40, s49
  s_mov_b32 m0, s43
  s_nop 0
  buffer_load_dwordx4 v4, s[12:15], s42 offen sc1 lds
  s_add_u32 m0, s43, 1024
  s_add_u32 s44, s42, 8192
  buffer_load_dwordx4 v4, s[12:15], s44 offen sc1 lds
  s_add_u32 s39, s39, 1
  s_and_b32 s39, s39, 15
  s_add_u32 s40, s40, 24576
  s_cmp_eq_u32 s40, 126976
  s_cselect_b32 s40, 4096, s40
  s_mul_i32 s42, s39, 128
  s_add_u32 s42, s42, s45
  s_add_u32 s43, s40, s48
  s_mov_b32 m0, s43
  s_nop 0
  buffer_load_dwordx4 v5, s[8:11], s42 offen sc1 lds
  s_add_u32 m0, s43, 4096
  s_add_u32 s44, s42, 65536
  buffer_load_dwordx4 v3, s[8:11], s44 offen sc1 lds
  s_add_u32 m0, s43, 8192
  s_add_u32 s44, s42, 131072
  buffer_load_dwordx4 v3, s[8:11], s44 offen sc1 lds
  s_add_u32 m0, s43, 12288
  s_add_u32 s44, s42, 196608
  buffer_load_dwordx4 v3, s[8:11], s44 offen sc1 lds
  s_mul_i32 s42, s39, 65536
  s_add_u32 s42, s42, s46
  s_add_u32 s43, s40, s49
  s_mov_b32 m0, s43
  s_nop 0
  buffer_load_dwordx4 v4, s[12:15], s42 offen sc1 lds
  s_add_u32 m0, s43, 1024
  s_add_u32 s44, s42, 8192
  buffer_load_dwordx4 v4, s[12:15], s44 offen sc1 lds
  s_add_u32 s39, s39, 1
  s_and_b32 s39, s39, 15
  s_add_u32 s40, s40, 24576
  s_cmp_eq_u32 s40, 126976
  s_cselect_b32 s40, 4096, s40
  s_waitcnt vmcnt(12)
  s_barrier
  s_mov_b32 s41, 13
p3_LD_st_7:
  s_mul_i32 s42, s39, 128
  s_add_u32 s42, s42, s45
  s_add_u32 s43, s40, s48
  s_mov_b32 m0, s43
  s_nop 0
  buffer_load_dwordx4 v5, s[8:11], s42 offen sc1 lds
  s_add_u32 m0, s43, 4096
  s_add_u32 s44, s42, 65536
  buffer_load_dwordx4 v3, s[8:11], s44 offen sc1 lds
  s_add_u32 m0, s43, 8192
  s_add_u32 s44, s42, 131072
  buffer_load_dwordx4 v3, s[8:11], s44 offen sc1 lds
  s_add_u32 m0, s43, 12288
  s_add_u32 s44, s42, 196608
  buffer_load_dwordx4 v3, s[8:11], s44 offen sc1 lds
  s_mul_i32 s42, s39, 65536
  s_add_u32 s42, s42, s46
  s_add_u32 s43, s40, s49
  s_mov_b32 m0, s43
  s_nop 0
  buffer_load_dwordx4 v4, s[12:15], s42 offen sc1 lds
  s_add_u32 m0, s43, 1024
  s_add_u32 s44, s42, 8192
  buffer_load_dwordx4 v4, s[12:15], s44 offen sc1 lds
  s_add_u32 s39, s39, 1
  s_and_b32 s39, s39, 15
  s_add_u32 s40, s40, 24576
  s_cmp_eq_u32 s40, 126976
  s_cselect_b32 s40, 4096, s40
  s_waitcnt vmcnt(12)
  s_barrier
  s_sub_u32 s41, s41, 1
  s_cmp_lg_u32 s41, 0
  s_cbranch_scc1 p3_LD_st_7
  s_waitcnt vmcnt(6)
  s_barrier
  s_waitcnt vmcnt(0)
  s_barrier
  s_barrier
  s_barrier
P3_PV_CONV:
  v_lshrrev_b32 v12, 4, v2
  v_lshlrev_b32 v12, 3, v12
  v_and_b32 v13, 15, v2
  v_sub_u32 v12, v12, v13
  v_add_u32 v12, 15, v12
  v_lshlrev_b32 v12, 1, v12
  v_and_b32 v13, 1, v13
  v_xor_b32 v13, 1, v13
  v_mul_u32_u24 v13, 190, v13
  v_add_u32 v12, v12, v13
  v_add_u32 v8, 126976, v12
  s_mul_i32 s42, s58, 3104
  v_add_u32 v8, s42, v8
  v_lshrrev_b32 v13, 4, v2
  v_lshlrev_b32 v12, 3, v13
  v_sub_u32 v6, v8, v12
  v_and_b32 v12, 15, v2
  v_min_u32 v14, 5, v12
  v_lshlrev_b32 v14, 5, v14
  v_lshl_add_u32 v9, v13, 4, v14
  s_mul_i32 s42, s58, 2176
  s_add_u32 s42, s42, 0
  v_add_u32 v9, s42, v9
  v_lshl_add_u32 v10, v13, 3, v14
  v_add_u32 v10, s42, v10
  v_lshlrev_b32 v15, 4, v12
  v_and_b32 v12, 2, v13
  v_lshl_add_u32 v15, v12, 2, v15
  v_cmp_gt_u32 vcc, s26, v15
  v_lshlrev_b32 v15, 1, v15
  v_and_b32 v12, 1, v13
  v_lshl_add_u32 v15, v12, 12, v15
  v_cndmask_b32 v11, -1, v15, vcc
  s_mul_i32 s42, s58, 32768
  s_add_u32 s42, s42, s25
  v_add_u32 v96, 0, v8
  v_add_u32 v97, 0, v6
  ds_read2_b32 v[16:17], v96 offset0:0 offset1:1
  ds_read2_b32 v[18:19], v96 offset0:2 offset1:3
  ds_read_b128 v[20:23], v9 offset:0
  ds_read2_b32 v[24:25], v97 offset0:16 offset1:17
  ds_read_b64 v[26:27], v10 offset:64
  ds_read_b64 v[28:29], v10 offset:32
  ds_read2_b32 v[32:33], v96 offset0:97 offset1:98
  ds_read2_b32 v[34:35], v96 offset0:99 offset1:100
  ds_read_b128 v[36:39], v9 offset:272
  ds_read2_b32 v[40:41], v97 offset0:113 offset1:114
  ds_read_b64 v[42:43], v10 offset:336
  ds_read_b64 v[44:45], v10 offset:304
  s_waitcnt lgkmcnt(3)
  v_add_u32 v98, 776, v8
  v_add_u32 v99, 776, v6
  ds_read2_b32 v[48:49], v98 offset0:0 offset1:1
  ds_read2_b32 v[50:51], v98 offset0:2 offset1:3
  ds_read_b128 v[52:55], v9 offset:544
  ds_read2_b32 v[56:57], v99 offset0:16 offset1:17
  ds_read_b64 v[58:59], v10 offset:608
  ds_read_b64 v[60:61], v10 offset:576
  ds_read2_b32 v[64:65], v98 offset0:97 offset1:98
  ds_read2_b32 v[66:67], v98 offset0:99 offset1:100
  ds_read_b128 v[68:71], v9 offset:816
  ds_read2_b32 v[72:73], v99 offset0:113 offset1:114
  ds_read_b64 v[74:75], v10 offset:880
  ds_read_b64 v[76:77], v10 offset:848
  s_waitcnt lgkmcnt(15)
  v_lshlrev_b32 v80, 16, v28
  v_and_b32 v81, 0xffff0000, v28
  v_lshlrev_b32 v82, 16, v29
  v_and_b32 v83, 0xffff0000, v29
  s_nop 1
  v_mfma_f32_16x16x32_bf16 v[80:83], v[16:19], v[20:23], v[80:83]
  s_waitcnt lgkmcnt(12)
  v_lshlrev_b32 v84, 16, v44
  v_and_b32 v85, 0xffff0000, v44
  v_lshlrev_b32 v86, 16, v45
  v_and_b32 v87, 0xffff0000, v45
  s_nop 1
  v_mfma_f32_16x16x32_bf16 v[84:87], v[32:35], v[36:39], v[84:87]
  v_mfma_f32_16x16x16_bf16 v[80:83], v[24:25], v[26:27], v[80:83]
  s_nop 4
  v_mfma_f32_16x16x16_bf16 v[84:87], v[40:41], v[42:43], v[84:87]
  s_waitcnt lgkmcnt(3)
  v_add_u32 v96, 1552, v8
  v_add_u32 v97, 1552, v6
  ds_read2_b32 v[16:17], v96 offset0:0 offset1:1
  ds_read2_b32 v[18:19], v96 offset0:2 offset1:3
  ds_read_b128 v[20:23], v9 offset:1088
  ds_read2_b32 v[24:25], v97 offset0:16 offset1:17
  ds_read_b64 v[26:27], v10 offset:1152
  ds_read_b64 v[28:29], v10 offset:1120
  ds_read2_b32 v[32:33], v96 offset0:97 offset1:98
  ds_read2_b32 v[34:35], v96 offset0:99 offset1:100
  ds_read_b128 v[36:39], v9 offset:1360
  ds_read2_b32 v[40:41], v97 offset0:113 offset1:114
  ds_read_b64 v[42:43], v10 offset:1424
  ds_read_b64 v[44:45], v10 offset:1392
  s_waitcnt lgkmcnt(15)
  v_lshlrev_b32 v88, 16, v60
  v_and_b32 v89, 0xffff0000, v60
  v_lshlrev_b32 v90, 16, v61
  v_and_b32 v91, 0xffff0000, v61
  s_nop 1
  v_mfma_f32_16x16x32_bf16 v[88:91], v[48:51], v[52:55], v[88:91]
  s_waitcnt lgkmcnt(12)
  v_lshlrev_b32 v92, 16, v76
  v_and_b32 v93, 0xffff0000, v76
  v_lshlrev_b32 v94, 16, v77
  v_and_b32 v95, 0xffff0000, v77
  s_nop 1
  v_mfma_f32_16x16x32_bf16 v[92:95], v[64:67], v[68:71], v[92:95]
  v_cvt_pk_bf16_f32 v100, v80, v81
  v_cvt_pk_bf16_f32 v101, v82, v83
  v_cvt_pk_bf16_f32 v102, v84, v85
  v_cvt_pk_bf16_f32 v103, v86, v87
  s_nop 0
  v_permlane16_swap_b32 v100, v102
  v_permlane16_swap_b32 v101, v103
  s_add_u32 s43, s42, 0
  buffer_store_dwordx4 v[100:103], v11, s[16:19], s43 offen sc1
  v_mfma_f32_16x16x16_bf16 v[88:91], v[56:57], v[58:59], v[88:91]
  v_mfma_f32_16x16x16_bf16 v[92:95], v[72:73], v[74:75], v[92:95]
  s_waitcnt lgkmcnt(3)
  v_add_u32 v98, 2328, v8
  v_add_u32 v99, 2328, v6
  ds_read2_b32 v[48:49], v98 offset0:0 offset1:1
  ds_read2_b32 v[50:51], v98 offset0:2 offset1:3
  ds_read_b128 v[52:55], v9 offset:1632
  ds_read2_b32 v[56:57], v99 offset0:16 offset1:17
  ds_read_b64 v[58:59], v10 offset:1696
  ds_read_b64 v[60:61], v10 offset:1664
  ds_read2_b32 v[64:65], v98 offset0:97 offset1:98
  ds_read2_b32 v[66:67], v98 offset0:99 offset1:100
  ds_read_b128 v[68:71], v9 offset:1904
  ds_read2_b32 v[72:73], v99 offset0:113 offset1:114
  ds_read_b64 v[74:75], v10 offset:1968
  ds_read_b64 v[76:77], v10 offset:1936
  s_waitcnt lgkmcnt(15)
  v_lshlrev_b32 v80, 16, v28
  v_and_b32 v81, 0xffff0000, v28
  v_lshlrev_b32 v82, 16, v29
  v_and_b32 v83, 0xffff0000, v29
  s_nop 1
  v_mfma_f32_16x16x32_bf16 v[80:83], v[16:19], v[20:23], v[80:83]
  s_waitcnt lgkmcnt(12)
  v_lshlrev_b32 v84, 16, v44
  v_and_b32 v85, 0xffff0000, v44
  v_lshlrev_b32 v86, 16, v45
  v_and_b32 v87, 0xffff0000, v45
  s_nop 1
  v_mfma_f32_16x16x32_bf16 v[84:87], v[32:35], v[36:39], v[84:87]
  v_cvt_pk_bf16_f32 v104, v88, v89
  v_cvt_pk_bf16_f32 v105, v90, v91
  v_cvt_pk_bf16_f32 v106, v92, v93
  v_cvt_pk_bf16_f32 v107, v94, v95
  s_nop 0
  v_permlane16_swap_b32 v104, v106
  v_permlane16_swap_b32 v105, v107
  s_add_u32 s43, s42, 8192
  buffer_store_dwordx4 v[104:107], v11, s[16:19], s43 offen sc1
  v_mfma_f32_16x16x16_bf16 v[80:83], v[24:25], v[26:27], v[80:83]
  v_mfma_f32_16x16x16_bf16 v[84:87], v[40:41], v[42:43], v[84:87]
  s_waitcnt lgkmcnt(6)
  v_lshlrev_b32 v88, 16, v60
  v_and_b32 v89, 0xffff0000, v60
  v_lshlrev_b32 v90, 16, v61
  v_and_b32 v91, 0xffff0000, v61
  s_nop 1
  v_mfma_f32_16x16x32_bf16 v[88:91], v[48:51], v[52:55], v[88:91]
  s_waitcnt lgkmcnt(0)
  v_lshlrev_b32 v92, 16, v76
  v_and_b32 v93, 0xffff0000, v76
  v_lshlrev_b32 v94, 16, v77
  v_and_b32 v95, 0xffff0000, v77
  s_nop 1
  v_mfma_f32_16x16x32_bf16 v[92:95], v[64:67], v[68:71], v[92:95]
  v_cvt_pk_bf16_f32 v100, v80, v81
  v_cvt_pk_bf16_f32 v101, v82, v83
  v_cvt_pk_bf16_f32 v102, v84, v85
  v_cvt_pk_bf16_f32 v103, v86, v87
  s_nop 0
  v_permlane16_swap_b32 v100, v102
  v_permlane16_swap_b32 v101, v103
  s_add_u32 s43, s42, 16384
  buffer_store_dwordx4 v[100:103], v11, s[16:19], s43 offen sc1
  v_mfma_f32_16x16x16_bf16 v[88:91], v[56:57], v[58:59], v[88:91]
  v_mfma_f32_16x16x16_bf16 v[92:95], v[72:73], v[74:75], v[92:95]
  s_nop 6
  v_cvt_pk_bf16_f32 v104, v88, v89
  v_cvt_pk_bf16_f32 v105, v90, v91
  v_cvt_pk_bf16_f32 v106, v92, v93
  v_cvt_pk_bf16_f32 v107, v94, v95
  s_nop 0
  v_permlane16_swap_b32 v104, v106
  v_permlane16_swap_b32 v105, v107
  s_add_u32 s43, s42, 24576
  buffer_store_dwordx4 v[104:107], v11, s[16:19], s43 offen sc1
  s_branch P3_FIN
P3_LOC:
  s_sub_u32 s50, s50, 22
  s_and_b32 s42, s47, 3
  s_lshl_b32 s37, s42, 1
  s_lshr_b32 s42, s50, 2
  s_add_u32 s37, s37, s42
  s_and_b32 s38, s50, 3
  s_mov_b32 s39, s50
  s_mov_b32 s39, 0
  s_lshl_b32 s43, s37, 7
  s_add_u32 s25, s38, 4
  s_lshl_b32 s25, s25, 19
  s_mul_i32 s42, s51, 1000
  s_add_u32 s42, s42, s43
  s_lshl_b32 s42, s42, 1
  s_mov_b32 s24, s42
  s_add_u32 s25, s25, s42
  s_sub_u32 s26, 1000, s43
  s_min_u32 s26, s26, 128
  s_lshl_b32 s27, s38, 8
  s_add_u32 s27, s27, 1024
  s_add_u32 s8, s4, 17825728
  s_addc_u32 s9, s5, 0
  s_mov_b32 s10, 2097216
  s_mov_b32 s11, 0x20000
  s_mov_b32 s12, s6
  s_mov_b32 s13, s7
  s_mov_b32 s14, 524288
  s_mov_b32 s15, 0x20000
  v_lshrrev_b32 v16, 7, v0
  v_add_u32 v16, 0, v16
  v_and_b32 v17, 127, v0
  v_lshlrev_b32 v18, 11, v16
  v_lshl_add_u32 v18, v17, 1, v18
  v_cmp_gt_u32 vcc, 31, v16
  s_nop 1
  v_cndmask_b32 v18, -1, v18, vcc
  buffer_load_ushort v240, v18, s[28:31], s27 offen
  v_lshrrev_b32 v16, 7, v0
  v_add_u32 v16, 4, v16
  v_and_b32 v17, 127, v0
  v_lshlrev_b32 v18, 11, v16
  v_lshl_add_u32 v18, v17, 1, v18
  v_cmp_gt_u32 vcc, 31, v16
  s_nop 1
  v_cndmask_b32 v18, -1, v18, vcc
  buffer_load_ushort v241, v18, s[28:31], s27 offen
  v_lshrrev_b32 v16, 7, v0
  v_add_u32 v16, 8, v16
  v_and_b32 v17, 127, v0
  v_lshlrev_b32 v18, 11, v16
  v_lshl_add_u32 v18, v17, 1, v18
  v_cmp_gt_u32 vcc, 31, v16
  s_nop 1
  v_cndmask_b32 v18, -1, v18, vcc
  buffer_load_ushort v242, v18, s[28:31], s27 offen
  v_lshrrev_b32 v16, 7, v0
  v_add_u32 v16, 12, v16
  v_and_b32 v17, 127, v0
  v_lshlrev_b32 v18, 11, v16
  v_lshl_add_u32 v18, v17, 1, v18
  v_cmp_gt_u32 vcc, 31, v16
  s_nop 1
  v_cndmask_b32 v18, -1, v18, vcc
  buffer_load_ushort v243, v18, s[28:31], s27 offen
  v_lshrrev_b32 v16, 7, v0
  v_add_u32 v16, 16, v16
  v_and_b32 v17, 127, v0
  v_lshlrev_b32 v18, 11, v16
  v_lshl_add_u32 v18, v17, 1, v18
  v_cmp_gt_u32 vcc, 31, v16
  s_nop 1
  v_cndmask_b32 v18, -1, v18, vcc
  buffer_load_ushort v244, v18, s[28:31], s27 offen
  v_lshrrev_b32 v16, 7, v0
  v_add_u32 v16, 20, v16
  v_and_b32 v17, 127, v0
  v_lshlrev_b32 v18, 11, v16
  v_lshl_add_u32 v18, v17, 1, v18
  v_cmp_gt_u32 vcc, 31, v16
  s_nop 1
  v_cndmask_b32 v18, -1, v18, vcc
  buffer_load_ushort v245, v18, s[28:31], s27 offen
  v_lshrrev_b32 v16, 7, v0
  v_add_u32 v16, 24, v16
  v_and_b32 v17, 127, v0
  v_lshlrev_b32 v18, 11, v16
  v_lshl_add_u32 v18, v17, 1, v18
  v_cmp_gt_u32 vcc, 31, v16
  s_nop 1
  v_cndmask_b32 v18, -1, v18, vcc
  buffer_load_ushort v246, v18, s[28:31], s27 offen
  v_lshrrev_b32 v16, 7, v0
  v_add_u32 v16, 28, v16
  v_and_b32 v17, 127, v0
  v_lshlrev_b32 v18, 11, v16
  v_lshl_add_u32 v18, v17, 1, v18
  v_cmp_gt_u32 vcc, 31, v16
  s_nop 1
  v_cndmask_b32 v18, -1, v18, vcc
  buffer_load_ushort v247, v18, s[28:31], s27 offen
  s_lshl_b32 s101, s51, 5
  s_lshl_b32 s42, s37, 2
  s_add_u32 s101, s101, s42
  s_add_u32 s101, s101, s38
  s_add_u32 s101, s101, 176
  s_cmp_ge_u32 s36, 4
  s_cbranch_scc1 P3_LOC_LOADER
  v_lshrrev_b32 v6, 5, v2
  v_lshlrev_b32 v6, 3, v6
  v_bfe_u32 v7, v2, 2, 2
  v_add_u32 v6, v6, v7
  v_bfe_u32 v8, v2, 4, 1
  v_lshlrev_b32 v8, 5, v8
  v_and_b32 v9, 3, v2
  v_lshl_add_u32 v8, v9, 3, v8
  v_mul_u32_u24 v3, 320, v6
  v_add_u32 v3, v3, v8
  v_lshrrev_b32 v6, 5, v2
  v_lshlrev_b32 v6, 3, v6
  v_bfe_u32 v7, v2, 2, 2
  v_add_u32 v6, v6, v7
  v_bfe_u32 v8, v2, 4, 1
  v_lshlrev_b32 v8, 5, v8
  v_and_b32 v9, 3, v2
  v_lshl_add_u32 v8, v9, 3, v8
  v_lshlrev_b32 v9, 8, v6
  v_add_u32 v9, v9, v8
  v_add_u32 v9, 20480, v9
  v_bfe_u32 v10, v2, 2, 2
  v_xor_b32 v10, s36, v10
  v_lshlrev_b32 v10, 6, v10
  v_add_u32 v4, v9, v10
  s_mov_b32 s53, 0
  s_mov_b32 s56, 4294856704
  s_mov_b32 s57, 36864
  v_mov_b32 v64, 0
  v_mov_b32 v65, 0
  v_mov_b32 v66, 0
  v_mov_b32 v67, 0
  v_mov_b32 v68, 0
  v_mov_b32 v69, 0
  v_mov_b32 v70, 0
  v_mov_b32 v71, 0
  v_mov_b32 v72, 0
  v_mov_b32 v73, 0
  v_mov_b32 v74, 0
  v_mov_b32 v75, 0
  v_mov_b32 v76, 0
  v_mov_b32 v77, 0
  v_mov_b32 v78, 0
  v_mov_b32 v79, 0
  v_mov_b32 v80, 0
  v_mov_b32 v81, 0
  v_mov_b32 v82, 0
  v_mov_b32 v83, 0
  v_mov_b32 v84, 0
  v_mov_b32 v85, 0
  v_mov_b32 v86, 0
  v_mov_b32 v87, 0
  v_mov_b32 v88, 0
  v_mov_b32 v89, 0
  v_mov_b32 v90, 0
  v_mov_b32 v91, 0
  v_mov_b32 v92, 0
  v_mov_b32 v93, 0
  v_mov_b32 v94, 0
  v_mov_b32 v95, 0
  v_mov_b32 v96, 0
  v_mov_b32 v97, 0
  v_mov_b32 v98, 0
  v_mov_b32 v99, 0
  v_mov_b32 v100, 0
  v_mov_b32 v101, 0
  v_mov_b32 v102, 0
  v_mov_b32 v103, 0
  v_mov_b32 v104, 0
  v_mov_b32 v105, 0
  v_mov_b32 v106, 0
  v_mov_b32 v107, 0
  v_mov_b32 v108, 0
  v_mov_b32 v109, 0
  v_mov_b32 v110, 0
  v_mov_b32 v111, 0
  v_mov_b32 v112, 0
  v_mov_b32 v113, 0
  v_mov_b32 v114, 0
  v_mov_b32 v115, 0
  v_mov_b32 v116, 0
  v_mov_b32 v117, 0
  v_mov_b32 v118, 0
  v_mov_b32 v119, 0
  v_mov_b32 v120, 0
  v_mov_b32 v121, 0
  v_mov_b32 v122, 0
  v_mov_b32 v123, 0
  v_mov_b32 v124, 0
  v_mov_b32 v125, 0
  v_mov_b32 v126, 0
  v_mov_b32 v127, 0
  v_mov_b32 v128, 0
  v_mov_b32 v129, 0
  v_mov_b32 v130, 0
  v_mov_b32 v131, 0
  v_mov_b32 v132, 0
  v_mov_b32 v133, 0
  v_mov_b32 v134, 0
  v_mov_b32 v135, 0
  v_mov_b32 v136, 0
  v_mov_b32 v137, 0
  v_mov_b32 v138, 0
  v_mov_b32 v139, 0
  v_mov_b32 v140, 0
  v_mov_b32 v141, 0
  v_mov_b32 v142, 0
  v_mov_b32 v143, 0
  s_cmp_lg_u32 s58, 0
  s_cbranch_scc1 p3_gwd_8
  s_lshl_b32 s96, s37, 7
  s_add_u32 s97, s96, 143
  s_min_u32 s97, s97, 999
  s_lshr_b32 s97, s97, 8
  s_max_u32 s96, s96, 16
  s_sub_u32 s96, s96, 16
  s_lshr_b32 s96, s96, 8
  v_mov_b32 v7, s96
  v_mov_b32 v8, s97
  v_bfe_u32 v9, v2, 3, 1
  v_cmp_eq_u32 vcc, 1, v9
  s_nop 1
  v_cndmask_b32 v7, v7, v8, vcc
  s_lshl_b32 s96, s51, 2
  s_add_u32 s96, s96, 192
  v_add_u32 v7, s96, v7
  v_and_b32 v8, 7, v2
  v_lshl_add_u32 v6, v8, 3, v7
  v_lshlrev_b32 v6, 7, v6
  s_mov_b32 s97, 32768
  s_mov_b32 s96, 0x200000
p3_gw_9:
  buffer_load_dword v7, v6, s[92:95], s97 offen sc1
  s_waitcnt vmcnt(0)
  v_cmp_ne_u32 vcc, s3, v7
  s_sub_u32 s96, s96, 1
  s_cmp_eq_u32 s96, 0
  s_cbranch_scc1 p3_gwd_8
  s_nop 1
  s_cbranch_vccnz p3_gw_9
p3_gwd_8:
  s_barrier
  s_barrier
  ds_read_b64_tr_b16 v[56:57], v4 offset:0
  ds_read_b64_tr_b16 v[58:59], v4 offset:1024
  ds_read_b64_tr_b16 v[16:17], v3 offset:0
  ds_read_b64_tr_b16 v[18:19], v3 offset:1280
  ds_read_b64_tr_b16 v[20:21], v3 offset:64
  ds_read_b64_tr_b16 v[22:23], v3 offset:1344
  ds_read_b64_tr_b16 v[24:25], v3 offset:128
  ds_read_b64_tr_b16 v[26:27], v3 offset:1408
  ds_read_b64_tr_b16 v[28:29], v3 offset:192
  ds_read_b64_tr_b16 v[30:31], v3 offset:1472
  ds_read_b64_tr_b16 v[32:33], v3 offset:256
  ds_read_b64_tr_b16 v[34:35], v3 offset:1536
  s_mov_b32 s41, 7
p3_L_loop_10:
  s_waitcnt lgkmcnt(8)
  v_mfma_f32_32x32x16_bf16 v[64:79], v[16:19], v[56:59], v[64:79]
  ds_read_b64_tr_b16 v[60:61], v4 offset:4096
  ds_read_b64_tr_b16 v[62:63], v4 offset:5120
  ds_read_b64_tr_b16 v[36:37], v3 offset:5120
  ds_read_b64_tr_b16 v[38:39], v3 offset:6400
  s_waitcnt lgkmcnt(10)
  v_mfma_f32_32x32x16_bf16 v[80:95], v[20:23], v[56:59], v[80:95]
  ds_read_b64_tr_b16 v[40:41], v3 offset:5184
  ds_read_b64_tr_b16 v[42:43], v3 offset:6464
  ds_read_b64_tr_b16 v[44:45], v3 offset:5248
  ds_read_b64_tr_b16 v[46:47], v3 offset:6528
  s_waitcnt lgkmcnt(12)
  v_mfma_f32_32x32x16_bf16 v[96:111], v[24:27], v[56:59], v[96:111]
  ds_read_b64_tr_b16 v[48:49], v3 offset:5312
  ds_read_b64_tr_b16 v[50:51], v3 offset:6592
  ds_read_b64_tr_b16 v[52:53], v3 offset:5376
  ds_read_b64_tr_b16 v[54:55], v3 offset:6656
  s_waitcnt lgkmcnt(14)
  v_mfma_f32_32x32x16_bf16 v[112:127], v[28:31], v[56:59], v[112:127]
  s_waitcnt lgkmcnt(12)
  v_mfma_f32_32x32x16_bf16 v[128:143], v[32:35], v[56:59], v[128:143]
  s_waitcnt lgkmcnt(8)
  v_mfma_f32_32x32x16_bf16 v[64:79], v[36:39], v[60:63], v[64:79]
  ds_read_b64_tr_b16 v[56:57], v4 offset:8192
  ds_read_b64_tr_b16 v[58:59], v4 offset:9216
  ds_read_b64_tr_b16 v[16:17], v3 offset:10240
  ds_read_b64_tr_b16 v[18:19], v3 offset:11520
  s_waitcnt lgkmcnt(10)
  v_mfma_f32_32x32x16_bf16 v[80:95], v[40:43], v[60:63], v[80:95]
  ds_read_b64_tr_b16 v[20:21], v3 offset:10304
  ds_read_b64_tr_b16 v[22:23], v3 offset:11584
  ds_read_b64_tr_b16 v[24:25], v3 offset:10368
  ds_read_b64_tr_b16 v[26:27], v3 offset:11648
  s_waitcnt lgkmcnt(12)
  v_mfma_f32_32x32x16_bf16 v[96:111], v[44:47], v[60:63], v[96:111]
  ds_read_b64_tr_b16 v[28:29], v3 offset:10432
  ds_read_b64_tr_b16 v[30:31], v3 offset:11712
  ds_read_b64_tr_b16 v[32:33], v3 offset:10496
  ds_read_b64_tr_b16 v[34:35], v3 offset:11776
  s_waitcnt lgkmcnt(14)
  v_mfma_f32_32x32x16_bf16 v[112:127], v[48:51], v[60:63], v[112:127]
  s_waitcnt lgkmcnt(12)
  v_mfma_f32_32x32x16_bf16 v[128:143], v[52:55], v[60:63], v[128:143]
  s_waitcnt lgkmcnt(8)
  v_mfma_f32_32x32x16_bf16 v[64:79], v[16:19], v[56:59], v[64:79]
  ds_read_b64_tr_b16 v[60:61], v4 offset:12288
  ds_read_b64_tr_b16 v[62:63], v4 offset:13312
  ds_read_b64_tr_b16 v[36:37], v3 offset:15360
  ds_read_b64_tr_b16 v[38:39], v3 offset:16640
  s_waitcnt lgkmcnt(10)
  v_mfma_f32_32x32x16_bf16 v[80:95], v[20:23], v[56:59], v[80:95]
  ds_read_b64_tr_b16 v[40:41], v3 offset:15424
  ds_read_b64_tr_b16 v[42:43], v3 offset:16704
  ds_read_b64_tr_b16 v[44:45], v3 offset:15488
  ds_read_b64_tr_b16 v[46:47], v3 offset:16768
  s_waitcnt lgkmcnt(12)
  v_mfma_f32_32x32x16_bf16 v[96:111], v[24:27], v[56:59], v[96:111]
  ds_read_b64_tr_b16 v[48:49], v3 offset:15552
  ds_read_b64_tr_b16 v[50:51], v3 offset:16832
  ds_read_b64_tr_b16 v[52:53], v3 offset:15616
  ds_read_b64_tr_b16 v[54:55], v3 offset:16896
  s_waitcnt lgkmcnt(14)
  v_mfma_f32_32x32x16_bf16 v[112:127], v[28:31], v[56:59], v[112:127]
  s_waitcnt lgkmcnt(12)
  v_mfma_f32_32x32x16_bf16 v[128:143], v[32:35], v[56:59], v[128:143]
  s_barrier
  s_add_u32 s53, s53, 36864
  s_cmp_eq_u32 s53, 147456
  s_cselect_b32 s52, s56, s57
  s_cselect_b32 s53, 0, s53
  v_add_u32 v3, s52, v3
  v_add_u32 v4, s52, v4
  s_waitcnt lgkmcnt(8)
  v_mfma_f32_32x32x16_bf16 v[64:79], v[36:39], v[60:63], v[64:79]
  ds_read_b64_tr_b16 v[56:57], v4 offset:0
  ds_read_b64_tr_b16 v[58:59], v4 offset:1024
  ds_read_b64_tr_b16 v[16:17], v3 offset:0
  ds_read_b64_tr_b16 v[18:19], v3 offset:1280
  s_waitcnt lgkmcnt(10)
  v_mfma_f32_32x32x16_bf16 v[80:95], v[40:43], v[60:63], v[80:95]
  ds_read_b64_tr_b16 v[20:21], v3 offset:64
  ds_read_b64_tr_b16 v[22:23], v3 offset:1344
  ds_read_b64_tr_b16 v[24:25], v3 offset:128
  ds_read_b64_tr_b16 v[26:27], v3 offset:1408
  s_waitcnt lgkmcnt(12)
  v_mfma_f32_32x32x16_bf16 v[96:111], v[44:47], v[60:63], v[96:111]
  ds_read_b64_tr_b16 v[28:29], v3 offset:192
  ds_read_b64_tr_b16 v[30:31], v3 offset:1472
  ds_read_b64_tr_b16 v[32:33], v3 offset:256
  ds_read_b64_tr_b16 v[34:35], v3 offset:1536
  s_waitcnt lgkmcnt(14)
  v_mfma_f32_32x32x16_bf16 v[112:127], v[48:51], v[60:63], v[112:127]
  s_waitcnt lgkmcnt(12)
  v_mfma_f32_32x32x16_bf16 v[128:143], v[52:55], v[60:63], v[128:143]
  s_sub_u32 s41, s41, 1
  s_cmp_lg_u32 s41, 0
  s_cbranch_scc1 p3_L_loop_10
  s_waitcnt lgkmcnt(8)
  v_mfma_f32_32x32x16_bf16 v[64:79], v[16:19], v[56:59], v[64:79]
  ds_read_b64_tr_b16 v[60:61], v4 offset:4096
  ds_read_b64_tr_b16 v[62:63], v4 offset:5120
  ds_read_b64_tr_b16 v[36:37], v3 offset:5120
  ds_read_b64_tr_b16 v[38:39], v3 offset:6400
  s_waitcnt lgkmcnt(10)
  v_mfma_f32_32x32x16_bf16 v[80:95], v[20:23], v[56:59], v[80:95]
  ds_read_b64_tr_b16 v[40:41], v3 offset:5184
  ds_read_b64_tr_b16 v[42:43], v3 offset:6464
  ds_read_b64_tr_b16 v[44:45], v3 offset:5248
  ds_read_b64_tr_b16 v[46:47], v3 offset:6528
  s_waitcnt lgkmcnt(12)
  v_mfma_f32_32x32x16_bf16 v[96:111], v[24:27], v[56:59], v[96:111]
  ds_read_b64_tr_b16 v[48:49], v3 offset:5312
  ds_read_b64_tr_b16 v[50:51], v3 offset:6592
  ds_read_b64_tr_b16 v[52:53], v3 offset:5376
  ds_read_b64_tr_b16 v[54:55], v3 offset:6656
  s_waitcnt lgkmcnt(14)
  v_mfma_f32_32x32x16_bf16 v[112:127], v[28:31], v[56:59], v[112:127]
  s_waitcnt lgkmcnt(12)
  v_mfma_f32_32x32x16_bf16 v[128:143], v[32:35], v[56:59], v[128:143]
  s_waitcnt lgkmcnt(8)
  v_mfma_f32_32x32x16_bf16 v[64:79], v[36:39], v[60:63], v[64:79]
  ds_read_b64_tr_b16 v[56:57], v4 offset:8192
  ds_read_b64_tr_b16 v[58:59], v4 offset:9216
  ds_read_b64_tr_b16 v[16:17], v3 offset:10240
  ds_read_b64_tr_b16 v[18:19], v3 offset:11520
  s_waitcnt lgkmcnt(10)
  v_mfma_f32_32x32x16_bf16 v[80:95], v[40:43], v[60:63], v[80:95]
  ds_read_b64_tr_b16 v[20:21], v3 offset:10304
  ds_read_b64_tr_b16 v[22:23], v3 offset:11584
  ds_read_b64_tr_b16 v[24:25], v3 offset:10368
  ds_read_b64_tr_b16 v[26:27], v3 offset:11648
  s_waitcnt lgkmcnt(12)
  v_mfma_f32_32x32x16_bf16 v[96:111], v[44:47], v[60:63], v[96:111]
  ds_read_b64_tr_b16 v[28:29], v3 offset:10432
  ds_read_b64_tr_b16 v[30:31], v3 offset:11712
  ds_read_b64_tr_b16 v[32:33], v3 offset:10496
  ds_read_b64_tr_b16 v[34:35], v3 offset:11776
  s_waitcnt lgkmcnt(14)
  v_mfma_f32_32x32x16_bf16 v[112:127], v[48:51], v[60:63], v[112:127]
  s_waitcnt lgkmcnt(12)
  v_mfma_f32_32x32x16_bf16 v[128:143], v[52:55], v[60:63], v[128:143]
  s_waitcnt lgkmcnt(8)
  v_mfma_f32_32x32x16_bf16 v[64:79], v[16:19], v[56:59], v[64:79]
  ds_read_b64_tr_b16 v[60:61], v4 offset:12288
  ds_read_b64_tr_b16 v[62:63], v4 offset:13312
  ds_read_b64_tr_b16 v[36:37], v3 offset:15360
  ds_read_b64_tr_b16 v[38:39], v3 offset:16640
  s_waitcnt lgkmcnt(10)
  v_mfma_f32_32x32x16_bf16 v[80:95], v[20:23], v[56:59], v[80:95]
  ds_read_b64_tr_b16 v[40:41], v3 offset:15424
  ds_read_b64_tr_b16 v[42:43], v3 offset:16704
  ds_read_b64_tr_b16 v[44:45], v3 offset:15488
  ds_read_b64_tr_b16 v[46:47], v3 offset:16768
  s_waitcnt lgkmcnt(12)
  v_mfma_f32_32x32x16_bf16 v[96:111], v[24:27], v[56:59], v[96:111]
  ds_read_b64_tr_b16 v[48:49], v3 offset:15552
  ds_read_b64_tr_b16 v[50:51], v3 offset:16832
  ds_read_b64_tr_b16 v[52:53], v3 offset:15616
  ds_read_b64_tr_b16 v[54:55], v3 offset:16896
  s_waitcnt lgkmcnt(14)
  v_mfma_f32_32x32x16_bf16 v[112:127], v[28:31], v[56:59], v[112:127]
  s_waitcnt lgkmcnt(12)
  v_mfma_f32_32x32x16_bf16 v[128:143], v[32:35], v[56:59], v[128:143]
  s_waitcnt lgkmcnt(8)
  v_mfma_f32_32x32x16_bf16 v[64:79], v[36:39], v[60:63], v[64:79]
  s_waitcnt lgkmcnt(6)
  v_mfma_f32_32x32x16_bf16 v[80:95], v[40:43], v[60:63], v[80:95]
  s_waitcnt lgkmcnt(4)
  v_mfma_f32_32x32x16_bf16 v[96:111], v[44:47], v[60:63], v[96:111]
  s_waitcnt lgkmcnt(2)
  v_mfma_f32_32x32x16_bf16 v[112:127], v[48:51], v[60:63], v[112:127]
  s_waitcnt lgkmcnt(0)
  v_mfma_f32_32x32x16_bf16 v[128:143], v[52:55], v[60:63], v[128:143]
  v_and_b32 v6, 31, v2
  s_lshl_b32 s42, s36, 5
  v_add_u32 v6, s42, v6
  v_mul_u32_u24 v148, 336, v6
  v_lshrrev_b32 v7, 5, v2
  v_lshl_add_u32 v148, v7, 3, v148
  s_barrier
  v_cvt_pk_bf16_f32 v144, v64, v65
  v_cvt_pk_bf16_f32 v145, v66, v67
  ds_write_b64 v148, v[144:145] offset:0
  v_cvt_pk_bf16_f32 v146, v68, v69
  v_cvt_pk_bf16_f32 v147, v70, v71
  ds_write_b64 v148, v[146:147] offset:16
  v_cvt_pk_bf16_f32 v144, v72, v73
  v_cvt_pk_bf16_f32 v145, v74, v75
  ds_write_b64 v148, v[144:145] offset:32
  v_cvt_pk_bf16_f32 v146, v76, v77
  v_cvt_pk_bf16_f32 v147, v78, v79
  ds_write_b64 v148, v[146:147] offset:48
  v_cvt_pk_bf16_f32 v144, v80, v81
  v_cvt_pk_bf16_f32 v145, v82, v83
  ds_write_b64 v148, v[144:145] offset:64
  v_cvt_pk_bf16_f32 v146, v84, v85
  v_cvt_pk_bf16_f32 v147, v86, v87
  ds_write_b64 v148, v[146:147] offset:80
  v_cvt_pk_bf16_f32 v144, v88, v89
  v_cvt_pk_bf16_f32 v145, v90, v91
  ds_write_b64 v148, v[144:145] offset:96
  v_cvt_pk_bf16_f32 v146, v92, v93
  v_cvt_pk_bf16_f32 v147, v94, v95
  ds_write_b64 v148, v[146:147] offset:112
  v_cvt_pk_bf16_f32 v144, v96, v97
  v_cvt_pk_bf16_f32 v145, v98, v99
  ds_write_b64 v148, v[144:145] offset:128
  v_cvt_pk_bf16_f32 v146, v100, v101
  v_cvt_pk_bf16_f32 v147, v102, v103
  ds_write_b64 v148, v[146:147] offset:144
  v_cvt_pk_bf16_f32 v144, v104, v105
  v_cvt_pk_bf16_f32 v145, v106, v107
  ds_write_b64 v148, v[144:145] offset:160
  v_cvt_pk_bf16_f32 v146, v108, v109
  v_cvt_pk_bf16_f32 v147, v110, v111
  ds_write_b64 v148, v[146:147] offset:176
  v_cvt_pk_bf16_f32 v144, v112, v113
  v_cvt_pk_bf16_f32 v145, v114, v115
  ds_write_b64 v148, v[144:145] offset:192
  v_cvt_pk_bf16_f32 v146, v116, v117
  v_cvt_pk_bf16_f32 v147, v118, v119
  ds_write_b64 v148, v[146:147] offset:208
  v_cvt_pk_bf16_f32 v144, v120, v121
  v_cvt_pk_bf16_f32 v145, v122, v123
  ds_write_b64 v148, v[144:145] offset:224
  v_cvt_pk_bf16_f32 v146, v124, v125
  v_cvt_pk_bf16_f32 v147, v126, v127
  ds_write_b64 v148, v[146:147] offset:240
  v_cvt_pk_bf16_f32 v144, v128, v129
  v_cvt_pk_bf16_f32 v145, v130, v131
  ds_write_b64 v148, v[144:145] offset:256
  v_cvt_pk_bf16_f32 v146, v132, v133
  v_cvt_pk_bf16_f32 v147, v134, v135
  ds_write_b64 v148, v[146:147] offset:272
  v_cvt_pk_bf16_f32 v144, v136, v137
  v_cvt_pk_bf16_f32 v145, v138, v139
  ds_write_b64 v148, v[144:145] offset:288
  v_cvt_pk_bf16_f32 v146, v140, v141
  v_cvt_pk_bf16_f32 v147, v142, v143
  ds_write_b64 v148, v[146:147] offset:304
  s_waitcnt vmcnt(0) lgkmcnt(0)
  s_barrier
  s_branch P3_LOC_TAPS
P3_LOC_LOADER:
  s_sub_u32 s36, s36, 4
  s_lshl_b32 s42, s37, 7
  v_add_u32 v10, 0, v2
  v_mul_u32_u24 v11, 52429, v10
  v_lshrrev_b32 v11, 20, v11
  v_mul_u32_u24 v12, 20, v11
  v_sub_u32 v12, v10, v12
  v_lshlrev_b32 v13, 3, v12
  v_add_u32 v13, s42, v13
  v_subrev_u32 v13, 16, v13
  v_cmp_gt_u32 vcc, 1000, v13
  v_lshlrev_b32 v12, 4, v12
  v_lshl_add_u32 v3, v11, 12, v12
  v_mov_b32 v13, 0x7ff00000
  v_cndmask_b32 v3, v13, v3, vcc
  v_add_u32 v10, 64, v2
  v_mul_u32_u24 v11, 52429, v10
  v_lshrrev_b32 v11, 20, v11
  v_mul_u32_u24 v12, 20, v11
  v_sub_u32 v12, v10, v12
  v_lshlrev_b32 v13, 3, v12
  v_add_u32 v13, s42, v13
  v_subrev_u32 v13, 16, v13
  v_cmp_gt_u32 vcc, 1000, v13
  v_lshlrev_b32 v12, 4, v12
  v_lshl_add_u32 v4, v11, 12, v12
  v_mov_b32 v13, 0x7ff00000
  v_cndmask_b32 v4, v13, v4, vcc
  v_add_u32 v10, 128, v2
  v_mul_u32_u24 v11, 52429, v10
  v_lshrrev_b32 v11, 20, v11
  v_mul_u32_u24 v12, 20, v11
  v_sub_u32 v12, v10, v12
  v_lshlrev_b32 v13, 3, v12
  v_add_u32 v13, s42, v13
  v_subrev_u32 v13, 16, v13
  v_cmp_gt_u32 vcc, 1000, v13
  v_lshlrev_b32 v12, 4, v12
  v_lshl_add_u32 v5, v11, 12, v12
  v_mov_b32 v13, 0x7ff00000
  v_cndmask_b32 v5, v13, v5, vcc
  v_add_u32 v10, 192, v2
  v_mul_u32_u24 v11, 52429, v10
  v_lshrrev_b32 v11, 20, v11
  v_mul_u32_u24 v12, 20, v11
  v_sub_u32 v12, v10, v12
  v_lshlrev_b32 v13, 3, v12
  v_add_u32 v13, s42, v13
  v_subrev_u32 v13, 16, v13
  v_cmp_gt_u32 vcc, 1000, v13
  v_lshlrev_b32 v12, 4, v12
  v_lshl_add_u32 v6, v11, 12, v12
  v_mov_b32 v13, 0x7ff00000
  v_cndmask_b32 v6, v13, v6, vcc
  v_add_u32 v10, 256, v2
  v_mul_u32_u24 v11, 52429, v10
  v_lshrrev_b32 v11, 20, v11
  v_mul_u32_u24 v12, 20, v11
  v_sub_u32 v12, v10, v12
  v_lshlrev_b32 v13, 3, v12
  v_add_u32 v13, s42, v13
  v_subrev_u32 v13, 16, v13
  v_cmp_gt_u32 vcc, 1000, v13
  v_lshlrev_b32 v12, 4, v12
  v_lshl_add_u32 v7, v11, 12, v12
  v_mov_b32 v13, 0x7ff00000
  v_cndmask_b32 v7, v13, v7, vcc
  v_lshrrev_b32 v10, 4, v2
  v_lshlrev_b32 v11, 2, v10
  v_and_b32 v12, 15, v2
  v_xor_b32 v12, v12, v11
  v_lshlrev_b32 v12, 4, v12
  v_mul_u32_u24 v10, 1024, v10
  v_add_u32 v8, v10, v12
  s_lshl_b32 s45, s36, 16
  s_add_u32 s45, s45, s24
  s_add_u32 s45, s45, 32
  s_lshl_b32 s46, s36, 14
  s_lshl_b32 s42, s38, 8
  s_add_u32 s46, s46, s42
  s_mul_i32 s48, s36, 5120
  s_lshl_b32 s49, s36, 12
  s_add_u32 s49, s49, 20480
  s_barrier
  s_mov_b32 s40, 0
  s_mul_i32 s42, s39, 262144
  s_add_u32 s42, s42, s45
  s_add_u32 s43, s40, s48
  s_mov_b32 m0, s43
  s_nop 0
  buffer_load_dwordx4 v3, s[8:11], s42 offen sc1 lds
  s_add_u32 m0, s43, 1024
  s_nop 0
  buffer_load_dwordx4 v4, s[8:11], s42 offen sc1 lds
  s_add_u32 m0, s43, 2048
  s_nop 0
  buffer_load_dwordx4 v5, s[8:11], s42 offen sc1 lds
  s_add_u32 m0, s43, 3072
  s_nop 0
  buffer_load_dwordx4 v6, s[8:11], s42 offen sc1 lds
  s_add_u32 m0, s43, 4096
  s_nop 0
  buffer_load_dwordx4 v7, s[8:11], s42 offen sc1 lds
  s_mul_i32 s42, s39, 65536
  s_add_u32 s42, s42, s46
  s_add_u32 s43, s40, s49
  s_mov_b32 m0, s43
  s_nop 0
  buffer_load_dwordx4 v8, s[12:15], s42 offen  lds
  s_add_u32 m0, s43, 1024
  s_add_u32 s44, s42, 4096
  buffer_load_dwordx4 v8, s[12:15], s44 offen  lds
  s_add_u32 m0, s43, 2048
  s_add_u32 s44, s42, 8192
  buffer_load_dwordx4 v8, s[12:15], s44 offen  lds
  s_add_u32 m0, s43, 3072
  s_add_u32 s44, s42, 12288
  buffer_load_dwordx4 v8, s[12:15], s44 offen  lds
  s_add_u32 s39, s39, 1
  s_and_b32 s39, s39, 7
  s_add_u32 s40, s40, 36864
  s_cmp_eq_u32 s40, 147456
  s_cselect_b32 s40, 0, s40
  s_mul_i32 s42, s39, 262144
  s_add_u32 s42, s42, s45
  s_add_u32 s43, s40, s48
  s_mov_b32 m0, s43
  s_nop 0
  buffer_load_dwordx4 v3, s[8:11], s42 offen sc1 lds
  s_add_u32 m0, s43, 1024
  s_nop 0
  buffer_load_dwordx4 v4, s[8:11], s42 offen sc1 lds
  s_add_u32 m0, s43, 2048
  s_nop 0
  buffer_load_dwordx4 v5, s[8:11], s42 offen sc1 lds
  s_add_u32 m0, s43, 3072
  s_nop 0
  buffer_load_dwordx4 v6, s[8:11], s42 offen sc1 lds
  s_add_u32 m0, s43, 4096
  s_nop 0
  buffer_load_dwordx4 v7, s[8:11], s42 offen sc1 lds
  s_mul_i32 s42, s39, 65536
  s_add_u32 s42, s42, s46
  s_add_u32 s43, s40, s49
  s_mov_b32 m0, s43
  s_nop 0
  buffer_load_dwordx4 v8, s[12:15], s42 offen  lds
  s_add_u32 m0, s43, 1024
  s_add_u32 s44, s42, 4096
  buffer_load_dwordx4 v8, s[12:15], s44 offen  lds
  s_add_u32 m0, s43, 2048
  s_add_u32 s44, s42, 8192
  buffer_load_dwordx4 v8, s[12:15], s44 offen  lds
  s_add_u32 m0, s43, 3072
  s_add_u32 s44, s42, 12288
  buffer_load_dwordx4 v8, s[12:15], s44 offen  lds
  s_add_u32 s39, s39, 1
  s_and_b32 s39, s39, 7
  s_add_u32 s40, s40, 36864
  s_cmp_eq_u32 s40, 147456
  s_cselect_b32 s40, 0, s40
  s_waitcnt vmcnt(9)
  s_barrier
  s_mov_b32 s41, 6
p3_LD_st_11:
  s_mul_i32 s42, s39, 262144
  s_add_u32 s42, s42, s45
  s_add_u32 s43, s40, s48
  s_mov_b32 m0, s43
  s_nop 0
  buffer_load_dwordx4 v3, s[8:11], s42 offen sc1 lds
  s_add_u32 m0, s43, 1024
  s_nop 0
  buffer_load_dwordx4 v4, s[8:11], s42 offen sc1 lds
  s_add_u32 m0, s43, 2048
  s_nop 0
  buffer_load_dwordx4 v5, s[8:11], s42 offen sc1 lds
  s_add_u32 m0, s43, 3072
  s_nop 0
  buffer_load_dwordx4 v6, s[8:11], s42 offen sc1 lds
  s_add_u32 m0, s43, 4096
  s_nop 0
  buffer_load_dwordx4 v7, s[8:11], s42 offen sc1 lds
  s_mul_i32 s42, s39, 65536
  s_add_u32 s42, s42, s46
  s_add_u32 s43, s40, s49
  s_mov_b32 m0, s43
  s_nop 0
  buffer_load_dwordx4 v8, s[12:15], s42 offen  lds
  s_add_u32 m0, s43, 1024
  s_add_u32 s44, s42, 4096
  buffer_load_dwordx4 v8, s[12:15], s44 offen  lds
  s_add_u32 m0, s43, 2048
  s_add_u32 s44, s42, 8192
  buffer_load_dwordx4 v8, s[12:15], s44 offen  lds
  s_add_u32 m0, s43, 3072
  s_add_u32 s44, s42, 12288
  buffer_load_dwordx4 v8, s[12:15], s44 offen  lds
  s_add_u32 s39, s39, 1
  s_and_b32 s39, s39, 7
  s_add_u32 s40, s40, 36864
  s_cmp_eq_u32 s40, 147456
  s_cselect_b32 s40, 0, s40
  s_waitcnt vmcnt(9)
  s_barrier
  s_sub_u32 s41, s41, 1
  s_cmp_lg_u32 s41, 0
  s_cbranch_scc1 p3_LD_st_11
  s_waitcnt vmcnt(0)
  s_barrier
  s_barrier
  v_subrev_u32 v0, 256, v0
  v_mov_b32 v8, 0
  v_mov_b32 v9, 0
  v_mov_b32 v10, 0
  v_mov_b32 v11, 0
  v_add_u32 v13, 0, v0
  v_lshlrev_b32 v12, 4, v13
  ds_write_b128 v12, v[8:11] offset:43008
  v_add_u32 v13, 256, v0
  v_lshlrev_b32 v12, 4, v13
  ds_write_b128 v12, v[8:11] offset:43008
  v_add_u32 v13, 512, v0
  v_lshlrev_b32 v12, 4, v13
  ds_write_b128 v12, v[8:11] offset:43008
  v_add_u32 v13, 768, v0
  v_lshlrev_b32 v12, 4, v13
  ds_write_b128 v12, v[8:11] offset:43008
  v_add_u32 v13, 1024, v0
  v_lshlrev_b32 v12, 4, v13
  ds_write_b128 v12, v[8:11] offset:43008
  v_add_u32 v13, 1280, v0
  v_lshlrev_b32 v12, 4, v13
  ds_write_b128 v12, v[8:11] offset:43008
  v_add_u32 v13, 1536, v0
  v_lshlrev_b32 v12, 4, v13
  ds_write_b128 v12, v[8:11] offset:43008
  v_add_u32 v13, 1792, v0
  v_lshlrev_b32 v12, 4, v13
  ds_write_b128 v12, v[8:11] offset:43008
  v_add_u32 v13, 2048, v0
  v_lshlrev_b32 v12, 4, v13
  ds_write_b128 v12, v[8:11] offset:43008
  v_add_u32 v13, 2304, v0
  v_lshlrev_b32 v12, 4, v13
  ds_write_b128 v12, v[8:11] offset:43008
  v_add_u32 v13, 2560, v0
  v_lshlrev_b32 v12, 4, v13
  ds_write_b128 v12, v[8:11] offset:43008
  v_add_u32 v13, 2816, v0
  v_lshlrev_b32 v12, 4, v13
  ds_write_b128 v12, v[8:11] offset:43008
  v_add_u32 v13, 3072, v0
  v_lshlrev_b32 v12, 4, v13
  v_cmp_gt_u32 vcc, 3104, v13
  s_nop 0
  s_and_saveexec_b64 s[54:55], vcc
  ds_write_b128 v12, v[8:11] offset:43008
  s_mov_b64 exec, s[54:55]
  v_add_u32 v0, 256, v0
  s_waitcnt vmcnt(0) lgkmcnt(0)
  s_barrier
P3_LOC_TAPS:
  v_and_b32 v17, 127, v0
  v_mul_u32_u24 v17, 388, v17
  v_lshrrev_b32 v16, 7, v0
  v_lshl_add_u32 v17, v16, 1, v17
  ds_write_b16 v17, v240 offset:43040
  ds_write_b16 v17, v240 offset:43230
  ds_write_b16 v17, v241 offset:43048
  ds_write_b16 v17, v241 offset:43238
  ds_write_b16 v17, v242 offset:43056
  ds_write_b16 v17, v242 offset:43246
  ds_write_b16 v17, v243 offset:43064
  ds_write_b16 v17, v243 offset:43254
  ds_write_b16 v17, v244 offset:43072
  ds_write_b16 v17, v244 offset:43262
  ds_write_b16 v17, v245 offset:43080
  ds_write_b16 v17, v245 offset:43270
  ds_write_b16 v17, v246 offset:43088
  ds_write_b16 v17, v246 offset:43278
  v_add_u32 v18, 28, v16
  v_cmp_gt_u32 vcc, 31, v18
  s_nop 0
  s_and_saveexec_b64 s[54:55], vcc
  ds_write_b16 v17, v247 offset:43096
  ds_write_b16 v17, v247 offset:43286
  s_mov_b64 exec, s[54:55]
  s_waitcnt lgkmcnt(0)
  s_barrier
P3_LOC_CONV:
  v_lshrrev_b32 v12, 4, v2
  v_lshlrev_b32 v12, 3, v12
  v_and_b32 v13, 15, v2
  v_sub_u32 v12, v12, v13
  v_add_u32 v12, 15, v12
  v_lshlrev_b32 v12, 1, v12
  v_and_b32 v13, 1, v13
  v_xor_b32 v13, 1, v13
  v_mul_u32_u24 v13, 190, v13
  v_add_u32 v12, v12, v13
  v_add_u32 v8, 43008, v12
  s_mul_i32 s42, s58, 6208
  v_add_u32 v8, s42, v8
  v_lshrrev_b32 v13, 4, v2
  v_lshlrev_b32 v12, 3, v13
  v_sub_u32 v6, v8, v12
  v_and_b32 v12, 15, v2
  v_min_u32 v14, 7, v12
  v_lshlrev_b32 v14, 5, v14
  v_lshl_add_u32 v9, v13, 4, v14
  s_mul_i32 s42, s58, 5376
  s_add_u32 s42, s42, 0
  v_add_u32 v9, s42, v9
  v_lshl_add_u32 v10, v13, 3, v14
  v_add_u32 v10, s42, v10
  v_lshlrev_b32 v15, 4, v12
  v_and_b32 v12, 2, v13
  v_lshl_add_u32 v15, v12, 2, v15
  v_cmp_gt_u32 vcc, s26, v15
  v_lshlrev_b32 v15, 1, v15
  v_and_b32 v12, 1, v13
  v_lshl_add_u32 v15, v12, 12, v15
  v_cndmask_b32 v11, -1, v15, vcc
  s_mul_i32 s42, s58, 65536
  s_add_u32 s42, s42, s25
  v_add_u32 v96, 0, v8
  v_add_u32 v97, 0, v6
  ds_read2_b32 v[16:17], v96 offset0:0 offset1:1
  ds_read2_b32 v[18:19], v96 offset0:2 offset1:3
  ds_read_b128 v[20:23], v9 offset:0
  ds_read2_b32 v[24:25], v97 offset0:16 offset1:17
  ds_read_b64 v[26:27], v10 offset:64
  ds_read_b64 v[28:29], v10 offset:32
  ds_read2_b32 v[32:33], v96 offset0:97 offset1:98
  ds_read2_b32 v[34:35], v96 offset0:99 offset1:100
  ds_read_b128 v[36:39], v9 offset:336
  ds_read2_b32 v[40:41], v97 offset0:113 offset1:114
  ds_read_b64 v[42:43], v10 offset:400
  ds_read_b64 v[44:45], v10 offset:368
  s_waitcnt lgkmcnt(3)
  v_add_u32 v98, 776, v8
  v_add_u32 v99, 776, v6
  ds_read2_b32 v[48:49], v98 offset0:0 offset1:1
  ds_read2_b32 v[50:51], v98 offset0:2 offset1:3
  ds_read_b128 v[52:55], v9 offset:672
  ds_read2_b32 v[56:57], v99 offset0:16 offset1:17
  ds_read_b64 v[58:59], v10 offset:736
  ds_read_b64 v[60:61], v10 offset:704
  ds_read2_b32 v[64:65], v98 offset0:97 offset1:98
  ds_read2_b32 v[66:67], v98 offset0:99 offset1:100
  ds_read_b128 v[68:71], v9 offset:1008
  ds_read2_b32 v[72:73], v99 offset0:113 offset1:114
  ds_read_b64 v[74:75], v10 offset:1072
  ds_read_b64 v[76:77], v10 offset:1040
  s_waitcnt lgkmcnt(15)
  v_lshlrev_b32 v80, 16, v28
  v_and_b32 v81, 0xffff0000, v28
  v_lshlrev_b32 v82, 16, v29
  v_and_b32 v83, 0xffff0000, v29
  s_nop 1
  v_mfma_f32_16x16x32_bf16 v[80:83], v[16:19], v[20:23], v[80:83]
  s_waitcnt lgkmcnt(12)
  v_lshlrev_b32 v84, 16, v44
  v_and_b32 v85, 0xffff0000, v44
  v_lshlrev_b32 v86, 16, v45
  v_and_b32 v87, 0xffff0000, v45
  s_nop 1
  v_mfma_f32_16x16x32_bf16 v[84:87], v[32:35], v[36:39], v[84:87]
  v_mfma_f32_16x16x16_bf16 v[80:83], v[24:25], v[26:27], v[80:83]
  s_nop 4
  v_mfma_f32_16x16x16_bf16 v[84:87], v[40:41], v[42:43], v[84:87]
  s_waitcnt lgkmcnt(3)
  v_add_u32 v96, 1552, v8
  v_add_u32 v97, 1552, v6
  ds_read2_b32 v[16:17], v96 offset0:0 offset1:1
  ds_read2_b32 v[18:19], v96 offset0:2 offset1:3
  ds_read_b128 v[20:23], v9 offset:1344
  ds_read2_b32 v[24:25], v97 offset0:16 offset1:17
  ds_read_b64 v[26:27], v10 offset:1408
  ds_read_b64 v[28:29], v10 offset:1376
  ds_read2_b32 v[32:33], v96 offset0:97 offset1:98
  ds_read2_b32 v[34:35], v96 offset0:99 offset1:100
  ds_read_b128 v[36:39], v9 offset:1680
  ds_read2_b32 v[40:41], v97 offset0:113 offset1:114
  ds_read_b64 v[42:43], v10 offset:1744
  ds_read_b64 v[44:45], v10 offset:1712
  s_waitcnt lgkmcnt(15)
  v_lshlrev_b32 v88, 16, v60
  v_and_b32 v89, 0xffff0000, v60
  v_lshlrev_b32 v90, 16, v61
  v_and_b32 v91, 0xffff0000, v61
  s_nop 1
  v_mfma_f32_16x16x32_bf16 v[88:91], v[48:51], v[52:55], v[88:91]
  s_waitcnt lgkmcnt(12)
  v_lshlrev_b32 v92, 16, v76
  v_and_b32 v93, 0xffff0000, v76
  v_lshlrev_b32 v94, 16, v77
  v_and_b32 v95, 0xffff0000, v77
  s_nop 1
  v_mfma_f32_16x16x32_bf16 v[92:95], v[64:67], v[68:71], v[92:95]
  v_cvt_pk_bf16_f32 v100, v80, v81
  v_cvt_pk_bf16_f32 v101, v82, v83
  v_cvt_pk_bf16_f32 v102, v84, v85
  v_cvt_pk_bf16_f32 v103, v86, v87
  s_nop 0
  v_permlane16_swap_b32 v100, v102
  v_permlane16_swap_b32 v101, v103
  s_add_u32 s43, s42, 0
  buffer_store_dwordx4 v[100:103], v11, s[16:19], s43 offen sc1
  v_mfma_f32_16x16x16_bf16 v[88:91], v[56:57], v[58:59], v[88:91]
  v_mfma_f32_16x16x16_bf16 v[92:95], v[72:73], v[74:75], v[92:95]
  s_waitcnt lgkmcnt(3)
  v_add_u32 v98, 2328, v8
  v_add_u32 v99, 2328, v6
  ds_read2_b32 v[48:49], v98 offset0:0 offset1:1
  ds_read2_b32 v[50:51], v98 offset0:2 offset1:3
  ds_read_b128 v[52:55], v9 offset:2016
  ds_read2_b32 v[56:57], v99 offset0:16 offset1:17
  ds_read_b64 v[58:59], v10 offset:2080
  ds_read_b64 v[60:61], v10 offset:2048
  ds_read2_b32 v[64:65], v98 offset0:97 offset1:98
  ds_read2_b32 v[66:67], v98 offset0:99 offset1:100
  ds_read_b128 v[68:71], v9 offset:2352
  ds_read2_b32 v[72:73], v99 offset0:113 offset1:114
  ds_read_b64 v[74:75], v10 offset:2416
  ds_read_b64 v[76:77], v10 offset:2384
  s_waitcnt lgkmcnt(15)
  v_lshlrev_b32 v80, 16, v28
  v_and_b32 v81, 0xffff0000, v28
  v_lshlrev_b32 v82, 16, v29
  v_and_b32 v83, 0xffff0000, v29
  s_nop 1
  v_mfma_f32_16x16x32_bf16 v[80:83], v[16:19], v[20:23], v[80:83]
  s_waitcnt lgkmcnt(12)
  v_lshlrev_b32 v84, 16, v44
  v_and_b32 v85, 0xffff0000, v44
  v_lshlrev_b32 v86, 16, v45
  v_and_b32 v87, 0xffff0000, v45
  s_nop 1
  v_mfma_f32_16x16x32_bf16 v[84:87], v[32:35], v[36:39], v[84:87]
  v_cvt_pk_bf16_f32 v104, v88, v89
  v_cvt_pk_bf16_f32 v105, v90, v91
  v_cvt_pk_bf16_f32 v106, v92, v93
  v_cvt_pk_bf16_f32 v107, v94, v95
  s_nop 0
  v_permlane16_swap_b32 v104, v106
  v_permlane16_swap_b32 v105, v107
  s_add_u32 s43, s42, 8192
  buffer_store_dwordx4 v[104:107], v11, s[16:19], s43 offen sc1
  v_mfma_f32_16x16x16_bf16 v[80:83], v[24:25], v[26:27], v[80:83]
  v_mfma_f32_16x16x16_bf16 v[84:87], v[40:41], v[42:43], v[84:87]
  s_waitcnt lgkmcnt(3)
  v_add_u32 v96, 3104, v8
  v_add_u32 v97, 3104, v6
  ds_read2_b32 v[16:17], v96 offset0:0 offset1:1
  ds_read2_b32 v[18:19], v96 offset0:2 offset1:3
  ds_read_b128 v[20:23], v9 offset:2688
  ds_read2_b32 v[24:25], v97 offset0:16 offset1:17
  ds_read_b64 v[26:27], v10 offset:2752
  ds_read_b64 v[28:29], v10 offset:2720
  ds_read2_b32 v[32:33], v96 offset0:97 offset1:98
  ds_read2_b32 v[34:35], v96 offset0:99 offset1:100
  ds_read_b128 v[36:39], v9 offset:3024
  ds_read2_b32 v[40:41], v97 offset0:113 offset1:114
  ds_read_b64 v[42:43], v10 offset:3088
  ds_read_b64 v[44:45], v10 offset:3056
  s_waitcnt lgkmcnt(15)
  v_lshlrev_b32 v88, 16, v60
  v_and_b32 v89, 0xffff0000, v60
  v_lshlrev_b32 v90, 16, v61
  v_and_b32 v91, 0xffff0000, v61
  s_nop 1
  v_mfma_f32_16x16x32_bf16 v[88:91], v[48:51], v[52:55], v[88:91]
  s_waitcnt lgkmcnt(12)
  v_lshlrev_b32 v92, 16, v76
  v_and_b32 v93, 0xffff0000, v76
  v_lshlrev_b32 v94, 16, v77
  v_and_b32 v95, 0xffff0000, v77
  s_nop 1
  v_mfma_f32_16x16x32_bf16 v[92:95], v[64:67], v[68:71], v[92:95]
  v_cvt_pk_bf16_f32 v100, v80, v81
  v_cvt_pk_bf16_f32 v101, v82, v83
  v_cvt_pk_bf16_f32 v102, v84, v85
  v_cvt_pk_bf16_f32 v103, v86, v87
  s_nop 0
  v_permlane16_swap_b32 v100, v102
  v_permlane16_swap_b32 v101, v103
  s_add_u32 s43, s42, 16384
  buffer_store_dwordx4 v[100:103], v11, s[16:19], s43 offen sc1
  v_mfma_f32_16x16x16_bf16 v[88:91], v[56:57], v[58:59], v[88:91]
  v_mfma_f32_16x16x16_bf16 v[92:95], v[72:73], v[74:75], v[92:95]
  s_waitcnt lgkmcnt(3)
  v_add_u32 v98, 3880, v8
  v_add_u32 v99, 3880, v6
  ds_read2_b32 v[48:49], v98 offset0:0 offset1:1
  ds_read2_b32 v[50:51], v98 offset0:2 offset1:3
  ds_read_b128 v[52:55], v9 offset:3360
  ds_read2_b32 v[56:57], v99 offset0:16 offset1:17
  ds_read_b64 v[58:59], v10 offset:3424
  ds_read_b64 v[60:61], v10 offset:3392
  ds_read2_b32 v[64:65], v98 offset0:97 offset1:98
  ds_read2_b32 v[66:67], v98 offset0:99 offset1:100
  ds_read_b128 v[68:71], v9 offset:3696
  ds_read2_b32 v[72:73], v99 offset0:113 offset1:114
  ds_read_b64 v[74:75], v10 offset:3760
  ds_read_b64 v[76:77], v10 offset:3728
  s_waitcnt lgkmcnt(15)
  v_lshlrev_b32 v80, 16, v28
  v_and_b32 v81, 0xffff0000, v28
  v_lshlrev_b32 v82, 16, v29
  v_and_b32 v83, 0xffff0000, v29
  s_nop 1
  v_mfma_f32_16x16x32_bf16 v[80:83], v[16:19], v[20:23], v[80:83]
  s_waitcnt lgkmcnt(12)
  v_lshlrev_b32 v84, 16, v44
  v_and_b32 v85, 0xffff0000, v44
  v_lshlrev_b32 v86, 16, v45
  v_and_b32 v87, 0xffff0000, v45
  s_nop 1
  v_mfma_f32_16x16x32_bf16 v[84:87], v[32:35], v[36:39], v[84:87]
  v_cvt_pk_bf16_f32 v104, v88, v89
  v_cvt_pk_bf16_f32 v105, v90, v91
  v_cvt_pk_bf16_f32 v106, v92, v93
  v_cvt_pk_bf16_f32 v107, v94, v95
  s_nop 0
  v_permlane16_swap_b32 v104, v106
  v_permlane16_swap_b32 v105, v107
  s_add_u32 s43, s42, 24576
  buffer_store_dwordx4 v[104:107], v11, s[16:19], s43 offen sc1
  v_mfma_f32_16x16x16_bf16 v[80:83], v[24:25], v[26:27], v[80:83]
  v_mfma_f32_16x16x16_bf16 v[84:87], v[40:41], v[42:43], v[84:87]
  s_waitcnt lgkmcnt(3)
  v_add_u32 v96, 4656, v8
  v_add_u32 v97, 4656, v6
  ds_read2_b32 v[16:17], v96 offset0:0 offset1:1
  ds_read2_b32 v[18:19], v96 offset0:2 offset1:3
  ds_read_b128 v[20:23], v9 offset:4032
  ds_read2_b32 v[24:25], v97 offset0:16 offset1:17
  ds_read_b64 v[26:27], v10 offset:4096
  ds_read_b64 v[28:29], v10 offset:4064
  ds_read2_b32 v[32:33], v96 offset0:97 offset1:98
  ds_read2_b32 v[34:35], v96 offset0:99 offset1:100
  ds_read_b128 v[36:39], v9 offset:4368
  ds_read2_b32 v[40:41], v97 offset0:113 offset1:114
  ds_read_b64 v[42:43], v10 offset:4432
  ds_read_b64 v[44:45], v10 offset:4400
  s_waitcnt lgkmcnt(15)
  v_lshlrev_b32 v88, 16, v60
  v_and_b32 v89, 0xffff0000, v60
  v_lshlrev_b32 v90, 16, v61
  v_and_b32 v91, 0xffff0000, v61
  s_nop 1
  v_mfma_f32_16x16x32_bf16 v[88:91], v[48:51], v[52:55], v[88:91]
  s_waitcnt lgkmcnt(12)
  v_lshlrev_b32 v92, 16, v76
  v_and_b32 v93, 0xffff0000, v76
  v_lshlrev_b32 v94, 16, v77
  v_and_b32 v95, 0xffff0000, v77
  s_nop 1
  v_mfma_f32_16x16x32_bf16 v[92:95], v[64:67], v[68:71], v[92:95]
  v_cvt_pk_bf16_f32 v100, v80, v81
  v_cvt_pk_bf16_f32 v101, v82, v83
  v_cvt_pk_bf16_f32 v102, v84, v85
  v_cvt_pk_bf16_f32 v103, v86, v87
  s_nop 0
  v_permlane16_swap_b32 v100, v102
  v_permlane16_swap_b32 v101, v103
  s_add_u32 s43, s42, 32768
  buffer_store_dwordx4 v[100:103], v11, s[16:19], s43 offen sc1
  v_mfma_f32_16x16x16_bf16 v[88:91], v[56:57], v[58:59], v[88:91]
  v_mfma_f32_16x16x16_bf16 v[92:95], v[72:73], v[74:75], v[92:95]
  s_waitcnt lgkmcnt(3)
  v_add_u32 v98, 5432, v8
  v_add_u32 v99, 5432, v6
  ds_read2_b32 v[48:49], v98 offset0:0 offset1:1
  ds_read2_b32 v[50:51], v98 offset0:2 offset1:3
  ds_read_b128 v[52:55], v9 offset:4704
  ds_read2_b32 v[56:57], v99 offset0:16 offset1:17
  ds_read_b64 v[58:59], v10 offset:4768
  ds_read_b64 v[60:61], v10 offset:4736
  ds_read2_b32 v[64:65], v98 offset0:97 offset1:98
  ds_read2_b32 v[66:67], v98 offset0:99 offset1:100
  ds_read_b128 v[68:71], v9 offset:5040
  ds_read2_b32 v[72:73], v99 offset0:113 offset1:114
  ds_read_b64 v[74:75], v10 offset:5104
  ds_read_b64 v[76:77], v10 offset:5072
  s_waitcnt lgkmcnt(15)
  v_lshlrev_b32 v80, 16, v28
  v_and_b32 v81, 0xffff0000, v28
  v_lshlrev_b32 v82, 16, v29
  v_and_b32 v83, 0xffff0000, v29
  s_nop 1
  v_mfma_f32_16x16x32_bf16 v[80:83], v[16:19], v[20:23], v[80:83]
  s_waitcnt lgkmcnt(12)
  v_lshlrev_b32 v84, 16, v44
  v_and_b32 v85, 0xffff0000, v44
  v_lshlrev_b32 v86, 16, v45
  v_and_b32 v87, 0xffff0000, v45
  s_nop 1
  v_mfma_f32_16x16x32_bf16 v[84:87], v[32:35], v[36:39], v[84:87]
  v_cvt_pk_bf16_f32 v104, v88, v89
  v_cvt_pk_bf16_f32 v105, v90, v91
  v_cvt_pk_bf16_f32 v106, v92, v93
  v_cvt_pk_bf16_f32 v107, v94, v95
  s_nop 0
  v_permlane16_swap_b32 v104, v106
  v_permlane16_swap_b32 v105, v107
  s_add_u32 s43, s42, 40960
  buffer_store_dwordx4 v[104:107], v11, s[16:19], s43 offen sc1
  v_mfma_f32_16x16x16_bf16 v[80:83], v[24:25], v[26:27], v[80:83]
  v_mfma_f32_16x16x16_bf16 v[84:87], v[40:41], v[42:43], v[84:87]
  s_waitcnt lgkmcnt(6)
  v_lshlrev_b32 v88, 16, v60
  v_and_b32 v89, 0xffff0000, v60
  v_lshlrev_b32 v90, 16, v61
  v_and_b32 v91, 0xffff0000, v61
  s_nop 1
  v_mfma_f32_16x16x32_bf16 v[88:91], v[48:51], v[52:55], v[88:91]
  s_waitcnt lgkmcnt(0)
  v_lshlrev_b32 v92, 16, v76
  v_and_b32 v93, 0xffff0000, v76
  v_lshlrev_b32 v94, 16, v77
  v_and_b32 v95, 0xffff0000, v77
  s_nop 1
  v_mfma_f32_16x16x32_bf16 v[92:95], v[64:67], v[68:71], v[92:95]
  v_cvt_pk_bf16_f32 v100, v80, v81
  v_cvt_pk_bf16_f32 v101, v82, v83
  v_cvt_pk_bf16_f32 v102, v84, v85
  v_cvt_pk_bf16_f32 v103, v86, v87
  s_nop 0
  v_permlane16_swap_b32 v100, v102
  v_permlane16_swap_b32 v101, v103
  s_add_u32 s43, s42, 49152
  buffer_store_dwordx4 v[100:103], v11, s[16:19], s43 offen sc1
  v_mfma_f32_16x16x16_bf16 v[88:91], v[56:57], v[58:59], v[88:91]
  v_mfma_f32_16x16x16_bf16 v[92:95], v[72:73], v[74:75], v[92:95]
  s_nop 6
  v_cvt_pk_bf16_f32 v104, v88, v89
  v_cvt_pk_bf16_f32 v105, v90, v91
  v_cvt_pk_bf16_f32 v106, v92, v93
  v_cvt_pk_bf16_f32 v107, v94, v95
  s_nop 0
  v_permlane16_swap_b32 v104, v106
  v_permlane16_swap_b32 v105, v107
  s_add_u32 s43, s42, 57344
  buffer_store_dwordx4 v[104:107], v11, s[16:19], s43 offen sc1
P3_FIN:
P3_END:
  s_waitcnt vmcnt(0) lgkmcnt(0)
  s_barrier
  v_lshrrev_b32 v1, 6, v0
  s_nop 0
  v_readfirstlane_b32 s96, v1
  s_nop 0
  s_cmp_lg_u32 s96, 0
  s_cbranch_scc1 p3_arr_12
  s_cmp_eq_u32 s101, -1
  s_cbranch_scc1 p3_arr_12
  s_lshl_b32 s96, s101, 7
  s_add_u32 s96, s96, 65536
  v_mov_b32 v1, s3
  v_mov_b32 v2, 0
  s_mov_b64 exec, 1
  buffer_store_dword v1, v2, s[92:95], s96 offen sc1
  s_mov_b64 exec, -1
p3_arr_12:
  s_cmp_ge_u32 s2, 256
  s_cbranch_scc1 P4_END
  s_load_dwordx2 s[4:5], s[0:1], 80
  s_load_dwordx2 s[6:7], s[0:1], 56
  s_load_dwordx2 s[32:33], s[0:1], 0
  s_load_dwordx2 s[34:35], s[0:1], 64
  v_lshrrev_b32 v1, 6, v0
  v_and_b32 v2, 63, v0
  v_readfirstlane_b32 s36, v1
  s_and_b32 s47, s2, 7
  s_lshr_b32 s50, s2, 3
  s_mov_b32 s58, s36
  s_waitcnt lgkmcnt(0)
  s_lshr_b32 s42, s50, 3
  s_lshl_b32 s37, s47, 2
  s_add_u32 s37, s37, s42
  s_and_b32 s38, s50, 7
  s_lshl_b32 s42, s42, 2
  s_lshl_b32 s39, s38, 1
  s_add_u32 s39, s39, s42
  s_and_b32 s39, s39, 15
  s_mov_b32 s39, 0
  s_mov_b32 s8, s6
  s_mov_b32 s9, s7
  s_mov_b32 s10, 1048576
  s_mov_b32 s11, 0x20000
  s_add_u32 s12, s4, 24117248
  s_addc_u32 s13, s5, 0
  s_mov_b32 s14, 4194304
  s_mov_b32 s15, 0x20000
  s_mov_b32 s16, s34
  s_mov_b32 s17, s35
  s_mov_b32 s18, 2048000
  s_mov_b32 s19, 0x20000
  s_mov_b32 s20, s32
  s_mov_b32 s21, s33
  s_mov_b32 s22, 2048000
  s_mov_b32 s23, 0x20000
  v_lshrrev_b32 v4, 3, v0
  v_and_b32 v5, 7, v0
  v_lshlrev_b32 v5, 4, v5
  v_lshl_add_u32 v70, v4, 10, v5
  s_lshl_b32 s43, s37, 16
  s_lshl_b32 s44, s38, 7
  s_add_u32 s26, s43, s44
  s_cmp_ge_u32 s36, 4
  s_cbranch_scc1 P4_LOADER
  s_and_b32 s24, s36, 1
  s_lshr_b32 s25, s36, 1
  v_lshrrev_b32 v6, 5, v2
  v_lshlrev_b32 v6, 3, v6
  v_bfe_u32 v7, v2, 2, 2
  v_add_u32 v6, v6, v7
  v_bfe_u32 v8, v2, 4, 1
  v_lshlrev_b32 v8, 5, v8
  v_and_b32 v9, 3, v2
  v_lshl_add_u32 v8, v9, 3, v8
  v_lshlrev_b32 v9, 7, v6
  v_add_u32 v9, v9, v8
  v_add_u32 v9, 0, v9
  v_bfe_u32 v10, v2, 3, 1
  v_xor_b32 v10, s24, v10
  v_lshlrev_b32 v10, 6, v10
  v_add_u32 v3, v9, v10
  v_lshrrev_b32 v6, 5, v2
  v_lshlrev_b32 v6, 3, v6
  v_bfe_u32 v7, v2, 2, 2
  v_add_u32 v6, v6, v7
  v_bfe_u32 v8, v2, 4, 1
  v_lshlrev_b32 v8, 5, v8
  v_and_b32 v9, 3, v2
  v_lshl_add_u32 v8, v9, 3, v8
  v_lshlrev_b32 v9, 7, v6
  v_add_u32 v9, v9, v8
  v_add_u32 v9, 98304, v9
  v_bfe_u32 v10, v2, 3, 1
  v_xor_b32 v10, s25, v10
  v_lshlrev_b32 v10, 6, v10
  v_add_u32 v4, v9, v10
  s_mov_b32 s53, 0
  s_mov_b32 s56, 4294909952
  s_mov_b32 s57, 8192
  v_mov_b32 v48, 0
  v_mov_b32 v49, 0
  v_mov_b32 v50, 0
  v_mov_b32 v51, 0
  v_mov_b32 v52, 0
  v_mov_b32 v53, 0
  v_mov_b32 v54, 0
  v_mov_b32 v55, 0
  v_mov_b32 v56, 0
  v_mov_b32 v57, 0
  v_mov_b32 v58, 0
  v_mov_b32 v59, 0
  v_mov_b32 v60, 0
  v_mov_b32 v61, 0
  v_mov_b32 v62, 0
  v_mov_b32 v63, 0
  s_cmp_lg_u32 s58, 0
  s_cbranch_scc1 p4_gwd_1
  s_lshl_b32 s96, s37, 6
  s_add_u32 s97, s96, 63
  s_min_u32 s97, s97, 1999
  s_min_u32 s96, s96, 1999
  v_mov_b32 v7, s96
  v_mov_b32 v8, s97
  v_bfe_u32 v9, v2, 3, 1
  v_bfe_u32 v10, v2, 2, 1
  v_cmp_lt_u32 vcc, 15, v2
  s_nop 1
  v_cndmask_b32 v9, v9, v10, vcc
  v_cmp_eq_u32 vcc, 1, v9
  s_nop 1
  v_cndmask_b32 v7, v7, v8, vcc
  v_cmp_le_u32 vcc, 1000, v7
  v_subrev_u32 v8, 1000, v7
  s_nop 0
  v_cndmask_b32 v7, v7, v8, vcc
  v_mov_b32 v8, 0
  v_mov_b32 v9, 1
  v_cndmask_b32 v8, v8, v9, vcc
  v_mul_u32_u24 v9, 683, v7
  v_lshrrev_b32 v9, 16, v9
  v_mul_u32_u24 v10, 11, v8
  v_add_u32 v9, v9, v10
  v_and_b32 v10, 7, v2
  v_lshl_add_u32 v9, v9, 3, v10
  v_lshrrev_b32 v10, 7, v7
  v_lshl_add_u32 v10, v8, 3, v10
  v_and_b32 v11, 3, v2
  v_lshl_add_u32 v10, v10, 2, v11
  v_add_u32 v10, 176, v10
  v_cmp_lt_u32 vcc, 15, v2
  s_nop 1
  v_cndmask_b32 v6, v9, v10, vcc
  v_lshlrev_b32 v6, 7, v6
  s_mov_b32 s97, 65536
  s_mov_b32 s96, 0x200000
p4_gw_2:
  buffer_load_dword v7, v6, s[92:95], s97 offen sc1
  s_waitcnt vmcnt(0)
  v_cmp_ne_u32 vcc, s3, v7
  s_sub_u32 s96, s96, 1
  s_cmp_eq_u32 s96, 0
  s_cbranch_scc1 p4_gwd_1
  s_nop 1
  s_cbranch_vccnz p4_gw_2
p4_gwd_1:
  s_barrier
  s_barrier
  ds_read_b64_tr_b16 v[16:17], v3 offset:0
  ds_read_b64_tr_b16 v[18:19], v3 offset:512
  ds_read_b64_tr_b16 v[32:33], v4 offset:0
  ds_read_b64_tr_b16 v[34:35], v4 offset:512
  ds_read_b64_tr_b16 v[20:21], v3 offset:2048
  ds_read_b64_tr_b16 v[22:23], v3 offset:2560
  ds_read_b64_tr_b16 v[36:37], v4 offset:2048
  ds_read_b64_tr_b16 v[38:39], v4 offset:2560
  ds_read_b64_tr_b16 v[24:25], v3 offset:4096
  ds_read_b64_tr_b16 v[26:27], v3 offset:4608
  ds_read_b64_tr_b16 v[40:41], v4 offset:4096
  ds_read_b64_tr_b16 v[42:43], v4 offset:4608
  ds_read_b64_tr_b16 v[28:29], v3 offset:6144
  ds_read_b64_tr_b16 v[30:31], v3 offset:6656
  ds_read_b64_tr_b16 v[44:45], v4 offset:6144
  ds_read_b64_tr_b16 v[46:47], v4 offset:6656
  s_barrier
  s_add_u32 s53, s53, 8192
  s_cmp_eq_u32 s53, 65536
  s_cselect_b32 s52, s56, s57
  s_cselect_b32 s53, 0, s53
  v_add_u32 v4, s52, v4
  v_add_u32 v3, 8192, v3
  s_waitcnt lgkmcnt(12)
  v_mfma_f32_32x32x16_bf16 v[48:63], v[16:19], v[32:35], v[48:63]
  ds_read_b64_tr_b16 v[16:17], v3 offset:0
  ds_read_b64_tr_b16 v[18:19], v3 offset:512
  ds_read_b64_tr_b16 v[32:33], v4 offset:0
  ds_read_b64_tr_b16 v[34:35], v4 offset:512
  s_waitcnt lgkmcnt(12)
  v_mfma_f32_32x32x16_bf16 v[48:63], v[20:23], v[36:39], v[48:63]
  ds_read_b64_tr_b16 v[20:21], v3 offset:2048
  ds_read_b64_tr_b16 v[22:23], v3 offset:2560
  ds_read_b64_tr_b16 v[36:37], v4 offset:2048
  ds_read_b64_tr_b16 v[38:39], v4 offset:2560
  s_waitcnt lgkmcnt(12)
  v_mfma_f32_32x32x16_bf16 v[48:63], v[24:27], v[40:43], v[48:63]
  ds_read_b64_tr_b16 v[24:25], v3 offset:4096
  ds_read_b64_tr_b16 v[26:27], v3 offset:4608
  ds_read_b64_tr_b16 v[40:41], v4 offset:4096
  ds_read_b64_tr_b16 v[42:43], v4 offset:4608
  s_waitcnt lgkmcnt(12)
  v_mfma_f32_32x32x16_bf16 v[48:63], v[28:31], v[44:47], v[48:63]
  ds_read_b64_tr_b16 v[28:29], v3 offset:6144
  ds_read_b64_tr_b16 v[30:31], v3 offset:6656
  ds_read_b64_tr_b16 v[44:45], v4 offset:6144
  ds_read_b64_tr_b16 v[46:47], v4 offset:6656
  s_barrier
  s_add_u32 s53, s53, 8192
  s_cmp_eq_u32 s53, 65536
  s_cselect_b32 s52, s56, s57
  s_cselect_b32 s53, 0, s53
  v_add_u32 v4, s52, v4
  v_add_u32 v3, 8192, v3
  s_waitcnt lgkmcnt(12)
  v_mfma_f32_32x32x16_bf16 v[48:63], v[16:19], v[32:35], v[48:63]
  ds_read_b64_tr_b16 v[16:17], v3 offset:0
  ds_read_b64_tr_b16 v[18:19], v3 offset:512
  ds_read_b64_tr_b16 v[32:33], v4 offset:0
  ds_read_b64_tr_b16 v[34:35], v4 offset:512
  s_waitcnt lgkmcnt(12)
  v_mfma_f32_32x32x16_bf16 v[48:63], v[20:23], v[36:39], v[48:63]
  ds_read_b64_tr_b16 v[20:21], v3 offset:2048
  ds_read_b64_tr_b16 v[22:23], v3 offset:2560
  ds_read_b64_tr_b16 v[36:37], v4 offset:2048
  ds_read_b64_tr_b16 v[38:39], v4 offset:2560
  s_waitcnt lgkmcnt(12)
  v_mfma_f32_32x32x16_bf16 v[48:63], v[24:27], v[40:43], v[48:63]
  ds_read_b64_tr_b16 v[24:25], v3 offset:4096
  ds_read_b64_tr_b16 v[26:27], v3 offset:4608
  ds_read_b64_tr_b16 v[40:41], v4 offset:4096
  ds_read_b64_tr_b16 v[42:43], v4 offset:4608
  s_waitcnt lgkmcnt(12)
  v_mfma_f32_32x32x16_bf16 v[48:63], v[28:31], v[44:47], v[48:63]
  ds_read_b64_tr_b16 v[28:29], v3 offset:6144
  ds_read_b64_tr_b16 v[30:31], v3 offset:6656
  ds_read_b64_tr_b16 v[44:45], v4 offset:6144
  ds_read_b64_tr_b16 v[46:47], v4 offset:6656
  s_barrier
  s_add_u32 s53, s53, 8192
  s_cmp_eq_u32 s53, 65536
  s_cselect_b32 s52, s56, s57
  s_cselect_b32 s53, 0, s53
  v_add_u32 v4, s52, v4
  v_add_u32 v3, 8192, v3
  s_waitcnt lgkmcnt(12)
  v_mfma_f32_32x32x16_bf16 v[48:63], v[16:19], v[32:35], v[48:63]
  ds_read_b64_tr_b16 v[16:17], v3 offset:0
  ds_read_b64_tr_b16 v[18:19], v3 offset:512
  ds_read_b64_tr_b16 v[32:33], v4 offset:0
  ds_read_b64_tr_b16 v[34:35], v4 offset:512
  s_waitcnt lgkmcnt(12)
  v_mfma_f32_32x32x16_bf16 v[48:63], v[20:23], v[36:39], v[48:63]
  ds_read_b64_tr_b16 v[20:21], v3 offset:2048
  ds_read_b64_tr_b16 v[22:23], v3 offset:2560
  ds_read_b64_tr_b16 v[36:37], v4 offset:2048
  ds_read_b64_tr_b16 v[38:39], v4 offset:2560
  s_waitcnt lgkmcnt(12)
  v_mfma_f32_32x32x16_bf16 v[48:63], v[24:27], v[40:43], v[48:63]
  ds_read_b64_tr_b16 v[24:25], v3 offset:4096
  ds_read_b64_tr_b16 v[26:27], v3 offset:4608
  ds_read_b64_tr_b16 v[40:41], v4 offset:4096
  ds_read_b64_tr_b16 v[42:43], v4 offset:4608
  s_waitcnt lgkmcnt(12)
  v_mfma_f32_32x32x16_bf16 v[48:63], v[28:31], v[44:47], v[48:63]
  ds_read_b64_tr_b16 v[28:29], v3 offset:6144
  ds_read_b64_tr_b16 v[30:31], v3 offset:6656
  ds_read_b64_tr_b16 v[44:45], v4 offset:6144
  ds_read_b64_tr_b16 v[46:47], v4 offset:6656
  s_barrier
  s_add_u32 s53, s53, 8192
  s_cmp_eq_u32 s53, 65536
  s_cselect_b32 s52, s56, s57
  s_cselect_b32 s53, 0, s53
  v_add_u32 v4, s52, v4
  v_add_u32 v3, 8192, v3
  s_waitcnt lgkmcnt(12)
  v_mfma_f32_32x32x16_bf16 v[48:63], v[16:19], v[32:35], v[48:63]
  ds_read_b64_tr_b16 v[16:17], v3 offset:0
  ds_read_b64_tr_b16 v[18:19], v3 offset:512
  ds_read_b64_tr_b16 v[32:33], v4 offset:0
  ds_read_b64_tr_b16 v[34:35], v4 offset:512
  s_waitcnt lgkmcnt(12)
  v_mfma_f32_32x32x16_bf16 v[48:63], v[20:23], v[36:39], v[48:63]
  ds_read_b64_tr_b16 v[20:21], v3 offset:2048
  ds_read_b64_tr_b16 v[22:23], v3 offset:2560
  ds_read_b64_tr_b16 v[36:37], v4 offset:2048
  ds_read_b64_tr_b16 v[38:39], v4 offset:2560
  s_waitcnt lgkmcnt(12)
  v_mfma_f32_32x32x16_bf16 v[48:63], v[24:27], v[40:43], v[48:63]
  ds_read_b64_tr_b16 v[24:25], v3 offset:4096
  ds_read_b64_tr_b16 v[26:27], v3 offset:4608
  ds_read_b64_tr_b16 v[40:41], v4 offset:4096
  ds_read_b64_tr_b16 v[42:43], v4 offset:4608
  s_waitcnt lgkmcnt(12)
  v_mfma_f32_32x32x16_bf16 v[48:63], v[28:31], v[44:47], v[48:63]
  ds_read_b64_tr_b16 v[28:29], v3 offset:6144
  ds_read_b64_tr_b16 v[30:31], v3 offset:6656
  ds_read_b64_tr_b16 v[44:45], v4 offset:6144
  ds_read_b64_tr_b16 v[46:47], v4 offset:6656
  s_barrier
  s_add_u32 s53, s53, 8192
  s_cmp_eq_u32 s53, 65536
  s_cselect_b32 s52, s56, s57
  s_cselect_b32 s53, 0, s53
  v_add_u32 v4, s52, v4
  v_add_u32 v3, 8192, v3
  s_waitcnt lgkmcnt(12)
  v_mfma_f32_32x32x16_bf16 v[48:63], v[16:19], v[32:35], v[48:63]
  ds_read_b64_tr_b16 v[16:17], v3 offset:0
  ds_read_b64_tr_b16 v[18:19], v3 offset:512
  ds_read_b64_tr_b16 v[32:33], v4 offset:0
  ds_read_b64_tr_b16 v[34:35], v4 offset:512
  s_waitcnt lgkmcnt(12)
  v_mfma_f32_32x32x16_bf16 v[48:63], v[20:23], v[36:39], v[48:63]
  ds_read_b64_tr_b16 v[20:21], v3 offset:2048
  ds_read_b64_tr_b16 v[22:23], v3 offset:2560
  ds_read_b64_tr_b16 v[36:37], v4 offset:2048
  ds_read_b64_tr_b16 v[38:39], v4 offset:2560
  s_waitcnt lgkmcnt(12)
  v_mfma_f32_32x32x16_bf16 v[48:63], v[24:27], v[40:43], v[48:63]
  ds_read_b64_tr_b16 v[24:25], v3 offset:4096
  ds_read_b64_tr_b16 v[26:27], v3 offset:4608
  ds_read_b64_tr_b16 v[40:41], v4 offset:4096
  ds_read_b64_tr_b16 v[42:43], v4 offset:4608
  s_waitcnt lgkmcnt(12)
  v_mfma_f32_32x32x16_bf16 v[48:63], v[28:31], v[44:47], v[48:63]
  ds_read_b64_tr_b16 v[28:29], v3 offset:6144
  ds_read_b64_tr_b16 v[30:31], v3 offset:6656
  ds_read_b64_tr_b16 v[44:45], v4 offset:6144
  ds_read_b64_tr_b16 v[46:47], v4 offset:6656
  s_barrier
  s_add_u32 s53, s53, 8192
  s_cmp_eq_u32 s53, 65536
  s_cselect_b32 s52, s56, s57
  s_cselect_b32 s53, 0, s53
  v_add_u32 v4, s52, v4
  v_add_u32 v3, 8192, v3
  s_waitcnt lgkmcnt(12)
  v_mfma_f32_32x32x16_bf16 v[48:63], v[16:19], v[32:35], v[48:63]
  ds_read_b64_tr_b16 v[16:17], v3 offset:0
  ds_read_b64_tr_b16 v[18:19], v3 offset:512
  ds_read_b64_tr_b16 v[32:33], v4 offset:0
  ds_read_b64_tr_b16 v[34:35], v4 offset:512
  s_waitcnt lgkmcnt(12)
  v_mfma_f32_32x32x16_bf16 v[48:63], v[20:23], v[36:39], v[48:63]
  ds_read_b64_tr_b16 v[20:21], v3 offset:2048
  ds_read_b64_tr_b16 v[22:23], v3 offset:2560
  ds_read_b64_tr_b16 v[36:37], v4 offset:2048
  ds_read_b64_tr_b16 v[38:39], v4 offset:2560
  s_waitcnt lgkmcnt(12)
  v_mfma_f32_32x32x16_bf16 v[48:63], v[24:27], v[40:43], v[48:63]
  ds_read_b64_tr_b16 v[24:25], v3 offset:4096
  ds_read_b64_tr_b16 v[26:27], v3 offset:4608
  ds_read_b64_tr_b16 v[40:41], v4 offset:4096
  ds_read_b64_tr_b16 v[42:43], v4 offset:4608
  s_waitcnt lgkmcnt(12)
  v_mfma_f32_32x32x16_bf16 v[48:63], v[28:31], v[44:47], v[48:63]
  ds_read_b64_tr_b16 v[28:29], v3 offset:6144
  ds_read_b64_tr_b16 v[30:31], v3 offset:6656
  ds_read_b64_tr_b16 v[44:45], v4 offset:6144
  ds_read_b64_tr_b16 v[46:47], v4 offset:6656
  s_barrier
  s_add_u32 s53, s53, 8192
  s_cmp_eq_u32 s53, 65536
  s_cselect_b32 s52, s56, s57
  s_cselect_b32 s53, 0, s53
  v_add_u32 v4, s52, v4
  v_add_u32 v3, 8192, v3
  s_waitcnt lgkmcnt(12)
  v_mfma_f32_32x32x16_bf16 v[48:63], v[16:19], v[32:35], v[48:63]
  ds_read_b64_tr_b16 v[16:17], v3 offset:0
  ds_read_b64_tr_b16 v[18:19], v3 offset:512
  ds_read_b64_tr_b16 v[32:33], v4 offset:0
  ds_read_b64_tr_b16 v[34:35], v4 offset:512
  s_waitcnt lgkmcnt(12)
  v_mfma_f32_32x32x16_bf16 v[48:63], v[20:23], v[36:39], v[48:63]
  ds_read_b64_tr_b16 v[20:21], v3 offset:2048
  ds_read_b64_tr_b16 v[22:23], v3 offset:2560
  ds_read_b64_tr_b16 v[36:37], v4 offset:2048
  ds_read_b64_tr_b16 v[38:39], v4 offset:2560
  s_waitcnt lgkmcnt(12)
  v_mfma_f32_32x32x16_bf16 v[48:63], v[24:27], v[40:43], v[48:63]
  ds_read_b64_tr_b16 v[24:25], v3 offset:4096
  ds_read_b64_tr_b16 v[26:27], v3 offset:4608
  ds_read_b64_tr_b16 v[40:41], v4 offset:4096
  ds_read_b64_tr_b16 v[42:43], v4 offset:4608
  s_waitcnt lgkmcnt(12)
  v_mfma_f32_32x32x16_bf16 v[48:63], v[28:31], v[44:47], v[48:63]
  ds_read_b64_tr_b16 v[28:29], v3 offset:6144
  ds_read_b64_tr_b16 v[30:31], v3 offset:6656
  ds_read_b64_tr_b16 v[44:45], v4 offset:6144
  ds_read_b64_tr_b16 v[46:47], v4 offset:6656
  s_barrier
  s_add_u32 s53, s53, 8192
  s_cmp_eq_u32 s53, 65536
  s_cselect_b32 s52, s56, s57
  s_cselect_b32 s53, 0, s53
  v_add_u32 v4, s52, v4
  v_add_u32 v3, 8192, v3
  s_waitcnt lgkmcnt(12)
  v_mfma_f32_32x32x16_bf16 v[48:63], v[16:19], v[32:35], v[48:63]
  ds_read_b64_tr_b16 v[16:17], v3 offset:0
  ds_read_b64_tr_b16 v[18:19], v3 offset:512
  ds_read_b64_tr_b16 v[32:33], v4 offset:0
  ds_read_b64_tr_b16 v[34:35], v4 offset:512
  s_waitcnt lgkmcnt(12)
  v_mfma_f32_32x32x16_bf16 v[48:63], v[20:23], v[36:39], v[48:63]
  ds_read_b64_tr_b16 v[20:21], v3 offset:2048
  ds_read_b64_tr_b16 v[22:23], v3 offset:2560
  ds_read_b64_tr_b16 v[36:37], v4 offset:2048
  ds_read_b64_tr_b16 v[38:39], v4 offset:2560
  s_waitcnt lgkmcnt(12)
  v_mfma_f32_32x32x16_bf16 v[48:63], v[24:27], v[40:43], v[48:63]
  ds_read_b64_tr_b16 v[24:25], v3 offset:4096
  ds_read_b64_tr_b16 v[26:27], v3 offset:4608
  ds_read_b64_tr_b16 v[40:41], v4 offset:4096
  ds_read_b64_tr_b16 v[42:43], v4 offset:4608
  s_waitcnt lgkmcnt(12)
  v_mfma_f32_32x32x16_bf16 v[48:63], v[28:31], v[44:47], v[48:63]
  ds_read_b64_tr_b16 v[28:29], v3 offset:6144
  ds_read_b64_tr_b16 v[30:31], v3 offset:6656
  ds_read_b64_tr_b16 v[44:45], v4 offset:6144
  ds_read_b64_tr_b16 v[46:47], v4 offset:6656
  s_barrier
  s_add_u32 s53, s53, 8192
  s_cmp_eq_u32 s53, 65536
  s_cselect_b32 s52, s56, s57
  s_cselect_b32 s53, 0, s53
  v_add_u32 v4, s52, v4
  v_add_u32 v3, 8192, v3
  s_waitcnt lgkmcnt(12)
  v_mfma_f32_32x32x16_bf16 v[48:63], v[16:19], v[32:35], v[48:63]
  ds_read_b64_tr_b16 v[16:17], v3 offset:0
  ds_read_b64_tr_b16 v[18:19], v3 offset:512
  ds_read_b64_tr_b16 v[32:33], v4 offset:0
  ds_read_b64_tr_b16 v[34:35], v4 offset:512
  s_waitcnt lgkmcnt(12)
  v_mfma_f32_32x32x16_bf16 v[48:63], v[20:23], v[36:39], v[48:63]
  ds_read_b64_tr_b16 v[20:21], v3 offset:2048
  ds_read_b64_tr_b16 v[22:23], v3 offset:2560
  ds_read_b64_tr_b16 v[36:37], v4 offset:2048
  ds_read_b64_tr_b16 v[38:39], v4 offset:2560
  s_waitcnt lgkmcnt(12)
  v_mfma_f32_32x32x16_bf16 v[48:63], v[24:27], v[40:43], v[48:63]
  ds_read_b64_tr_b16 v[24:25], v3 offset:4096
  ds_read_b64_tr_b16 v[26:27], v3 offset:4608
  ds_read_b64_tr_b16 v[40:41], v4 offset:4096
  ds_read_b64_tr_b16 v[42:43], v4 offset:4608
  s_waitcnt lgkmcnt(12)
  v_mfma_f32_32x32x16_bf16 v[48:63], v[28:31], v[44:47], v[48:63]
  ds_read_b64_tr_b16 v[28:29], v3 offset:6144
  ds_read_b64_tr_b16 v[30:31], v3 offset:6656
  ds_read_b64_tr_b16 v[44:45], v4 offset:6144
  ds_read_b64_tr_b16 v[46:47], v4 offset:6656
  s_barrier
  s_add_u32 s53, s53, 8192
  s_cmp_eq_u32 s53, 65536
  s_cselect_b32 s52, s56, s57
  s_cselect_b32 s53, 0, s53
  v_add_u32 v4, s52, v4
  v_add_u32 v3, 8192, v3
  s_waitcnt lgkmcnt(12)
  v_mfma_f32_32x32x16_bf16 v[48:63], v[16:19], v[32:35], v[48:63]
  ds_read_b64_tr_b16 v[16:17], v3 offset:0
  ds_read_b64_tr_b16 v[18:19], v3 offset:512
  ds_read_b64_tr_b16 v[32:33], v4 offset:0
  ds_read_b64_tr_b16 v[34:35], v4 offset:512
  s_waitcnt lgkmcnt(12)
  v_mfma_f32_32x32x16_bf16 v[48:63], v[20:23], v[36:39], v[48:63]
  ds_read_b64_tr_b16 v[20:21], v3 offset:2048
  ds_read_b64_tr_b16 v[22:23], v3 offset:2560
  ds_read_b64_tr_b16 v[36:37], v4 offset:2048
  ds_read_b64_tr_b16 v[38:39], v4 offset:2560
  s_waitcnt lgkmcnt(12)
  v_mfma_f32_32x32x16_bf16 v[48:63], v[24:27], v[40:43], v[48:63]
  ds_read_b64_tr_b16 v[24:25], v3 offset:4096
  ds_read_b64_tr_b16 v[26:27], v3 offset:4608
  ds_read_b64_tr_b16 v[40:41], v4 offset:4096
  ds_read_b64_tr_b16 v[42:43], v4 offset:4608
  s_waitcnt lgkmcnt(12)
  v_mfma_f32_32x32x16_bf16 v[48:63], v[28:31], v[44:47], v[48:63]
  ds_read_b64_tr_b16 v[28:29], v3 offset:6144
  ds_read_b64_tr_b16 v[30:31], v3 offset:6656
  ds_read_b64_tr_b16 v[44:45], v4 offset:6144
  ds_read_b64_tr_b16 v[46:47], v4 offset:6656
  s_barrier
  s_add_u32 s53, s53, 8192
  s_cmp_eq_u32 s53, 65536
  s_cselect_b32 s52, s56, s57
  s_cselect_b32 s53, 0, s53
  v_add_u32 v4, s52, v4
  v_add_u32 v3, 8192, v3
  s_waitcnt lgkmcnt(12)
  v_mfma_f32_32x32x16_bf16 v[48:63], v[16:19], v[32:35], v[48:63]
  ds_read_b64_tr_b16 v[16:17], v3 offset:0
  ds_read_b64_tr_b16 v[18:19], v3 offset:512
  ds_read_b64_tr_b16 v[32:33], v4 offset:0
  ds_read_b64_tr_b16 v[34:35], v4 offset:512
  s_waitcnt lgkmcnt(12)
  v_mfma_f32_32x32x16_bf16 v[48:63], v[20:23], v[36:39], v[48:63]
  ds_read_b64_tr_b16 v[20:21], v3 offset:2048
  ds_read_b64_tr_b16 v[22:23], v3 offset:2560
  ds_read_b64_tr_b16 v[36:37], v4 offset:2048
  ds_read_b64_tr_b16 v[38:39], v4 offset:2560
  s_waitcnt lgkmcnt(12)
  v_mfma_f32_32x32x16_bf16 v[48:63], v[24:27], v[40:43], v[48:63]
  ds_read_b64_tr_b16 v[24:25], v3 offset:4096
  ds_read_b64_tr_b16 v[26:27], v3 offset:4608
  ds_read_b64_tr_b16 v[40:41], v4 offset:4096
  ds_read_b64_tr_b16 v[42:43], v4 offset:4608
  s_waitcnt lgkmcnt(12)
  v_mfma_f32_32x32x16_bf16 v[48:63], v[28:31], v[44:47], v[48:63]
  ds_read_b64_tr_b16 v[28:29], v3 offset:6144
  ds_read_b64_tr_b16 v[30:31], v3 offset:6656
  ds_read_b64_tr_b16 v[44:45], v4 offset:6144
  ds_read_b64_tr_b16 v[46:47], v4 offset:6656
  s_barrier
  s_add_u32 s53, s53, 8192
  s_cmp_eq_u32 s53, 65536
  s_cselect_b32 s52, s56, s57
  s_cselect_b32 s53, 0, s53
  v_add_u32 v4, s52, v4
  v_add_u32 v3, 4294877184, v3
  s_waitcnt lgkmcnt(12)
  v_mfma_f32_32x32x16_bf16 v[48:63], v[16:19], v[32:35], v[48:63]
  ds_read_b64_tr_b16 v[16:17], v3 offset:0
  ds_read_b64_tr_b16 v[18:19], v3 offset:512
  ds_read_b64_tr_b16 v[32:33], v4 offset:0
  ds_read_b64_tr_b16 v[34:35], v4 offset:512
  s_waitcnt lgkmcnt(12)
  v_mfma_f32_32x32x16_bf16 v[48:63], v[20:23], v[36:39], v[48:63]
  ds_read_b64_tr_b16 v[20:21], v3 offset:2048
  ds_read_b64_tr_b16 v[22:23], v3 offset:2560
  ds_read_b64_tr_b16 v[36:37], v4 offset:2048
  ds_read_b64_tr_b16 v[38:39], v4 offset:2560
  s_waitcnt lgkmcnt(12)
  v_mfma_f32_32x32x16_bf16 v[48:63], v[24:27], v[40:43], v[48:63]
  ds_read_b64_tr_b16 v[24:25], v3 offset:4096
  ds_read_b64_tr_b16 v[26:27], v3 offset:4608
  ds_read_b64_tr_b16 v[40:41], v4 offset:4096
  ds_read_b64_tr_b16 v[42:43], v4 offset:4608
  s_waitcnt lgkmcnt(12)
  v_mfma_f32_32x32x16_bf16 v[48:63], v[28:31], v[44:47], v[48:63]
  ds_read_b64_tr_b16 v[28:29], v3 offset:6144
  ds_read_b64_tr_b16 v[30:31], v3 offset:6656
  ds_read_b64_tr_b16 v[44:45], v4 offset:6144
  ds_read_b64_tr_b16 v[46:47], v4 offset:6656
  s_barrier
  s_add_u32 s53, s53, 8192
  s_cmp_eq_u32 s53, 65536
  s_cselect_b32 s52, s56, s57
  s_cselect_b32 s53, 0, s53
  v_add_u32 v4, s52, v4
  v_add_u32 v3, 8192, v3
  s_waitcnt lgkmcnt(12)
  v_mfma_f32_32x32x16_bf16 v[48:63], v[16:19], v[32:35], v[48:63]
  ds_read_b64_tr_b16 v[16:17], v3 offset:0
  ds_read_b64_tr_b16 v[18:19], v3 offset:512
  ds_read_b64_tr_b16 v[32:33], v4 offset:0
  ds_read_b64_tr_b16 v[34:35], v4 offset:512
  s_waitcnt lgkmcnt(12)
  v_mfma_f32_32x32x16_bf16 v[48:63], v[20:23], v[36:39], v[48:63]
  ds_read_b64_tr_b16 v[20:21], v3 offset:2048
  ds_read_b64_tr_b16 v[22:23], v3 offset:2560
  ds_read_b64_tr_b16 v[36:37], v4 offset:2048
  ds_read_b64_tr_b16 v[38:39], v4 offset:2560
  s_waitcnt lgkmcnt(12)
  v_mfma_f32_32x32x16_bf16 v[48:63], v[24:27], v[40:43], v[48:63]
  ds_read_b64_tr_b16 v[24:25], v3 offset:4096
  ds_read_b64_tr_b16 v[26:27], v3 offset:4608
  ds_read_b64_tr_b16 v[40:41], v4 offset:4096
  ds_read_b64_tr_b16 v[42:43], v4 offset:4608
  s_waitcnt lgkmcnt(12)
  v_mfma_f32_32x32x16_bf16 v[48:63], v[28:31], v[44:47], v[48:63]
  ds_read_b64_tr_b16 v[28:29], v3 offset:6144
  ds_read_b64_tr_b16 v[30:31], v3 offset:6656
  ds_read_b64_tr_b16 v[44:45], v4 offset:6144
  ds_read_b64_tr_b16 v[46:47], v4 offset:6656
  s_barrier
  s_add_u32 s53, s53, 8192
  s_cmp_eq_u32 s53, 65536
  s_cselect_b32 s52, s56, s57
  s_cselect_b32 s53, 0, s53
  v_add_u32 v4, s52, v4
  v_add_u32 v3, 8192, v3
  s_waitcnt lgkmcnt(12)
  v_mfma_f32_32x32x16_bf16 v[48:63], v[16:19], v[32:35], v[48:63]
  ds_read_b64_tr_b16 v[16:17], v3 offset:0
  ds_read_b64_tr_b16 v[18:19], v3 offset:512
  ds_read_b64_tr_b16 v[32:33], v4 offset:0
  ds_read_b64_tr_b16 v[34:35], v4 offset:512
  s_waitcnt lgkmcnt(12)
  v_mfma_f32_32x32x16_bf16 v[48:63], v[20:23], v[36:39], v[48:63]
  ds_read_b64_tr_b16 v[20:21], v3 offset:2048
  ds_read_b64_tr_b16 v[22:23], v3 offset:2560
  ds_read_b64_tr_b16 v[36:37], v4 offset:2048
  ds_read_b64_tr_b16 v[38:39], v4 offset:2560
  s_waitcnt lgkmcnt(12)
  v_mfma_f32_32x32x16_bf16 v[48:63], v[24:27], v[40:43], v[48:63]
  ds_read_b64_tr_b16 v[24:25], v3 offset:4096
  ds_read_b64_tr_b16 v[26:27], v3 offset:4608
  ds_read_b64_tr_b16 v[40:41], v4 offset:4096
  ds_read_b64_tr_b16 v[42:43], v4 offset:4608
  s_waitcnt lgkmcnt(12)
  v_mfma_f32_32x32x16_bf16 v[48:63], v[28:31], v[44:47], v[48:63]
  ds_read_b64_tr_b16 v[28:29], v3 offset:6144
  ds_read_b64_tr_b16 v[30:31], v3 offset:6656
  ds_read_b64_tr_b16 v[44:45], v4 offset:6144
  ds_read_b64_tr_b16 v[46:47], v4 offset:6656
  s_barrier
  s_add_u32 s53, s53, 8192
  s_cmp_eq_u32 s53, 65536
  s_cselect_b32 s52, s56, s57
  s_cselect_b32 s53, 0, s53
  v_add_u32 v4, s52, v4
  v_add_u32 v3, 8192, v3
  s_waitcnt lgkmcnt(12)
  v_mfma_f32_32x32x16_bf16 v[48:63], v[16:19], v[32:35], v[48:63]
  ds_read_b64_tr_b16 v[16:17], v3 offset:0
  ds_read_b64_tr_b16 v[18:19], v3 offset:512
  ds_read_b64_tr_b16 v[32:33], v4 offset:0
  ds_read_b64_tr_b16 v[34:35], v4 offset:512
  s_waitcnt lgkmcnt(12)
  v_mfma_f32_32x32x16_bf16 v[48:63], v[20:23], v[36:39], v[48:63]
  ds_read_b64_tr_b16 v[20:21], v3 offset:2048
  ds_read_b64_tr_b16 v[22:23], v3 offset:2560
  ds_read_b64_tr_b16 v[36:37], v4 offset:2048
  ds_read_b64_tr_b16 v[38:39], v4 offset:2560
  s_waitcnt lgkmcnt(12)
  v_mfma_f32_32x32x16_bf16 v[48:63], v[24:27], v[40:43], v[48:63]
  ds_read_b64_tr_b16 v[24:25], v3 offset:4096
  ds_read_b64_tr_b16 v[26:27], v3 offset:4608
  ds_read_b64_tr_b16 v[40:41], v4 offset:4096
  ds_read_b64_tr_b16 v[42:43], v4 offset:4608
  s_waitcnt lgkmcnt(12)
  v_mfma_f32_32x32x16_bf16 v[48:63], v[28:31], v[44:47], v[48:63]
  ds_read_b64_tr_b16 v[28:29], v3 offset:6144
  ds_read_b64_tr_b16 v[30:31], v3 offset:6656
  ds_read_b64_tr_b16 v[44:45], v4 offset:6144
  ds_read_b64_tr_b16 v[46:47], v4 offset:6656
  s_waitcnt lgkmcnt(12)
  v_mfma_f32_32x32x16_bf16 v[48:63], v[16:19], v[32:35], v[48:63]
  s_waitcnt lgkmcnt(8)
  v_mfma_f32_32x32x16_bf16 v[48:63], v[20:23], v[36:39], v[48:63]
  s_waitcnt lgkmcnt(4)
  v_mfma_f32_32x32x16_bf16 v[48:63], v[24:27], v[40:43], v[48:63]
  s_waitcnt lgkmcnt(0)
  v_mfma_f32_32x32x16_bf16 v[48:63], v[28:31], v[44:47], v[48:63]
  v_and_b32 v6, 31, v2
  s_lshl_b32 s42, s25, 5
  v_add_u32 v6, s42, v6
  v_mul_u32_u24 v64, 272, v6
  s_lshl_b32 s42, s24, 7
  v_add_u32 v64, s42, v64
  v_lshrrev_b32 v7, 5, v2
  v_lshl_add_u32 v64, v7, 4, v64
  s_barrier
  s_nop 2
  ds_write_b128 v64, v[48:51] offset:0
  ds_write_b128 v64, v[52:55] offset:32
  ds_write_b128 v64, v[56:59] offset:64
  ds_write_b128 v64, v[60:63] offset:96
  s_waitcnt lgkmcnt(0)
  s_barrier
  s_branch P4_STORE
P4_LOADER:
  s_sub_u32 s36, s36, 4
  v_lshrrev_b32 v8, 3, v2
  v_bfe_u32 v9, v2, 4, 1
  v_lshlrev_b32 v9, 2, v9
  v_and_b32 v10, 7, v2
  v_xor_b32 v10, v10, v9
  v_lshlrev_b32 v10, 4, v10
  v_mul_u32_u24 v8, 1024, v8
  v_add_u32 v3, v8, v10
  v_lshrrev_b32 v8, 3, v2
  v_bfe_u32 v9, v2, 4, 1
  v_lshlrev_b32 v9, 2, v9
  v_and_b32 v10, 7, v2
  v_xor_b32 v10, v10, v9
  v_lshlrev_b32 v10, 4, v10
  v_mul_u32_u24 v8, 4096, v8
  v_add_u32 v4, v8, v10
  s_lshl_b32 s45, s36, 14
  s_lshl_b32 s42, s38, 7
  s_add_u32 s45, s45, s42
  s_lshl_b32 s46, s36, 16
  s_lshl_b32 s42, s37, 7
  s_add_u32 s46, s46, s42
  s_lshl_b32 s48, s36, 11
  s_mov_b32 s49, s48
  s_add_u32 m0, s48, 0
  s_add_u32 s44, s45, 0
  buffer_load_dwordx4 v3, s[8:11], s44 offen lds
  s_add_u32 m0, s48, 1024
  s_add_u32 s44, s45, 8192
  buffer_load_dwordx4 v3, s[8:11], s44 offen lds
  s_add_u32 m0, s48, 8192
  s_add_u32 s44, s45, 65536
  buffer_load_dwordx4 v3, s[8:11], s44 offen lds
  s_add_u32 m0, s48, 9216
  s_add_u32 s44, s45, 73728
  buffer_load_dwordx4 v3, s[8:11], s44 offen lds
  s_add_u32 m0, s48, 16384
  s_add_u32 s44, s45, 131072
  buffer_load_dwordx4 v3, s[8:11], s44 offen lds
  s_add_u32 m0, s48, 17408
  s_add_u32 s44, s45, 139264
  buffer_load_dwordx4 v3, s[8:11], s44 offen lds
  s_add_u32 m0, s48, 24576
  s_add_u32 s44, s45, 196608
  buffer_load_dwordx4 v3, s[8:11], s44 offen lds
  s_add_u32 m0, s48, 25600
  s_add_u32 s44, s45, 204800
  buffer_load_dwordx4 v3, s[8:11], s44 offen lds
  s_add_u32 m0, s48, 32768
  s_add_u32 s44, s45, 262144
  buffer_load_dwordx4 v3, s[8:11], s44 offen lds
  s_add_u32 m0, s48, 33792
  s_add_u32 s44, s45, 270336
  buffer_load_dwordx4 v3, s[8:11], s44 offen lds
  s_add_u32 m0, s48, 40960
  s_add_u32 s44, s45, 327680
  buffer_load_dwordx4 v3, s[8:11], s44 offen lds
  s_add_u32 m0, s48, 41984
  s_add_u32 s44, s45, 335872
  buffer_load_dwordx4 v3, s[8:11], s44 offen lds
  s_add_u32 m0, s48, 49152
  s_add_u32 s44, s45, 393216
  buffer_load_dwordx4 v3, s[8:11], s44 offen lds
  s_add_u32 m0, s48, 50176
  s_add_u32 s44, s45, 401408
  buffer_load_dwordx4 v3, s[8:11], s44 offen lds
  s_add_u32 m0, s48, 57344
  s_add_u32 s44, s45, 458752
  buffer_load_dwordx4 v3, s[8:11], s44 offen lds
  s_add_u32 m0, s48, 58368
  s_add_u32 s44, s45, 466944
  buffer_load_dwordx4 v3, s[8:11], s44 offen lds
  s_add_u32 m0, s48, 65536
  s_add_u32 s44, s45, 524288
  buffer_load_dwordx4 v3, s[8:11], s44 offen lds
  s_add_u32 m0, s48, 66560
  s_add_u32 s44, s45, 532480
  buffer_load_dwordx4 v3, s[8:11], s44 offen lds
  s_add_u32 m0, s48, 73728
  s_add_u32 s44, s45, 589824
  buffer_load_dwordx4 v3, s[8:11], s44 offen lds
  s_add_u32 m0, s48, 74752
  s_add_u32 s44, s45, 598016
  buffer_load_dwordx4 v3, s[8:11], s44 offen lds
  s_add_u32 m0, s48, 81920
  s_add_u32 s44, s45, 655360
  buffer_load_dwordx4 v3, s[8:11], s44 offen lds
  s_add_u32 m0, s48, 82944
  s_add_u32 s44, s45, 663552
  buffer_load_dwordx4 v3, s[8:11], s44 offen lds
  s_add_u32 m0, s48, 90112
  s_add_u32 s44, s45, 720896
  buffer_load_dwordx4 v3, s[8:11], s44 offen lds
  s_add_u32 m0, s48, 91136
  s_add_u32 s44, s45, 729088
  buffer_load_dwordx4 v3, s[8:11], s44 offen lds
  s_barrier
  s_add_u32 m0, s48, 98304
  s_add_u32 s44, s46, 0
  buffer_load_dwordx4 v4, s[12:15], s44 offen sc1 lds
  s_add_u32 m0, s48, 99328
  s_add_u32 s44, s46, 32768
  buffer_load_dwordx4 v4, s[12:15], s44 offen sc1 lds
  s_add_u32 m0, s48, 106496
  s_add_u32 s44, s46, 262144
  buffer_load_dwordx4 v4, s[12:15], s44 offen sc1 lds
  s_add_u32 m0, s48, 107520
  s_add_u32 s44, s46, 294912
  buffer_load_dwordx4 v4, s[12:15], s44 offen sc1 lds
  s_add_u32 m0, s48, 114688
  s_add_u32 s44, s46, 524288
  buffer_load_dwordx4 v4, s[12:15], s44 offen sc1 lds
  s_add_u32 m0, s48, 115712
  s_add_u32 s44, s46, 557056
  buffer_load_dwordx4 v4, s[12:15], s44 offen sc1 lds
  s_add_u32 m0, s48, 122880
  s_add_u32 s44, s46, 786432
  buffer_load_dwordx4 v4, s[12:15], s44 offen sc1 lds
  s_add_u32 m0, s48, 123904
  s_add_u32 s44, s46, 819200
  buffer_load_dwordx4 v4, s[12:15], s44 offen sc1 lds
  s_add_u32 m0, s48, 131072
  s_add_u32 s44, s46, 1048576
  buffer_load_dwordx4 v4, s[12:15], s44 offen sc1 lds
  s_add_u32 m0, s48, 132096
  s_add_u32 s44, s46, 1081344
  buffer_load_dwordx4 v4, s[12:15], s44 offen sc1 lds
  s_add_u32 m0, s48, 139264
  s_add_u32 s44, s46, 1310720
  buffer_load_dwordx4 v4, s[12:15], s44 offen sc1 lds
  s_add_u32 m0, s48, 140288
  s_add_u32 s44, s46, 1343488
  buffer_load_dwordx4 v4, s[12:15], s44 offen sc1 lds
  s_waitcnt vmcnt(10)
  s_barrier
  s_add_u32 m0, s48, 147456
  s_add_u32 s44, s46, 1572864
  buffer_load_dwordx4 v4, s[12:15], s44 offen sc1 lds
  s_add_u32 m0, s48, 148480
  s_add_u32 s44, s46, 1605632
  buffer_load_dwordx4 v4, s[12:15], s44 offen sc1 lds
  s_waitcnt vmcnt(10)
  s_barrier
  s_add_u32 m0, s48, 155648
  s_add_u32 s44, s46, 1835008
  buffer_load_dwordx4 v4, s[12:15], s44 offen sc1 lds
  s_add_u32 m0, s48, 156672
  s_add_u32 s44, s46, 1867776
  buffer_load_dwordx4 v4, s[12:15], s44 offen sc1 lds
  s_waitcnt vmcnt(10)
  s_barrier
  s_add_u32 m0, s48, 98304
  s_add_u32 s44, s46, 2097152
  buffer_load_dwordx4 v4, s[12:15], s44 offen sc1 lds
  s_add_u32 m0, s48, 99328
  s_add_u32 s44, s46, 2129920
  buffer_load_dwordx4 v4, s[12:15], s44 offen sc1 lds
  s_add_u32 m0, s48, 0
  s_add_u32 s44, s45, 786432
  buffer_load_dwordx4 v3, s[8:11], s44 offen lds
  s_add_u32 m0, s48, 1024
  s_add_u32 s44, s45, 794624
  buffer_load_dwordx4 v3, s[8:11], s44 offen lds
  s_waitcnt vmcnt(12)
  s_barrier
  s_add_u32 m0, s48, 106496
  s_add_u32 s44, s46, 2359296
  buffer_load_dwordx4 v4, s[12:15], s44 offen sc1 lds
  s_add_u32 m0, s48, 107520
  s_add_u32 s44, s46, 2392064
  buffer_load_dwordx4 v4, s[12:15], s44 offen sc1 lds
  s_add_u32 m0, s48, 8192
  s_add_u32 s44, s45, 851968
  buffer_load_dwordx4 v3, s[8:11], s44 offen lds
  s_add_u32 m0, s48, 9216
  s_add_u32 s44, s45, 860160
  buffer_load_dwordx4 v3, s[8:11], s44 offen lds
  s_waitcnt vmcnt(14)
  s_barrier
  s_add_u32 m0, s48, 114688
  s_add_u32 s44, s46, 2621440
  buffer_load_dwordx4 v4, s[12:15], s44 offen sc1 lds
  s_add_u32 m0, s48, 115712
  s_add_u32 s44, s46, 2654208
  buffer_load_dwordx4 v4, s[12:15], s44 offen sc1 lds
  s_add_u32 m0, s48, 16384
  s_add_u32 s44, s45, 917504
  buffer_load_dwordx4 v3, s[8:11], s44 offen lds
  s_add_u32 m0, s48, 17408
  s_add_u32 s44, s45, 925696
  buffer_load_dwordx4 v3, s[8:11], s44 offen lds
  s_waitcnt vmcnt(16)
  s_barrier
  s_add_u32 m0, s48, 122880
  s_add_u32 s44, s46, 2883584
  buffer_load_dwordx4 v4, s[12:15], s44 offen sc1 lds
  s_add_u32 m0, s48, 123904
  s_add_u32 s44, s46, 2916352
  buffer_load_dwordx4 v4, s[12:15], s44 offen sc1 lds
  s_add_u32 m0, s48, 24576
  s_add_u32 s44, s45, 983040
  buffer_load_dwordx4 v3, s[8:11], s44 offen lds
  s_add_u32 m0, s48, 25600
  s_add_u32 s44, s45, 991232
  buffer_load_dwordx4 v3, s[8:11], s44 offen lds
  s_waitcnt vmcnt(18)
  s_barrier
  s_add_u32 m0, s48, 131072
  s_add_u32 s44, s46, 3145728
  buffer_load_dwordx4 v4, s[12:15], s44 offen sc1 lds
  s_add_u32 m0, s48, 132096
  s_add_u32 s44, s46, 3178496
  buffer_load_dwordx4 v4, s[12:15], s44 offen sc1 lds
  s_waitcnt vmcnt(18)
  s_barrier
  s_add_u32 m0, s48, 139264
  s_add_u32 s44, s46, 3407872
  buffer_load_dwordx4 v4, s[12:15], s44 offen sc1 lds
  s_add_u32 m0, s48, 140288
  s_add_u32 s44, s46, 3440640
  buffer_load_dwordx4 v4, s[12:15], s44 offen sc1 lds
  s_waitcnt vmcnt(18)
  s_barrier
  s_add_u32 m0, s48, 147456
  s_add_u32 s44, s46, 3670016
  buffer_load_dwordx4 v4, s[12:15], s44 offen sc1 lds
  s_add_u32 m0, s48, 148480
  s_add_u32 s44, s46, 3702784
  buffer_load_dwordx4 v4, s[12:15], s44 offen sc1 lds
  s_waitcnt vmcnt(16)
  s_barrier
  s_add_u32 m0, s48, 155648
  s_add_u32 s44, s46, 3932160
  buffer_load_dwordx4 v4, s[12:15], s44 offen sc1 lds
  s_add_u32 m0, s48, 156672
  s_add_u32 s44, s46, 3964928
  buffer_load_dwordx4 v4, s[12:15], s44 offen sc1 lds
  s_waitcnt vmcnt(14)
  s_barrier
  s_waitcnt vmcnt(10)
  s_barrier
  s_waitcnt vmcnt(6)
  s_barrier
  s_waitcnt vmcnt(4)
  s_barrier
  s_waitcnt vmcnt(2)
  s_barrier
  s_waitcnt vmcnt(0)
  s_barrier
  s_barrier
  s_barrier
P4_STORE:
  buffer_load_dwordx4 v[20:23], v70, s[20:23], s26 offen
  v_lshrrev_b32 v4, 3, v0
  v_and_b32 v5, 7, v0
  v_mul_u32_u24 v6, 272, v4
  v_lshl_add_u32 v6, v5, 5, v6
  ds_read_b128 v[8:11], v6
  ds_read_b128 v[12:15], v6 offset:16
  s_waitcnt vmcnt(0) lgkmcnt(0)
  v_lshlrev_b32 v24, 16, v20
  v_and_b32 v25, 0xffff0000, v20
  v_add_f32 v24, v24, v8
  v_add_f32 v25, v25, v9
  v_cvt_pk_bf16_f32 v20, v24, v25
  v_lshlrev_b32 v24, 16, v21
  v_and_b32 v25, 0xffff0000, v21
  v_add_f32 v24, v24, v10
  v_add_f32 v25, v25, v11
  v_cvt_pk_bf16_f32 v21, v24, v25
  v_lshlrev_b32 v24, 16, v22
  v_and_b32 v25, 0xffff0000, v22
  v_add_f32 v24, v24, v12
  v_add_f32 v25, v25, v13
  v_cvt_pk_bf16_f32 v22, v24, v25
  v_lshlrev_b32 v24, 16, v23
  v_and_b32 v25, 0xffff0000, v23
  v_add_f32 v24, v24, v14
  v_add_f32 v25, v25, v15
  v_cvt_pk_bf16_f32 v23, v24, v25
  buffer_store_dwordx4 v[20:23], v70, s[16:19], s26 offen
P4_END:
  s_endpgm
P4_END_EXIT:
  s_endpgm
.section .rodata,"a"
.p2align 6
.amdhsa_kernel standalone__conformer_family_e_branchformer__speech_kernel
  .amdhsa_next_free_vgpr 248
  .amdhsa_next_free_sgpr 102
  .amdhsa_accum_offset 248
  .amdhsa_group_segment_fixed_size 0
  .amdhsa_kernarg_size 88
  .amdhsa_user_sgpr_count 2
  .amdhsa_user_sgpr_kernarg_segment_ptr 1
  .amdhsa_system_sgpr_workgroup_id_x 1
.end_amdhsa_kernel
```
